```python
import torch

def _softmax(x, axis=-1):
    return torch.softmax(x, dim=axis)
def _gelu(x):
    return torch.nn.functional.gelu(x, approximate="tanh")
def _silu(x):
    return torch.nn.functional.silu(x)
def _sigmoid(x):
    return torch.sigmoid(x)
def _layernorm(x, axis=-1, eps=1e-5):
    m = x.mean(dim=axis, keepdim=True)
    v = x.var(dim=axis, keepdim=True, unbiased=False)
    return (x - m) / torch.sqrt(v + eps)
def _scatter_add(tgt, idx, src, axis=0):
    return tgt.clone().index_add_(axis, idx, src)
def _segment_sum(src, seg, n):
    out = torch.zeros((n,) + src.shape[1:], dtype=src.dtype)
    return out.index_add_(0, seg, src)
def _pad(x, pw):
    flat = tuple(v for pair in reversed(pw) for v in pair)
    return torch.nn.functional.pad(x, flat)

kernel_name = 'gated_mix__grouped_kv_mqa__mixer_token_mlp__prompt'

def setup_inputs():

    _w = (lambda a: (lambda t: t.to(torch.bfloat16) if t.is_floating_point() else t)(torch.as_tensor(a)))
    def _A_setup():
        B, S, D, H = 1, 2048, 1024, 32
        Dh = D // H
        return {
            "x": _w((lambda *s: torch.randn(*s, dtype=torch.bfloat16) * 0.05)(B, S, D)),
            "wq": _w((lambda *s: torch.randn(*s, dtype=torch.bfloat16) * 0.8)(D, H * Dh)),
            "wk": _w((lambda *s: torch.randn(*s, dtype=torch.bfloat16) * 0.8)(D, Dh)),
            "wv": _w((lambda *s: torch.randn(*s, dtype=torch.bfloat16) * 0.05)(D, Dh)),
            "wo": _w((lambda *s: torch.randn(*s, dtype=torch.bfloat16) * 0.05)(H * Dh, D)),
        }
    _A_in = _A_setup()

    def _B_setup():
        B, S, D, F = 1, 2048, 1024, 3584
        return {
            "x": _w((lambda *s: torch.randn(*s, dtype=torch.bfloat16) * 0.05)(B, S, D)),
            "w1": _w((lambda *s: torch.randn(*s, dtype=torch.bfloat16) * 0.4)(S, F) * (S ** -0.5)),
            "b1": _w((lambda *s: torch.randn(*s, dtype=torch.bfloat16) * 3.2)(F) * 0.02),
            "w2": _w((lambda *s: torch.randn(*s, dtype=torch.bfloat16) * 0.1)(F, S) * (F ** -0.5)),
            "b2": _w((lambda *s: torch.randn(*s, dtype=torch.bfloat16) * 0.4)(S) * 0.02),
        }
    _B_in = _B_setup()

    return {
        "A_x": _A_in["x"],
        "A_wq": _A_in["wq"],
        "A_wk": _A_in["wk"],
        "A_wv": _A_in["wv"],
        "A_wo": _A_in["wo"],
        "B_x": _B_in["x"],
        "B_w1": _B_in["w1"],
        "B_b1": _B_in["b1"],
        "B_w2": _B_in["w2"],
        "B_b2": _B_in["b2"],
        "gate_w": _w((lambda *s: torch.randn(*s, dtype=torch.bfloat16) * 0.05)(1024) * 16.0),
    }

def reference(A_x, A_wq, A_wk, A_wv, A_wo, B_x, B_w1, B_b1, B_w2, B_b2, gate_w):
    def _A_ref(x, wq, wk, wv, wo):
        B, S, D = x.shape
        H = 32
        Dh = D // H
        q = (lambda x, *d: x.permute(*d))((x @ wq).reshape(B, S, H, Dh), 0, 2, 1, 3)
        k = x @ wk
        v = x @ wv
        scores = torch.einsum("bhqd,bkd->bhqk", q, k) * (Dh ** -0.5)
        p = _softmax(scores, axis=-1)
        o = torch.einsum("bhqk,bkd->bhqd", p, v)
        return (lambda x, *d: x.permute(*d))(o, 0, 2, 1, 3).reshape(B, S, H * Dh) @ wo

    def _B_ref(x, w1, b1, w2, b2):
        B, S, D = x.shape
        h = _layernorm(x, axis=-1)
        u = torch.einsum("bsd,sf->bdf", h, w1) + b1
        u = _gelu(u)
        y = torch.einsum("bdf,fs->bds", u, w2) + b2
        return (lambda x, *d: x.permute(*d))(y, 0, 2, 1)

    x = A_x
    g = _sigmoid((x * gate_w).sum(-1, keepdims=True))
    a = _A_ref(x, A_wq, A_wk, A_wv, A_wo)
    b = _B_ref(x, B_w1, B_b1, B_w2, B_b2)
    return g * a + (1 - g) * b
```

```asm
; @launch grid=(256,1,1) block=(1024,1,1) lds=163840
.amdgcn_target "amdgcn-amd-amdhsa--gfx950"
.text
.globl gated_mix__grouped_kv_mqa__mixer_token_mlp__prompt_kernel
.p2align 8
.type gated_mix__grouped_kv_mqa__mixer_token_mlp__prompt_kernel,@function
gated_mix__grouped_kv_mqa__mixer_token_mlp__prompt_kernel:
  s_cmp_ge_u32 s2, 256
  s_cbranch_scc1 L_end
  s_add_u32 s2, s2, 224
  s_and_b32 s2, s2, 255
  s_load_dwordx8 s[4:11], s[0:1], 0
  s_load_dwordx4 s[12:15], s[0:1], 48
  s_load_dwordx4 s[36:39], s[0:1], 96
  s_load_dwordx2 s[34:35], s[0:1], 80
  v_lshrrev_b32 v1, 6, v0
  v_and_b32 v2, 63, v0
  v_readfirstlane_b32 s3, v1
  v_lshlrev_b32 v3, 4, v2
  s_and_b32 s40, s2, 7
  s_lshr_b32 s41, s2, 3
  s_and_b32 s60, s40, 1
  s_lshr_b32 s61, s40, 1
  s_lshr_b32 s62, s41, 2
  s_and_b32 s63, s41, 3
  s_lshl_b32 s42, s60, 3
  s_add_u32 s42, s42, s62
  s_lshl_b32 s43, s61, 2
  s_add_u32 s43, s43, s63
  s_lshl_b32 s44, s60, 2
  s_add_u32 s44, s44, s63
  s_mul_i32 s45, s61, 7
  s_add_u32 s45, s45, s62
  s_cmp_ge_u32 s3, 4
  s_cbranch_scc1 L_nld
  s_lshl_b32 s62, s42, 6
  s_lshl_b32 s63, s43, 7
  v_lshrrev_b32 v4, 3, v2
  s_mov_b32 s60, 2048
  v_mul_lo_u32 v4, v4, s60
  s_mul_i32 s60, s3, 32768
  s_lshl_b32 s61, s62, 1
  s_add_u32 s60, s60, s61
  v_add_u32 v4, s60, v4
  v_bfe_u32 v5, v2, 4, 1
  v_lshlrev_b32 v5, 1, v5
  v_and_b32 v8, 7, v2
  v_xor_b32 v5, v5, v8
  v_lshl_add_u32 v8, v5, 4, v4
  v_xor_b32 v5, 4, v5
  v_lshl_add_u32 v9, v5, 4, v4
  v_add_u32 v9, 15360, v9
  s_lshl_b32 s60, s3, 5
  s_add_u32 s60, s60, s63
  s_mul_i32 s60, s60, 2048
  s_mov_b32 s61, 2048
  v_lshrrev_b32 v4, 3, v2
  v_mul_lo_u32 v4, v4, s61
  v_add_u32 v4, s60, v4
  v_lshrrev_b32 v5, 4, v2
  v_and_b32 v10, 7, v2
  v_xor_b32 v5, v5, v10
  v_lshl_add_u32 v10, v5, 4, v4
  v_xor_b32 v5, 4, v5
  v_lshl_add_u32 v4, v5, 4, v4
  v_add_u32 v11, 15360, v4
  v_add_u32 v12, 30720, v10
  v_add_u32 v13, 46080, v4
  s_add_u32 s51, s42, s43
  s_and_b32 s51, s51, 1
  s_mul_i32 s48, s51, 1048576
  s_mul_i32 s49, s51, 1024
  s_mul_i32 s51, s51, 32768
  s_lshl_b32 s55, s3, 12
  s_lshl_b32 s46, s3, 11
  s_lshl_b32 s47, s3, 10
  v_add_u32 v14, s55, v3
  v_add_u32 v26, s47, v3
  s_lshl_b32 s52, s43, 4
  s_add_u32 s52, s52, s42
  s_lshl_b32 s52, s52, 14
  s_mov_b32 s53, 0
  s_waitcnt lgkmcnt(0)
  s_mov_b32 s16, s6
  s_mov_b32 s17, s7
  s_mov_b32 s18, 2097152
  s_mov_b32 s19, 0x00020000
  s_mov_b32 s20, s4
  s_mov_b32 s21, s5
  s_mov_b32 s22, 4194304
  s_mov_b32 s23, 0x00020000
  s_mov_b32 s28, s34
  s_mov_b32 s29, s35
  s_mov_b32 s30, 2048
  s_mov_b32 s31, 0x00020000
  s_cmp_lt_u32 s2, 224
  s_cbranch_scc1 L_ldn
  s_and_b32 s63, s40, 1
  s_cmp_eq_u32 s63, 0
  s_cselect_b32 s24, s8, s10
  s_cselect_b32 s25, s9, s11
  s_mov_b32 s26, 65536
  s_mov_b32 s27, 0x00020000
  s_add_u32 m0, s47, 8192
  s_nop 0
  buffer_load_dwordx4 v26, s[24:27], s51 offen lds
  s_add_u32 s51, s51, 4096
  s_and_b32 s51, s51, 65535
  s_add_u32 m0, s55, 65536
  s_nop 0
  buffer_load_dwordx4 v10, s[20:23], s49 offen lds
  buffer_load_dwordx4 v11, s[20:23], s49 offen offset:1024 lds
  buffer_load_dwordx4 v12, s[20:23], s49 offen offset:2048 lds
  buffer_load_dwordx4 v13, s[20:23], s49 offen offset:3072 lds
  s_add_u32 s49, s49, 128
  s_and_b32 s49, s49, 2047
  s_add_u32 m0, s55, 131072
  s_nop 0
  buffer_load_dwordx4 v14, s[20:23], s52 offen lds
  buffer_load_dwordx4 v14, s[20:23], s52 offen offset:1024 lds
  buffer_load_dwordx4 v14, s[20:23], s52 offen offset:2048 lds
  buffer_load_dwordx4 v14, s[20:23], s52 offen offset:3072 lds
  s_add_u32 s52, s52, 0
  s_add_u32 m0, s47, 147456
  s_nop 0
  buffer_load_dwordx4 v26, s[28:31], s53 offen lds
  s_add_u32 s53, s53, 0
  s_add_u32 m0, s47, 24576
  s_nop 0
  buffer_load_dwordx4 v26, s[24:27], s51 offen lds
  s_add_u32 s51, s51, 4096
  s_and_b32 s51, s51, 65535
  s_add_u32 m0, s55, 81920
  s_nop 0
  buffer_load_dwordx4 v10, s[20:23], s49 offen lds
  buffer_load_dwordx4 v11, s[20:23], s49 offen offset:1024 lds
  buffer_load_dwordx4 v12, s[20:23], s49 offen offset:2048 lds
  buffer_load_dwordx4 v13, s[20:23], s49 offen offset:3072 lds
  s_add_u32 s49, s49, 128
  s_and_b32 s49, s49, 2047
  s_branch L_ldkv
L_ldn:
  s_add_u32 m0, s46, 0
  s_nop 0
  buffer_load_dwordx4 v8, s[16:19], s48 offen lds
  buffer_load_dwordx4 v9, s[16:19], s48 offen offset:1024 lds
  s_add_u32 s48, s48, 131072
  s_and_b32 s48, s48, 2097151
  s_add_u32 m0, s55, 65536
  s_nop 0
  buffer_load_dwordx4 v10, s[20:23], s49 offen lds
  buffer_load_dwordx4 v11, s[20:23], s49 offen offset:1024 lds
  buffer_load_dwordx4 v12, s[20:23], s49 offen offset:2048 lds
  buffer_load_dwordx4 v13, s[20:23], s49 offen offset:3072 lds
  s_add_u32 s49, s49, 128
  s_and_b32 s49, s49, 2047
  s_add_u32 m0, s55, 131072
  s_nop 0
  buffer_load_dwordx4 v14, s[20:23], s52 offen lds
  buffer_load_dwordx4 v14, s[20:23], s52 offen offset:1024 lds
  buffer_load_dwordx4 v14, s[20:23], s52 offen offset:2048 lds
  buffer_load_dwordx4 v14, s[20:23], s52 offen offset:3072 lds
  s_add_u32 s52, s52, 0
  s_add_u32 m0, s47, 147456
  s_nop 0
  buffer_load_dwordx4 v26, s[28:31], s53 offen lds
  s_add_u32 s53, s53, 0
  s_add_u32 m0, s46, 16384
  s_nop 0
  buffer_load_dwordx4 v8, s[16:19], s48 offen lds
  buffer_load_dwordx4 v9, s[16:19], s48 offen offset:1024 lds
  s_add_u32 s48, s48, 131072
  s_and_b32 s48, s48, 2097151
  s_add_u32 m0, s55, 81920
  s_nop 0
  buffer_load_dwordx4 v10, s[20:23], s49 offen lds
  buffer_load_dwordx4 v11, s[20:23], s49 offen offset:1024 lds
  buffer_load_dwordx4 v12, s[20:23], s49 offen offset:2048 lds
  buffer_load_dwordx4 v13, s[20:23], s49 offen offset:3072 lds
  s_add_u32 s49, s49, 128
  s_and_b32 s49, s49, 2047
  s_lshl_b32 s62, s45, 7
  s_lshl_b32 s63, s44, 2
  v_lshrrev_b32 v4, 4, v2
  v_and_b32 v5, 15, v2
  v_lshlrev_b32 v16, 1, v4
  v_xor_b32 v5, v5, v16
  s_mov_b32 s60, 7168
  v_mul_lo_u32 v4, v4, s60
  s_mul_i32 s60, s3, 114688
  s_lshl_b32 s61, s62, 1
  s_add_u32 s60, s60, s61
  v_add_u32 v4, s60, v4
  v_lshl_add_u32 v16, v5, 4, v4
  v_xor_b32 v5, 8, v5
  v_lshl_add_u32 v4, v5, 4, v4
  v_add_u32 v17, 27648, v16
  v_add_u32 v18, 55296, v4
  v_add_u32 v19, 82944, v4
  s_add_u32 s60, s63, s3
  s_mul_i32 s60, s60, 131072
  v_lshlrev_b32 v20, 4, v2
  v_add_u32 v20, s60, v20
  s_mov_b32 s52, 0
  s_mov_b32 s53, 0
  s_cmp_lt_u32 s3, 2
  s_cselect_b32 s54, 0, 123904
  s_add_u32 s54, s54, s46
  s_mov_b32 s28, s12
  s_mov_b32 s29, s13
  s_mov_b32 s30, 14680064
  s_mov_b32 s31, 0x00020000
  s_mov_b32 s64, s38
  s_mov_b32 s65, s39
  s_mov_b32 s66, 4194304
  s_mov_b32 s67, 0x00020000
  s_add_u32 s68, s38, 4259840
  s_addc_u32 s69, s39, 0
  s_mov_b32 s70, 262144
  s_mov_b32 s71, 0x00020000
  s_mov_b32 s56, s36
  s_mov_b32 s57, s37
  s_mov_b32 s58, 256
  s_mov_b32 s59, 0x00020000
  s_add_u32 s32, s38, 4227072
  s_addc_u32 s33, s39, 0
  s_mov_b32 s34, 32768
  s_mov_b32 s35, 0x00020000
  v_mov_b32 v23, 0
  v_lshlrev_b32 v24, 7, v2
  v_and_b32 v25, 31, v2
  v_lshlrev_b32 v25, 7, v25
  v_add_u32 v25, 8192, v25
  s_mov_b32 s50, 2
Ln_LD0:
  s_waitcnt vmcnt(6)
  s_barrier
  s_add_u32 m0, s46, 32768
  s_nop 0
  buffer_load_dwordx4 v8, s[16:19], s48 offen lds
  buffer_load_dwordx4 v9, s[16:19], s48 offen offset:1024 lds
  s_add_u32 s48, s48, 131072
  s_and_b32 s48, s48, 2097151
  s_add_u32 m0, s55, 98304
  s_nop 0
  buffer_load_dwordx4 v10, s[20:23], s49 offen lds
  buffer_load_dwordx4 v11, s[20:23], s49 offen offset:1024 lds
  buffer_load_dwordx4 v12, s[20:23], s49 offen offset:2048 lds
  buffer_load_dwordx4 v13, s[20:23], s49 offen offset:3072 lds
  s_add_u32 s49, s49, 128
  s_and_b32 s49, s49, 2047
  s_waitcnt vmcnt(6)
  s_barrier
  s_add_u32 m0, s46, 49152
  s_nop 0
  buffer_load_dwordx4 v8, s[16:19], s48 offen lds
  buffer_load_dwordx4 v9, s[16:19], s48 offen offset:1024 lds
  s_add_u32 s48, s48, 131072
  s_and_b32 s48, s48, 2097151
  s_add_u32 m0, s55, 114688
  s_nop 0
  buffer_load_dwordx4 v10, s[20:23], s49 offen lds
  buffer_load_dwordx4 v11, s[20:23], s49 offen offset:1024 lds
  buffer_load_dwordx4 v12, s[20:23], s49 offen offset:2048 lds
  buffer_load_dwordx4 v13, s[20:23], s49 offen offset:3072 lds
  s_add_u32 s49, s49, 128
  s_and_b32 s49, s49, 2047
  s_waitcnt vmcnt(6)
  s_barrier
  s_add_u32 m0, s46, 0
  s_nop 0
  buffer_load_dwordx4 v8, s[16:19], s48 offen lds
  buffer_load_dwordx4 v9, s[16:19], s48 offen offset:1024 lds
  s_add_u32 s48, s48, 131072
  s_and_b32 s48, s48, 2097151
  s_add_u32 m0, s55, 65536
  s_nop 0
  buffer_load_dwordx4 v10, s[20:23], s49 offen lds
  buffer_load_dwordx4 v11, s[20:23], s49 offen offset:1024 lds
  buffer_load_dwordx4 v12, s[20:23], s49 offen offset:2048 lds
  buffer_load_dwordx4 v13, s[20:23], s49 offen offset:3072 lds
  s_add_u32 s49, s49, 128
  s_and_b32 s49, s49, 2047
  s_waitcnt vmcnt(6)
  s_barrier
  s_add_u32 m0, s46, 16384
  s_nop 0
  buffer_load_dwordx4 v8, s[16:19], s48 offen lds
  buffer_load_dwordx4 v9, s[16:19], s48 offen offset:1024 lds
  s_add_u32 s48, s48, 131072
  s_and_b32 s48, s48, 2097151
  s_add_u32 m0, s55, 81920
  s_nop 0
  buffer_load_dwordx4 v10, s[20:23], s49 offen lds
  buffer_load_dwordx4 v11, s[20:23], s49 offen offset:1024 lds
  buffer_load_dwordx4 v12, s[20:23], s49 offen offset:2048 lds
  buffer_load_dwordx4 v13, s[20:23], s49 offen offset:3072 lds
  s_add_u32 s49, s49, 128
  s_and_b32 s49, s49, 2047
  s_sub_u32 s50, s50, 1
  s_cmp_lg_u32 s50, 0
  s_cbranch_scc1 Ln_LD0
  s_waitcnt vmcnt(6)
  s_barrier
  v_mov_b32 v27, 163836
  ds_read_b32 v27, v27
  s_waitcnt lgkmcnt(0)
  s_add_u32 m0, s46, 32768
  s_nop 0
  buffer_load_dwordx4 v8, s[16:19], s48 offen lds
  buffer_load_dwordx4 v9, s[16:19], s48 offen offset:1024 lds
  s_add_u32 s48, s48, 131072
  s_and_b32 s48, s48, 2097151
  s_add_u32 m0, s55, 98304
  s_nop 0
  buffer_load_dwordx4 v10, s[20:23], s49 offen lds
  buffer_load_dwordx4 v11, s[20:23], s49 offen offset:1024 lds
  buffer_load_dwordx4 v12, s[20:23], s49 offen offset:2048 lds
  buffer_load_dwordx4 v13, s[20:23], s49 offen offset:3072 lds
  s_add_u32 s49, s49, 128
  s_and_b32 s49, s49, 2047
  s_waitcnt vmcnt(6)
  s_barrier
  s_add_u32 m0, s46, 49152
  s_nop 0
  buffer_load_dwordx4 v8, s[16:19], s48 offen lds
  buffer_load_dwordx4 v9, s[16:19], s48 offen offset:1024 lds
  s_add_u32 s48, s48, 131072
  s_and_b32 s48, s48, 2097151
  s_add_u32 m0, s55, 114688
  s_nop 0
  buffer_load_dwordx4 v10, s[20:23], s49 offen lds
  buffer_load_dwordx4 v11, s[20:23], s49 offen offset:1024 lds
  buffer_load_dwordx4 v12, s[20:23], s49 offen offset:2048 lds
  buffer_load_dwordx4 v13, s[20:23], s49 offen offset:3072 lds
  s_add_u32 s49, s49, 128
  s_and_b32 s49, s49, 2047
  s_waitcnt vmcnt(6)
  s_barrier
  s_add_u32 m0, s46, 0
  s_nop 0
  buffer_load_dwordx4 v8, s[16:19], s48 offen lds
  buffer_load_dwordx4 v9, s[16:19], s48 offen offset:1024 lds
  s_add_u32 s48, s48, 131072
  s_and_b32 s48, s48, 2097151
  s_add_u32 m0, s55, 65536
  s_nop 0
  buffer_load_dwordx4 v10, s[20:23], s49 offen lds
  buffer_load_dwordx4 v11, s[20:23], s49 offen offset:1024 lds
  buffer_load_dwordx4 v12, s[20:23], s49 offen offset:2048 lds
  buffer_load_dwordx4 v13, s[20:23], s49 offen offset:3072 lds
  s_add_u32 s49, s49, 128
  s_and_b32 s49, s49, 2047
  s_waitcnt vmcnt(6)
  s_barrier
  s_add_u32 m0, s46, 16384
  s_nop 0
  buffer_load_dwordx4 v8, s[16:19], s48 offen lds
  buffer_load_dwordx4 v9, s[16:19], s48 offen offset:1024 lds
  s_add_u32 s48, s48, 131072
  s_and_b32 s48, s48, 2097151
  s_add_u32 m0, s55, 81920
  s_nop 0
  buffer_load_dwordx4 v10, s[20:23], s49 offen lds
  buffer_load_dwordx4 v11, s[20:23], s49 offen offset:1024 lds
  buffer_load_dwordx4 v12, s[20:23], s49 offen offset:2048 lds
  buffer_load_dwordx4 v13, s[20:23], s49 offen offset:3072 lds
  s_add_u32 s49, s49, 128
  s_and_b32 s49, s49, 2047
  s_waitcnt vmcnt(6)
  s_barrier
  s_add_u32 m0, s46, 32768
  s_nop 0
  buffer_load_dwordx4 v8, s[16:19], s48 offen lds
  buffer_load_dwordx4 v9, s[16:19], s48 offen offset:1024 lds
  s_add_u32 s48, s48, 131072
  s_and_b32 s48, s48, 2097151
  s_add_u32 m0, s55, 98304
  s_nop 0
  buffer_load_dwordx4 v10, s[20:23], s49 offen lds
  buffer_load_dwordx4 v11, s[20:23], s49 offen offset:1024 lds
  buffer_load_dwordx4 v12, s[20:23], s49 offen offset:2048 lds
  buffer_load_dwordx4 v13, s[20:23], s49 offen offset:3072 lds
  s_add_u32 s49, s49, 128
  s_and_b32 s49, s49, 2047
  s_waitcnt vmcnt(6)
  s_barrier
  s_add_u32 m0, s46, 49152
  s_nop 0
  buffer_load_dwordx4 v8, s[16:19], s48 offen lds
  buffer_load_dwordx4 v9, s[16:19], s48 offen offset:1024 lds
  s_add_u32 s48, s48, 131072
  s_and_b32 s48, s48, 2097151
  s_add_u32 m0, s55, 114688
  s_nop 0
  buffer_load_dwordx4 v10, s[20:23], s49 offen lds
  buffer_load_dwordx4 v11, s[20:23], s49 offen offset:1024 lds
  buffer_load_dwordx4 v12, s[20:23], s49 offen offset:2048 lds
  buffer_load_dwordx4 v13, s[20:23], s49 offen offset:3072 lds
  s_add_u32 s49, s49, 128
  s_and_b32 s49, s49, 2047
  s_waitcnt vmcnt(6)
  s_barrier
  s_cmp_lg_u32 s3, 0
  s_cbranch_scc1 L_ahnA
  buffer_load_dwordx4 v[28:31], v24, s[32:35], 0 offen sc1
L_ahnA:
  s_add_u32 m0, s55, 16384
  s_nop 0
  buffer_load_dwordx4 v16, s[28:31], s52 offen lds
  buffer_load_dwordx4 v17, s[28:31], s52 offen offset:1024 lds
  buffer_load_dwordx4 v18, s[28:31], s52 offen offset:2048 lds
  buffer_load_dwordx4 v19, s[28:31], s52 offen offset:3072 lds
  s_add_u32 s52, s52, 458752
  s_waitcnt vmcnt(4)
  s_cmp_lg_u32 s3, 0
  s_cbranch_scc1 L_chnA
  s_mov_b32 s62, 0x40000
L_phnA:
  v_xor_b32 v28, v27, v28
  v_xor_b32 v29, v27, v29
  v_xor_b32 v30, v27, v30
  v_xor_b32 v31, v27, v31
  v_or3_b32 v28, v28, v29, v30
  v_or_b32 v28, v28, v31
  v_cmp_ne_u32 vcc, 0, v28
  s_nop 4
  s_cbranch_vccz L_chnA
  s_sleep 6
  buffer_load_dwordx4 v[28:31], v24, s[32:35], 0 offen sc1
  s_sub_u32 s62, s62, 1
  s_cmp_lg_u32 s62, 0
  s_waitcnt vmcnt(0)
  s_cbranch_scc1 L_phnA
L_chnA:
  s_barrier
  s_or_b32 s60, s2, s3
  s_cbranch_scc1 L_znA
  s_mov_b64 exec, 1
  buffer_store_dword v23, v23, s[56:59], 0 offen sc1
  s_mov_b64 exec, -1
L_znA:
  s_add_u32 m0, s55, 81920
  s_nop 0
  buffer_load_dwordx4 v20, s[64:67], s53 offen sc1 lds
  buffer_load_dwordx4 v20, s[64:67], s53 offen offset:1024 sc1 lds
  buffer_load_dwordx4 v20, s[64:67], s53 offen offset:2048 sc1 lds
  buffer_load_dwordx4 v20, s[64:67], s53 offen offset:3072 sc1 lds
  s_add_u32 s53, s53, 4096
  s_waitcnt vmcnt(8)
  s_barrier
  s_cmp_lg_u32 s3, 0
  s_cbranch_scc1 L_aknA
  buffer_load_dword v32, v25, s[32:35], 0 offen sc1
L_aknA:
  s_add_u32 m0, s55, 32768
  s_nop 0
  buffer_load_dwordx4 v16, s[28:31], s52 offen lds
  buffer_load_dwordx4 v17, s[28:31], s52 offen offset:1024 lds
  buffer_load_dwordx4 v18, s[28:31], s52 offen offset:2048 lds
  buffer_load_dwordx4 v19, s[28:31], s52 offen offset:3072 lds
  s_add_u32 s52, s52, 458752
  s_add_u32 m0, s55, 98304
  s_nop 0
  buffer_load_dwordx4 v20, s[64:67], s53 offen sc1 lds
  buffer_load_dwordx4 v20, s[64:67], s53 offen offset:1024 sc1 lds
  buffer_load_dwordx4 v20, s[64:67], s53 offen offset:2048 sc1 lds
  buffer_load_dwordx4 v20, s[64:67], s53 offen offset:3072 sc1 lds
  s_add_u32 s53, s53, 4096
  s_waitcnt vmcnt(8)
  s_cmp_lg_u32 s3, 0
  s_cbranch_scc1 L_cknA
  s_mov_b32 s62, 0x40000
L_pknA:
  v_cmp_ne_u32 vcc, v27, v32
  s_nop 4
  s_cbranch_vccz L_cknA
  s_sleep 6
  buffer_load_dword v32, v25, s[32:35], 0 offen sc1
  s_sub_u32 s62, s62, 1
  s_cmp_lg_u32 s62, 0
  s_waitcnt vmcnt(0)
  s_cbranch_scc1 L_pknA
L_cknA:
  s_barrier
  s_add_u32 m0, s46, 147456
  s_nop 0
  buffer_load_dwordx4 v3, s[68:71], s54 offen sc1 lds
  buffer_load_dwordx4 v3, s[68:71], s54 offen offset:1024 sc1 lds
  s_add_u32 s54, s54, 4096
  s_add_u32 m0, s46, 155648
  s_nop 0
  buffer_load_dwordx4 v3, s[68:71], s54 offen sc1 lds
  buffer_load_dwordx4 v3, s[68:71], s54 offen offset:1024 sc1 lds
  s_add_u32 s54, s54, 4096
  s_add_u32 m0, s55, 49152
  s_nop 0
  buffer_load_dwordx4 v16, s[28:31], s52 offen lds
  buffer_load_dwordx4 v17, s[28:31], s52 offen offset:1024 lds
  buffer_load_dwordx4 v18, s[28:31], s52 offen offset:2048 lds
  buffer_load_dwordx4 v19, s[28:31], s52 offen offset:3072 lds
  s_add_u32 s52, s52, 458752
  s_add_u32 m0, s55, 114688
  s_nop 0
  buffer_load_dwordx4 v20, s[64:67], s53 offen sc1 lds
  buffer_load_dwordx4 v20, s[64:67], s53 offen offset:1024 sc1 lds
  buffer_load_dwordx4 v20, s[64:67], s53 offen offset:2048 sc1 lds
  buffer_load_dwordx4 v20, s[64:67], s53 offen offset:3072 sc1 lds
  s_add_u32 s53, s53, 4096
  s_waitcnt vmcnt(10)
  s_barrier
  s_add_u32 m0, s46, 131072
  s_nop 0
  buffer_load_dwordx4 v3, s[68:71], s54 offen sc1 lds
  buffer_load_dwordx4 v3, s[68:71], s54 offen offset:1024 sc1 lds
  s_add_u32 s54, s54, 4096
  s_add_u32 m0, s55, 0
  s_nop 0
  buffer_load_dwordx4 v16, s[28:31], s52 offen lds
  buffer_load_dwordx4 v17, s[28:31], s52 offen offset:1024 lds
  buffer_load_dwordx4 v18, s[28:31], s52 offen offset:2048 lds
  buffer_load_dwordx4 v19, s[28:31], s52 offen offset:3072 lds
  s_add_u32 s52, s52, 458752
  s_add_u32 m0, s55, 65536
  s_nop 0
  buffer_load_dwordx4 v20, s[64:67], s53 offen sc1 lds
  buffer_load_dwordx4 v20, s[64:67], s53 offen offset:1024 sc1 lds
  buffer_load_dwordx4 v20, s[64:67], s53 offen offset:2048 sc1 lds
  buffer_load_dwordx4 v20, s[64:67], s53 offen offset:3072 sc1 lds
  s_add_u32 s53, s53, 4096
  s_waitcnt vmcnt(10)
  s_barrier
  s_add_u32 m0, s46, 139264
  s_nop 0
  buffer_load_dwordx4 v3, s[68:71], s54 offen sc1 lds
  buffer_load_dwordx4 v3, s[68:71], s54 offen offset:1024 sc1 lds
  s_add_u32 s54, s54, 4096
  s_add_u32 m0, s55, 16384
  s_nop 0
  buffer_load_dwordx4 v16, s[28:31], s52 offen lds
  buffer_load_dwordx4 v17, s[28:31], s52 offen offset:1024 lds
  buffer_load_dwordx4 v18, s[28:31], s52 offen offset:2048 lds
  buffer_load_dwordx4 v19, s[28:31], s52 offen offset:3072 lds
  s_add_u32 s52, s52, 458752
  s_add_u32 m0, s55, 81920
  s_nop 0
  buffer_load_dwordx4 v20, s[64:67], s53 offen sc1 lds
  buffer_load_dwordx4 v20, s[64:67], s53 offen offset:1024 sc1 lds
  buffer_load_dwordx4 v20, s[64:67], s53 offen offset:2048 sc1 lds
  buffer_load_dwordx4 v20, s[64:67], s53 offen offset:3072 sc1 lds
  s_add_u32 s53, s53, 4096
  s_waitcnt vmcnt(10)
  s_barrier
  s_lshl_b32 s8, s44, 3
  s_lshr_b32 s9, s45, 2
  s_add_u32 s8, s8, s9
  s_lshl_b32 s8, s8, 7
  s_and_b32 s9, s45, 3
  s_lshl_b32 s9, s9, 2
  s_add_u32 s8, s8, s9
  s_add_u32 s8, s8, 12288
  s_sub_u32 s9, s2, 224
  s_lshl_b32 s9, s9, 7
  s_add_u32 s9, s9, 8196
  s_cmp_lt_u32 s2, 224
  s_cselect_b32 s8, s8, s9
  s_lshl_b32 s9, s43, 7
  s_lshl_b32 s10, s42, 2
  s_add_u32 s9, s9, s10
  s_add_u32 s9, s9, 20480
  s_load_dwordx2 s[10:11], s[0:1], 64
  s_load_dwordx2 s[40:41], s[0:1], 32
  s_bfe_u32 s14, s2, 0x10002
  s_bfe_u32 s42, s2, 0x30003
  s_and_b32 s43, s2, 3
  s_lshl_b32 s43, s43, 2
  s_lshr_b32 s44, s2, 6
  s_add_u32 s43, s43, s44
  s_add_u32 s15, s42, s43
  s_add_u32 s15, s15, s14
  s_and_b32 s15, s15, 1
  s_mul_i32 s49, s15, 2
  s_lshl_b32 s44, s42, 7
  s_lshl_b32 s45, s43, 7
  s_lshl_b32 s62, s42, 2
  s_lshl_b32 s63, s43, 2
  s_add_u32 s60, s62, s3
  s_mul_i32 s60, s60, 229376
  v_lshlrev_b32 v8, 4, v2
  v_add_u32 v8, s60, v8
  v_lshrrev_b32 v4, 4, v2
  v_and_b32 v5, 15, v2
  v_lshlrev_b32 v10, 1, v4
  v_xor_b32 v5, v5, v10
  s_mov_b32 s60, 4096
  v_mul_lo_u32 v4, v4, s60
  s_mul_i32 s60, s3, 65536
  s_lshl_b32 s61, s45, 1
  s_add_u32 s60, s60, s61
  v_add_u32 v4, s60, v4
  v_lshl_add_u32 v10, v5, 4, v4
  v_xor_b32 v5, 8, v5
  v_lshl_add_u32 v4, v5, 4, v4
  v_add_u32 v11, 15360, v4
  v_add_u32 v12, 30720, v10
  v_add_u32 v13, 46080, v4
  v_lshrrev_b32 v4, 4, v2
  v_and_b32 v5, 15, v2
  v_lshlrev_b32 v36, 1, v4
  v_xor_b32 v5, v5, v36
  s_mov_b32 s60, 2048
  v_mul_lo_u32 v4, v4, s60
  s_mul_i32 s60, s3, 32768
  s_lshl_b32 s61, s44, 1
  s_add_u32 s60, s60, s61
  v_add_u32 v4, s60, v4
  v_lshl_add_u32 v36, v5, 4, v4
  v_xor_b32 v5, 8, v5
  v_lshl_add_u32 v4, v5, 4, v4
  v_add_u32 v37, 7168, v4
  v_add_u32 v38, 14336, v36
  v_add_u32 v39, 21504, v4
  s_add_u32 s60, s63, s3
  s_mul_i32 s60, s60, 65536
  v_lshlrev_b32 v9, 4, v2
  v_add_u32 v9, s60, v9
  s_lshl_b32 s60, s49, 2
  s_sub_u32 s48, 39, s60
  s_add_u32 s51, s60, 32
  s_cmp_eq_u32 s14, 0
  s_cselect_b32 s60, s48, s51
  s_cselect_b32 s13, -1, 1
  s_mul_i32 s48, s60, 4096
  s_mul_i32 s51, s60, 262144
  s_mul_i32 s12, s13, 4096
  s_mul_i32 s13, s13, 262144
  s_mov_b32 s47, 0
  s_mov_b32 s63, 0
  v_min_u32 v33, 6, v2
  v_lshlrev_b32 v33, 7, v33
  s_lshl_b32 s60, s42, 10
  s_add_u32 s60, s60, 12288
  v_add_u32 v33, s60, v33
  v_and_b32 v34, 15, v2
  v_lshlrev_b32 v34, 2, v34
  s_lshl_b32 s60, s43, 7
  s_add_u32 s60, s60, 20480
  v_add_u32 v34, s60, v34
  s_waitcnt lgkmcnt(0)
  s_add_u32 s16, s38, 16777216
  s_addc_u32 s17, s39, 0
  s_mov_b32 s18, 7340032
  s_mov_b32 s19, 0x00020000
  s_mov_b32 s20, s10
  s_mov_b32 s21, s11
  s_mov_b32 s22, 14680064
  s_mov_b32 s23, 0x00020000
  s_mov_b32 s24, s40
  s_mov_b32 s25, s41
  s_mov_b32 s26, 2097152
  s_mov_b32 s27, 0x00020000
  s_add_u32 s4, s38, 12582912
  s_addc_u32 s5, s39, 0
  s_mov_b32 s6, 4194304
  s_mov_b32 s7, 0x00020000
  s_add_u32 m0, s46, 147456
  s_nop 0
  buffer_load_dwordx4 v3, s[68:71], s54 offen sc1 lds
  buffer_load_dwordx4 v3, s[68:71], s54 offen offset:1024 sc1 lds
  s_add_u32 s54, s54, 4096
  s_add_u32 m0, s55, 32768
  s_nop 0
  buffer_load_dwordx4 v16, s[28:31], s52 offen lds
  buffer_load_dwordx4 v17, s[28:31], s52 offen offset:1024 lds
  buffer_load_dwordx4 v18, s[28:31], s52 offen offset:2048 lds
  buffer_load_dwordx4 v19, s[28:31], s52 offen offset:3072 lds
  s_add_u32 s52, s52, 458752
  s_add_u32 m0, s55, 98304
  s_nop 0
  buffer_load_dwordx4 v20, s[64:67], s53 offen sc1 lds
  buffer_load_dwordx4 v20, s[64:67], s53 offen offset:1024 sc1 lds
  buffer_load_dwordx4 v20, s[64:67], s53 offen offset:2048 sc1 lds
  buffer_load_dwordx4 v20, s[64:67], s53 offen offset:3072 sc1 lds
  s_add_u32 s53, s53, 4096
  s_waitcnt vmcnt(10)
  s_barrier
  s_add_u32 m0, s46, 155648
  s_nop 0
  buffer_load_dwordx4 v3, s[68:71], s54 offen sc1 lds
  buffer_load_dwordx4 v3, s[68:71], s54 offen offset:1024 sc1 lds
  s_add_u32 s54, s54, 4096
  s_add_u32 m0, s55, 49152
  s_nop 0
  buffer_load_dwordx4 v16, s[28:31], s52 offen lds
  buffer_load_dwordx4 v17, s[28:31], s52 offen offset:1024 lds
  buffer_load_dwordx4 v18, s[28:31], s52 offen offset:2048 lds
  buffer_load_dwordx4 v19, s[28:31], s52 offen offset:3072 lds
  s_add_u32 s52, s52, 458752
  s_add_u32 m0, s55, 114688
  s_nop 0
  buffer_load_dwordx4 v20, s[64:67], s53 offen sc1 lds
  buffer_load_dwordx4 v20, s[64:67], s53 offen offset:1024 sc1 lds
  buffer_load_dwordx4 v20, s[64:67], s53 offen offset:2048 sc1 lds
  buffer_load_dwordx4 v20, s[64:67], s53 offen offset:3072 sc1 lds
  s_add_u32 s53, s53, 4096
  s_add_u32 m0, s46, 131072
  s_nop 0
  buffer_load_dwordx4 v3, s[68:71], s54 offen sc1 lds
  buffer_load_dwordx4 v3, s[68:71], s54 offen offset:1024 sc1 lds
  s_add_u32 s54, s54, 4096
  s_add_u32 m0, s55, 0
  s_nop 0
  buffer_load_dwordx4 v16, s[28:31], s52 offen lds
  buffer_load_dwordx4 v17, s[28:31], s52 offen offset:1024 lds
  buffer_load_dwordx4 v18, s[28:31], s52 offen offset:2048 lds
  buffer_load_dwordx4 v19, s[28:31], s52 offen offset:3072 lds
  s_add_u32 s52, s52, 458752
  s_add_u32 m0, s55, 65536
  s_nop 0
  buffer_load_dwordx4 v20, s[64:67], s53 offen sc1 lds
  buffer_load_dwordx4 v20, s[64:67], s53 offen offset:1024 sc1 lds
  buffer_load_dwordx4 v20, s[64:67], s53 offen offset:2048 sc1 lds
  buffer_load_dwordx4 v20, s[64:67], s53 offen offset:3072 sc1 lds
  s_add_u32 s53, s53, 4096
  s_waitcnt vmcnt(20)
  s_barrier
  s_add_u32 m0, s46, 139264
  s_nop 0
  buffer_load_dwordx4 v3, s[68:71], s54 offen sc1 lds
  buffer_load_dwordx4 v3, s[68:71], s54 offen offset:1024 sc1 lds
  s_add_u32 s54, s54, 4096
  s_add_u32 m0, s55, 16384
  s_nop 0
  buffer_load_dwordx4 v16, s[28:31], s52 offen lds
  buffer_load_dwordx4 v17, s[28:31], s52 offen offset:1024 lds
  buffer_load_dwordx4 v18, s[28:31], s52 offen offset:2048 lds
  buffer_load_dwordx4 v19, s[28:31], s52 offen offset:3072 lds
  s_add_u32 s52, s52, 458752
  s_add_u32 m0, s55, 81920
  s_nop 0
  buffer_load_dwordx4 v20, s[64:67], s53 offen sc1 lds
  buffer_load_dwordx4 v20, s[64:67], s53 offen offset:1024 sc1 lds
  buffer_load_dwordx4 v20, s[64:67], s53 offen offset:2048 sc1 lds
  buffer_load_dwordx4 v20, s[64:67], s53 offen offset:3072 sc1 lds
  s_add_u32 s53, s53, 4096
  s_waitcnt vmcnt(20)
  s_barrier
  s_add_u32 m0, s46, 147456
  s_nop 0
  buffer_load_dwordx4 v3, s[68:71], s54 offen sc1 lds
  buffer_load_dwordx4 v3, s[68:71], s54 offen offset:1024 sc1 lds
  s_add_u32 s54, s54, 4096
  s_add_u32 m0, s55, 32768
  s_nop 0
  buffer_load_dwordx4 v16, s[28:31], s52 offen lds
  buffer_load_dwordx4 v17, s[28:31], s52 offen offset:1024 lds
  buffer_load_dwordx4 v18, s[28:31], s52 offen offset:2048 lds
  buffer_load_dwordx4 v19, s[28:31], s52 offen offset:3072 lds
  s_add_u32 s52, s52, 458752
  s_add_u32 m0, s55, 98304
  s_nop 0
  buffer_load_dwordx4 v20, s[64:67], s53 offen sc1 lds
  buffer_load_dwordx4 v20, s[64:67], s53 offen offset:1024 sc1 lds
  buffer_load_dwordx4 v20, s[64:67], s53 offen offset:2048 sc1 lds
  buffer_load_dwordx4 v20, s[64:67], s53 offen offset:3072 sc1 lds
  s_add_u32 s53, s53, 4096
  s_waitcnt vmcnt(20)
  s_barrier
  s_add_u32 m0, s46, 155648
  s_nop 0
  buffer_load_dwordx4 v3, s[68:71], s54 offen sc1 lds
  buffer_load_dwordx4 v3, s[68:71], s54 offen offset:1024 sc1 lds
  s_add_u32 s54, s54, 4096
  s_add_u32 m0, s55, 49152
  s_nop 0
  buffer_load_dwordx4 v16, s[28:31], s52 offen lds
  buffer_load_dwordx4 v17, s[28:31], s52 offen offset:1024 lds
  buffer_load_dwordx4 v18, s[28:31], s52 offen offset:2048 lds
  buffer_load_dwordx4 v19, s[28:31], s52 offen offset:3072 lds
  s_add_u32 s52, s52, 458752
  s_add_u32 m0, s55, 114688
  s_nop 0
  buffer_load_dwordx4 v20, s[64:67], s53 offen sc1 lds
  buffer_load_dwordx4 v20, s[64:67], s53 offen offset:1024 sc1 lds
  buffer_load_dwordx4 v20, s[64:67], s53 offen offset:2048 sc1 lds
  buffer_load_dwordx4 v20, s[64:67], s53 offen offset:3072 sc1 lds
  s_add_u32 s53, s53, 4096
  s_waitcnt vmcnt(20)
  s_barrier
  s_add_u32 m0, s55, 0
  s_nop 0
  buffer_load_dwordx4 v16, s[28:31], s52 offen lds
  buffer_load_dwordx4 v17, s[28:31], s52 offen offset:1024 lds
  buffer_load_dwordx4 v18, s[28:31], s52 offen offset:2048 lds
  buffer_load_dwordx4 v19, s[28:31], s52 offen offset:3072 lds
  s_add_u32 s52, s52, 458752
  s_add_u32 m0, s55, 65536
  s_nop 0
  buffer_load_dwordx4 v20, s[64:67], s53 offen sc1 lds
  buffer_load_dwordx4 v20, s[64:67], s53 offen offset:1024 sc1 lds
  buffer_load_dwordx4 v20, s[64:67], s53 offen offset:2048 sc1 lds
  buffer_load_dwordx4 v20, s[64:67], s53 offen offset:3072 sc1 lds
  s_add_u32 s53, s53, 4096
  s_waitcnt vmcnt(18)
  s_barrier
  s_add_u32 m0, s46, 131072
  s_nop 0
  buffer_load_dwordx4 v3, s[68:71], s54 offen sc1 lds
  buffer_load_dwordx4 v3, s[68:71], s54 offen offset:1024 sc1 lds
  s_add_u32 s54, s54, 4096
  s_add_u32 m0, s55, 16384
  s_nop 0
  buffer_load_dwordx4 v16, s[28:31], s52 offen lds
  buffer_load_dwordx4 v17, s[28:31], s52 offen offset:1024 lds
  buffer_load_dwordx4 v18, s[28:31], s52 offen offset:2048 lds
  buffer_load_dwordx4 v19, s[28:31], s52 offen offset:3072 lds
  s_add_u32 s52, s52, 458752
  s_add_u32 m0, s55, 81920
  s_nop 0
  buffer_load_dwordx4 v20, s[64:67], s53 offen sc1 lds
  buffer_load_dwordx4 v20, s[64:67], s53 offen offset:1024 sc1 lds
  buffer_load_dwordx4 v20, s[64:67], s53 offen offset:2048 sc1 lds
  buffer_load_dwordx4 v20, s[64:67], s53 offen offset:3072 sc1 lds
  s_add_u32 s53, s53, 4096
  s_waitcnt vmcnt(18)
  s_barrier
  s_add_u32 m0, s55, 32768
  s_nop 0
  buffer_load_dwordx4 v16, s[28:31], s52 offen lds
  buffer_load_dwordx4 v17, s[28:31], s52 offen offset:1024 lds
  buffer_load_dwordx4 v18, s[28:31], s52 offen offset:2048 lds
  buffer_load_dwordx4 v19, s[28:31], s52 offen offset:3072 lds
  s_add_u32 s52, s52, 458752
  s_add_u32 m0, s55, 98304
  s_nop 0
  buffer_load_dwordx4 v20, s[64:67], s53 offen sc1 lds
  buffer_load_dwordx4 v20, s[64:67], s53 offen offset:1024 sc1 lds
  buffer_load_dwordx4 v20, s[64:67], s53 offen offset:2048 sc1 lds
  buffer_load_dwordx4 v20, s[64:67], s53 offen offset:3072 sc1 lds
  s_add_u32 s53, s53, 4096
  s_waitcnt vmcnt(18)
  s_barrier
  s_add_u32 m0, s46, 139264
  s_nop 0
  buffer_load_dwordx4 v3, s[68:71], s54 offen sc1 lds
  buffer_load_dwordx4 v3, s[68:71], s54 offen offset:1024 sc1 lds
  s_add_u32 s54, s54, 4096
  s_add_u32 m0, s55, 49152
  s_nop 0
  buffer_load_dwordx4 v16, s[28:31], s52 offen lds
  buffer_load_dwordx4 v17, s[28:31], s52 offen offset:1024 lds
  buffer_load_dwordx4 v18, s[28:31], s52 offen offset:2048 lds
  buffer_load_dwordx4 v19, s[28:31], s52 offen offset:3072 lds
  s_add_u32 s52, s52, 458752
  s_add_u32 m0, s55, 114688
  s_nop 0
  buffer_load_dwordx4 v20, s[64:67], s53 offen sc1 lds
  buffer_load_dwordx4 v20, s[64:67], s53 offen offset:1024 sc1 lds
  buffer_load_dwordx4 v20, s[64:67], s53 offen offset:2048 sc1 lds
  buffer_load_dwordx4 v20, s[64:67], s53 offen offset:3072 sc1 lds
  s_add_u32 s53, s53, 4096
  s_waitcnt vmcnt(18)
  s_barrier
  s_add_u32 m0, s55, 0
  s_nop 0
  buffer_load_dwordx4 v16, s[28:31], s52 offen lds
  buffer_load_dwordx4 v17, s[28:31], s52 offen offset:1024 lds
  buffer_load_dwordx4 v18, s[28:31], s52 offen offset:2048 lds
  buffer_load_dwordx4 v19, s[28:31], s52 offen offset:3072 lds
  s_add_u32 s52, s52, 458752
  s_add_u32 m0, s55, 65536
  s_nop 0
  buffer_load_dwordx4 v20, s[64:67], s53 offen sc1 lds
  buffer_load_dwordx4 v20, s[64:67], s53 offen offset:1024 sc1 lds
  buffer_load_dwordx4 v20, s[64:67], s53 offen offset:2048 sc1 lds
  buffer_load_dwordx4 v20, s[64:67], s53 offen offset:3072 sc1 lds
  s_add_u32 s53, s53, 4096
  s_waitcnt vmcnt(18)
  s_barrier
  s_add_u32 m0, s46, 147456
  s_nop 0
  buffer_load_dwordx4 v3, s[68:71], s54 offen sc1 lds
  buffer_load_dwordx4 v3, s[68:71], s54 offen offset:1024 sc1 lds
  s_add_u32 s54, s54, 4096
  s_add_u32 m0, s55, 16384
  s_nop 0
  buffer_load_dwordx4 v16, s[28:31], s52 offen lds
  buffer_load_dwordx4 v17, s[28:31], s52 offen offset:1024 lds
  buffer_load_dwordx4 v18, s[28:31], s52 offen offset:2048 lds
  buffer_load_dwordx4 v19, s[28:31], s52 offen offset:3072 lds
  s_add_u32 s52, s52, 458752
  s_add_u32 m0, s55, 81920
  s_nop 0
  buffer_load_dwordx4 v20, s[64:67], s53 offen sc1 lds
  buffer_load_dwordx4 v20, s[64:67], s53 offen offset:1024 sc1 lds
  buffer_load_dwordx4 v20, s[64:67], s53 offen offset:2048 sc1 lds
  buffer_load_dwordx4 v20, s[64:67], s53 offen offset:3072 sc1 lds
  s_add_u32 s53, s53, 4096
  s_waitcnt vmcnt(18)
  s_barrier
  s_add_u32 m0, s55, 32768
  s_nop 0
  buffer_load_dwordx4 v16, s[28:31], s52 offen lds
  buffer_load_dwordx4 v17, s[28:31], s52 offen offset:1024 lds
  buffer_load_dwordx4 v18, s[28:31], s52 offen offset:2048 lds
  buffer_load_dwordx4 v19, s[28:31], s52 offen offset:3072 lds
  s_add_u32 s52, s52, 458752
  s_add_u32 m0, s55, 98304
  s_nop 0
  buffer_load_dwordx4 v20, s[64:67], s53 offen sc1 lds
  buffer_load_dwordx4 v20, s[64:67], s53 offen offset:1024 sc1 lds
  buffer_load_dwordx4 v20, s[64:67], s53 offen offset:2048 sc1 lds
  buffer_load_dwordx4 v20, s[64:67], s53 offen offset:3072 sc1 lds
  s_add_u32 s53, s53, 4096
  s_waitcnt vmcnt(18)
  s_barrier
  s_add_u32 m0, s46, 155648
  s_nop 0
  buffer_load_dwordx4 v3, s[68:71], s54 offen sc1 lds
  buffer_load_dwordx4 v3, s[68:71], s54 offen offset:1024 sc1 lds
  s_add_u32 s54, s54, 4096
  s_add_u32 m0, s55, 49152
  s_nop 0
  buffer_load_dwordx4 v16, s[28:31], s52 offen lds
  buffer_load_dwordx4 v17, s[28:31], s52 offen offset:1024 lds
  buffer_load_dwordx4 v18, s[28:31], s52 offen offset:2048 lds
  buffer_load_dwordx4 v19, s[28:31], s52 offen offset:3072 lds
  s_add_u32 s52, s52, 458752
  s_add_u32 m0, s55, 114688
  s_nop 0
  buffer_load_dwordx4 v20, s[64:67], s53 offen sc1 lds
  buffer_load_dwordx4 v20, s[64:67], s53 offen offset:1024 sc1 lds
  buffer_load_dwordx4 v20, s[64:67], s53 offen offset:2048 sc1 lds
  buffer_load_dwordx4 v20, s[64:67], s53 offen offset:3072 sc1 lds
  s_add_u32 s53, s53, 4096
  s_waitcnt vmcnt(18)
  s_barrier
  s_add_u32 m0, s55, 0
  s_nop 0
  buffer_load_dwordx4 v16, s[28:31], s52 offen lds
  buffer_load_dwordx4 v17, s[28:31], s52 offen offset:1024 lds
  buffer_load_dwordx4 v18, s[28:31], s52 offen offset:2048 lds
  buffer_load_dwordx4 v19, s[28:31], s52 offen offset:3072 lds
  s_add_u32 s52, s52, 458752
  s_add_u32 m0, s55, 65536
  s_nop 0
  buffer_load_dwordx4 v20, s[64:67], s53 offen sc1 lds
  buffer_load_dwordx4 v20, s[64:67], s53 offen offset:1024 sc1 lds
  buffer_load_dwordx4 v20, s[64:67], s53 offen offset:2048 sc1 lds
  buffer_load_dwordx4 v20, s[64:67], s53 offen offset:3072 sc1 lds
  s_add_u32 s53, s53, 4096
  s_waitcnt vmcnt(18)
  s_barrier
  s_add_u32 m0, s46, 131072
  s_nop 0
  buffer_load_dwordx4 v3, s[68:71], s54 offen sc1 lds
  buffer_load_dwordx4 v3, s[68:71], s54 offen offset:1024 sc1 lds
  s_add_u32 s54, s54, 4096
  s_add_u32 m0, s55, 16384
  s_nop 0
  buffer_load_dwordx4 v16, s[28:31], s52 offen lds
  buffer_load_dwordx4 v17, s[28:31], s52 offen offset:1024 lds
  buffer_load_dwordx4 v18, s[28:31], s52 offen offset:2048 lds
  buffer_load_dwordx4 v19, s[28:31], s52 offen offset:3072 lds
  s_add_u32 s52, s52, 458752
  s_add_u32 m0, s55, 81920
  s_nop 0
  buffer_load_dwordx4 v20, s[64:67], s53 offen sc1 lds
  buffer_load_dwordx4 v20, s[64:67], s53 offen offset:1024 sc1 lds
  buffer_load_dwordx4 v20, s[64:67], s53 offen offset:2048 sc1 lds
  buffer_load_dwordx4 v20, s[64:67], s53 offen offset:3072 sc1 lds
  s_add_u32 s53, s53, 4096
  s_waitcnt vmcnt(18)
  s_barrier
  s_add_u32 m0, s55, 32768
  s_nop 0
  buffer_load_dwordx4 v16, s[28:31], s52 offen lds
  buffer_load_dwordx4 v17, s[28:31], s52 offen offset:1024 lds
  buffer_load_dwordx4 v18, s[28:31], s52 offen offset:2048 lds
  buffer_load_dwordx4 v19, s[28:31], s52 offen offset:3072 lds
  s_add_u32 s52, s52, 458752
  s_add_u32 m0, s55, 98304
  s_nop 0
  buffer_load_dwordx4 v20, s[64:67], s53 offen sc1 lds
  buffer_load_dwordx4 v20, s[64:67], s53 offen offset:1024 sc1 lds
  buffer_load_dwordx4 v20, s[64:67], s53 offen offset:2048 sc1 lds
  buffer_load_dwordx4 v20, s[64:67], s53 offen offset:3072 sc1 lds
  s_add_u32 s53, s53, 4096
  s_waitcnt vmcnt(18)
  s_barrier
  s_add_u32 m0, s46, 139264
  s_nop 0
  buffer_load_dwordx4 v3, s[68:71], s54 offen sc1 lds
  buffer_load_dwordx4 v3, s[68:71], s54 offen offset:1024 sc1 lds
  s_add_u32 s54, s54, 4096
  s_add_u32 m0, s55, 49152
  s_nop 0
  buffer_load_dwordx4 v16, s[28:31], s52 offen lds
  buffer_load_dwordx4 v17, s[28:31], s52 offen offset:1024 lds
  buffer_load_dwordx4 v18, s[28:31], s52 offen offset:2048 lds
  buffer_load_dwordx4 v19, s[28:31], s52 offen offset:3072 lds
  s_add_u32 s52, s52, 458752
  s_add_u32 m0, s55, 114688
  s_nop 0
  buffer_load_dwordx4 v20, s[64:67], s53 offen sc1 lds
  buffer_load_dwordx4 v20, s[64:67], s53 offen offset:1024 sc1 lds
  buffer_load_dwordx4 v20, s[64:67], s53 offen offset:2048 sc1 lds
  buffer_load_dwordx4 v20, s[64:67], s53 offen offset:3072 sc1 lds
  s_add_u32 s53, s53, 4096
  s_waitcnt vmcnt(18)
  s_barrier
  s_add_u32 m0, s55, 0
  s_nop 0
  buffer_load_dwordx4 v16, s[28:31], s52 offen lds
  buffer_load_dwordx4 v17, s[28:31], s52 offen offset:1024 lds
  buffer_load_dwordx4 v18, s[28:31], s52 offen offset:2048 lds
  buffer_load_dwordx4 v19, s[28:31], s52 offen offset:3072 lds
  s_add_u32 s52, s52, 458752
  s_add_u32 m0, s55, 65536
  s_nop 0
  buffer_load_dwordx4 v20, s[64:67], s53 offen sc1 lds
  buffer_load_dwordx4 v20, s[64:67], s53 offen offset:1024 sc1 lds
  buffer_load_dwordx4 v20, s[64:67], s53 offen offset:2048 sc1 lds
  buffer_load_dwordx4 v20, s[64:67], s53 offen offset:3072 sc1 lds
  s_add_u32 s53, s53, 4096
  s_waitcnt vmcnt(18)
  s_barrier
  s_add_u32 m0, s46, 147456
  s_nop 0
  buffer_load_dwordx4 v3, s[68:71], s54 offen sc1 lds
  buffer_load_dwordx4 v3, s[68:71], s54 offen offset:1024 sc1 lds
  s_add_u32 s54, s54, 4096
  s_add_u32 m0, s55, 16384
  s_nop 0
  buffer_load_dwordx4 v16, s[28:31], s52 offen lds
  buffer_load_dwordx4 v17, s[28:31], s52 offen offset:1024 lds
  buffer_load_dwordx4 v18, s[28:31], s52 offen offset:2048 lds
  buffer_load_dwordx4 v19, s[28:31], s52 offen offset:3072 lds
  s_add_u32 s52, s52, 458752
  s_add_u32 m0, s55, 81920
  s_nop 0
  buffer_load_dwordx4 v20, s[64:67], s53 offen sc1 lds
  buffer_load_dwordx4 v20, s[64:67], s53 offen offset:1024 sc1 lds
  buffer_load_dwordx4 v20, s[64:67], s53 offen offset:2048 sc1 lds
  buffer_load_dwordx4 v20, s[64:67], s53 offen offset:3072 sc1 lds
  s_add_u32 s53, s53, 4096
  s_waitcnt vmcnt(18)
  s_barrier
  s_add_u32 m0, s55, 32768
  s_nop 0
  buffer_load_dwordx4 v16, s[28:31], s52 offen lds
  buffer_load_dwordx4 v17, s[28:31], s52 offen offset:1024 lds
  buffer_load_dwordx4 v18, s[28:31], s52 offen offset:2048 lds
  buffer_load_dwordx4 v19, s[28:31], s52 offen offset:3072 lds
  s_add_u32 s52, s52, 458752
  s_add_u32 m0, s55, 98304
  s_nop 0
  buffer_load_dwordx4 v20, s[64:67], s53 offen sc1 lds
  buffer_load_dwordx4 v20, s[64:67], s53 offen offset:1024 sc1 lds
  buffer_load_dwordx4 v20, s[64:67], s53 offen offset:2048 sc1 lds
  buffer_load_dwordx4 v20, s[64:67], s53 offen offset:3072 sc1 lds
  s_add_u32 s53, s53, 4096
  s_waitcnt vmcnt(18)
  s_barrier
  s_add_u32 m0, s46, 155648
  s_nop 0
  buffer_load_dwordx4 v3, s[68:71], s54 offen sc1 lds
  buffer_load_dwordx4 v3, s[68:71], s54 offen offset:1024 sc1 lds
  s_add_u32 s54, s54, 4096
  s_add_u32 m0, s55, 49152
  s_nop 0
  buffer_load_dwordx4 v16, s[28:31], s52 offen lds
  buffer_load_dwordx4 v17, s[28:31], s52 offen offset:1024 lds
  buffer_load_dwordx4 v18, s[28:31], s52 offen offset:2048 lds
  buffer_load_dwordx4 v19, s[28:31], s52 offen offset:3072 lds
  s_add_u32 s52, s52, 458752
  s_add_u32 m0, s55, 114688
  s_nop 0
  buffer_load_dwordx4 v20, s[64:67], s53 offen sc1 lds
  buffer_load_dwordx4 v20, s[64:67], s53 offen offset:1024 sc1 lds
  buffer_load_dwordx4 v20, s[64:67], s53 offen offset:2048 sc1 lds
  buffer_load_dwordx4 v20, s[64:67], s53 offen offset:3072 sc1 lds
  s_add_u32 s53, s53, 4096
  s_waitcnt vmcnt(18)
  s_barrier
  s_add_u32 m0, s46, 131072
  s_nop 0
  buffer_load_dwordx4 v3, s[68:71], s54 offen sc1 lds
  buffer_load_dwordx4 v3, s[68:71], s54 offen offset:1024 sc1 lds
  s_add_u32 s54, s54, 4096
  s_add_u32 m0, s55, 0
  s_nop 0
  buffer_load_dwordx4 v16, s[28:31], s52 offen lds
  buffer_load_dwordx4 v17, s[28:31], s52 offen offset:1024 lds
  buffer_load_dwordx4 v18, s[28:31], s52 offen offset:2048 lds
  buffer_load_dwordx4 v19, s[28:31], s52 offen offset:3072 lds
  s_add_u32 s52, s52, 458752
  s_add_u32 m0, s55, 65536
  s_nop 0
  buffer_load_dwordx4 v20, s[64:67], s53 offen sc1 lds
  buffer_load_dwordx4 v20, s[64:67], s53 offen offset:1024 sc1 lds
  buffer_load_dwordx4 v20, s[64:67], s53 offen offset:2048 sc1 lds
  buffer_load_dwordx4 v20, s[64:67], s53 offen offset:3072 sc1 lds
  s_add_u32 s53, s53, 4096
  s_waitcnt vmcnt(20)
  s_barrier
  s_add_u32 m0, s46, 139264
  s_nop 0
  buffer_load_dwordx4 v3, s[68:71], s54 offen sc1 lds
  buffer_load_dwordx4 v3, s[68:71], s54 offen offset:1024 sc1 lds
  s_add_u32 s54, s54, 4096
  s_add_u32 m0, s55, 16384
  s_nop 0
  buffer_load_dwordx4 v16, s[28:31], s52 offen lds
  buffer_load_dwordx4 v17, s[28:31], s52 offen offset:1024 lds
  buffer_load_dwordx4 v18, s[28:31], s52 offen offset:2048 lds
  buffer_load_dwordx4 v19, s[28:31], s52 offen offset:3072 lds
  s_add_u32 s52, s52, 458752
  s_add_u32 m0, s55, 81920
  s_nop 0
  buffer_load_dwordx4 v20, s[64:67], s53 offen sc1 lds
  buffer_load_dwordx4 v20, s[64:67], s53 offen offset:1024 sc1 lds
  buffer_load_dwordx4 v20, s[64:67], s53 offen offset:2048 sc1 lds
  buffer_load_dwordx4 v20, s[64:67], s53 offen offset:3072 sc1 lds
  s_add_u32 s53, s53, 4096
  s_waitcnt vmcnt(20)
  s_barrier
  s_add_u32 m0, s46, 147456
  s_nop 0
  buffer_load_dwordx4 v3, s[68:71], s54 offen sc1 lds
  buffer_load_dwordx4 v3, s[68:71], s54 offen offset:1024 sc1 lds
  s_add_u32 s54, s54, 4096
  s_add_u32 m0, s55, 32768
  s_nop 0
  buffer_load_dwordx4 v16, s[28:31], s52 offen lds
  buffer_load_dwordx4 v17, s[28:31], s52 offen offset:1024 lds
  buffer_load_dwordx4 v18, s[28:31], s52 offen offset:2048 lds
  buffer_load_dwordx4 v19, s[28:31], s52 offen offset:3072 lds
  s_add_u32 s52, s52, 458752
  s_add_u32 m0, s55, 98304
  s_nop 0
  buffer_load_dwordx4 v20, s[64:67], s53 offen sc1 lds
  buffer_load_dwordx4 v20, s[64:67], s53 offen offset:1024 sc1 lds
  buffer_load_dwordx4 v20, s[64:67], s53 offen offset:2048 sc1 lds
  buffer_load_dwordx4 v20, s[64:67], s53 offen offset:3072 sc1 lds
  s_add_u32 s53, s53, 4096
  s_waitcnt vmcnt(20)
  s_barrier
  s_add_u32 m0, s46, 155648
  s_nop 0
  buffer_load_dwordx4 v3, s[68:71], s54 offen sc1 lds
  buffer_load_dwordx4 v3, s[68:71], s54 offen offset:1024 sc1 lds
  s_add_u32 s54, s54, 4096
  s_add_u32 m0, s55, 49152
  s_nop 0
  buffer_load_dwordx4 v16, s[28:31], s52 offen lds
  buffer_load_dwordx4 v17, s[28:31], s52 offen offset:1024 lds
  buffer_load_dwordx4 v18, s[28:31], s52 offen offset:2048 lds
  buffer_load_dwordx4 v19, s[28:31], s52 offen offset:3072 lds
  s_add_u32 s52, s52, 458752
  s_add_u32 m0, s55, 114688
  s_nop 0
  buffer_load_dwordx4 v20, s[64:67], s53 offen sc1 lds
  buffer_load_dwordx4 v20, s[64:67], s53 offen offset:1024 sc1 lds
  buffer_load_dwordx4 v20, s[64:67], s53 offen offset:2048 sc1 lds
  buffer_load_dwordx4 v20, s[64:67], s53 offen offset:3072 sc1 lds
  s_add_u32 s53, s53, 4096
  s_waitcnt vmcnt(20)
  s_barrier
  s_add_u32 m0, s46, 131072
  s_nop 0
  buffer_load_dwordx4 v3, s[68:71], s54 offen sc1 lds
  buffer_load_dwordx4 v3, s[68:71], s54 offen offset:1024 sc1 lds
  s_add_u32 s54, s54, 4096
  s_add_u32 m0, s55, 0
  s_nop 0
  buffer_load_dwordx4 v16, s[28:31], s52 offen lds
  buffer_load_dwordx4 v17, s[28:31], s52 offen offset:1024 lds
  buffer_load_dwordx4 v18, s[28:31], s52 offen offset:2048 lds
  buffer_load_dwordx4 v19, s[28:31], s52 offen offset:3072 lds
  s_add_u32 s52, s52, 458752
  s_add_u32 m0, s55, 65536
  s_nop 0
  buffer_load_dwordx4 v20, s[64:67], s53 offen sc1 lds
  buffer_load_dwordx4 v20, s[64:67], s53 offen offset:1024 sc1 lds
  buffer_load_dwordx4 v20, s[64:67], s53 offen offset:2048 sc1 lds
  buffer_load_dwordx4 v20, s[64:67], s53 offen offset:3072 sc1 lds
  s_add_u32 s53, s53, 4096
  s_waitcnt vmcnt(20)
  s_barrier
  s_add_u32 m0, s46, 139264
  s_nop 0
  buffer_load_dwordx4 v3, s[68:71], s54 offen sc1 lds
  buffer_load_dwordx4 v3, s[68:71], s54 offen offset:1024 sc1 lds
  s_add_u32 s54, s54, 4096
  s_waitcnt vmcnt(12)
  s_barrier
  s_add_u32 m0, s46, 147456
  s_nop 0
  buffer_load_dwordx4 v3, s[68:71], s54 offen sc1 lds
  buffer_load_dwordx4 v3, s[68:71], s54 offen offset:1024 sc1 lds
  s_add_u32 s54, s54, 4096
  s_waitcnt vmcnt(4)
  s_barrier
  s_add_u32 m0, s46, 155648
  s_nop 0
  buffer_load_dwordx4 v3, s[68:71], s54 offen sc1 lds
  buffer_load_dwordx4 v3, s[68:71], s54 offen offset:1024 sc1 lds
  s_add_u32 s54, s54, 4096
  s_waitcnt vmcnt(4)
  s_barrier
  s_add_u32 m0, s46, 131072
  s_nop 0
  buffer_load_dwordx4 v3, s[68:71], s54 offen sc1 lds
  buffer_load_dwordx4 v3, s[68:71], s54 offen offset:1024 sc1 lds
  s_add_u32 s54, s54, 4096
  s_waitcnt vmcnt(4)
  s_barrier
  s_add_u32 m0, s46, 139264
  s_nop 0
  buffer_load_dwordx4 v3, s[68:71], s54 offen sc1 lds
  buffer_load_dwordx4 v3, s[68:71], s54 offen offset:1024 sc1 lds
  s_add_u32 s54, s54, 4096
  s_waitcnt vmcnt(4)
  s_barrier
  s_add_u32 m0, s46, 147456
  s_nop 0
  buffer_load_dwordx4 v3, s[68:71], s54 offen sc1 lds
  buffer_load_dwordx4 v3, s[68:71], s54 offen offset:1024 sc1 lds
  s_add_u32 s54, s54, 4096
  s_waitcnt vmcnt(4)
  s_barrier
  s_cmp_lg_u32 s3, 0
  s_cbranch_scc1 L_asnA
  buffer_load_dword v32, v25, s[32:35], 0 offen offset:4 sc1
L_asnA:
  s_cmp_lg_u32 s3, 0
  s_cbranch_scc1 L_funA
  s_mov_b64 exec, 1
  buffer_store_dword v27, v23, s[32:35], s8 offen sc1
  s_mov_b64 exec, -1
L_funA:
  s_add_u32 m0, s46, 155648
  s_nop 0
  buffer_load_dwordx4 v3, s[68:71], s54 offen sc1 lds
  buffer_load_dwordx4 v3, s[68:71], s54 offen offset:1024 sc1 lds
  s_add_u32 s54, s54, 4096
  s_waitcnt vmcnt(2)
  s_cmp_lg_u32 s3, 0
  s_cbranch_scc1 L_csnA
  s_mov_b32 s62, 0x40000
L_psnA:
  v_cmp_ne_u32 vcc, v27, v32
  s_nop 4
  s_cbranch_vccz L_csnA
  s_sleep 6
  buffer_load_dword v32, v25, s[32:35], 0 offen offset:4 sc1
  s_sub_u32 s62, s62, 1
  s_cmp_lg_u32 s62, 0
  s_waitcnt vmcnt(0)
  s_cbranch_scc1 L_psnA
L_csnA:
  s_barrier
  s_waitcnt vmcnt(2)
  s_barrier
  s_cmp_lg_u32 s3, 0
  s_cbranch_scc1 L_aunA
  buffer_load_dwordx4 v[28:31], v33, s[32:35], 0 offen sc1
L_aunA:
  s_add_u32 m0, s46, 131072
  s_nop 0
  buffer_load_dwordx4 v3, s[68:71], s54 offen sc1 lds
  buffer_load_dwordx4 v3, s[68:71], s54 offen offset:1024 sc1 lds
  s_add_u32 s54, s54, 4096
  s_add_u32 m0, s55, 65536
  s_nop 0
  buffer_load_dwordx4 v10, s[20:23], s51 offen lds
  buffer_load_dwordx4 v11, s[20:23], s51 offen offset:1024 lds
  buffer_load_dwordx4 v12, s[20:23], s51 offen offset:2048 lds
  buffer_load_dwordx4 v13, s[20:23], s51 offen offset:3072 lds
  s_add_u32 s51, s51, s13
  s_waitcnt vmcnt(6)
  s_cmp_lg_u32 s3, 0
  s_cbranch_scc1 L_cunA
  s_mov_b32 s62, 0x40000
L_punA:
  v_xor_b32 v28, v27, v28
  v_xor_b32 v29, v27, v29
  v_xor_b32 v30, v27, v30
  v_xor_b32 v31, v27, v31
  v_or3_b32 v28, v28, v29, v30
  v_or_b32 v28, v28, v31
  v_cmp_ne_u32 vcc, 0, v28
  s_nop 4
  s_cbranch_vccz L_cunA
  s_sleep 6
  buffer_load_dwordx4 v[28:31], v33, s[32:35], 0 offen sc1
  s_sub_u32 s62, s62, 1
  s_cmp_lg_u32 s62, 0
  s_waitcnt vmcnt(0)
  s_cbranch_scc1 L_punA
L_cunA:
  s_barrier
  s_add_u32 m0, s55, 0
  s_nop 0
  buffer_load_dwordx4 v8, s[16:19], s48 offen sc1 lds
  buffer_load_dwordx4 v8, s[16:19], s48 offen offset:1024 sc1 lds
  buffer_load_dwordx4 v8, s[16:19], s48 offen offset:2048 sc1 lds
  buffer_load_dwordx4 v8, s[16:19], s48 offen offset:3072 sc1 lds
  s_add_u32 s48, s48, s12
  s_add_u32 m0, s46, 139264
  s_nop 0
  buffer_load_dwordx4 v3, s[68:71], s54 offen sc1 lds
  buffer_load_dwordx4 v3, s[68:71], s54 offen offset:1024 sc1 lds
  s_add_u32 s54, s54, 4096
  s_add_u32 m0, s55, 81920
  s_nop 0
  buffer_load_dwordx4 v10, s[20:23], s51 offen lds
  buffer_load_dwordx4 v11, s[20:23], s51 offen offset:1024 lds
  buffer_load_dwordx4 v12, s[20:23], s51 offen offset:2048 lds
  buffer_load_dwordx4 v13, s[20:23], s51 offen offset:3072 lds
  s_add_u32 s51, s51, s13
  s_add_u32 m0, s55, 16384
  s_nop 0
  buffer_load_dwordx4 v8, s[16:19], s48 offen sc1 lds
  buffer_load_dwordx4 v8, s[16:19], s48 offen offset:1024 sc1 lds
  buffer_load_dwordx4 v8, s[16:19], s48 offen offset:2048 sc1 lds
  buffer_load_dwordx4 v8, s[16:19], s48 offen offset:3072 sc1 lds
  s_add_u32 s48, s48, s12
  s_waitcnt vmcnt(10)
  s_barrier
  s_add_u32 m0, s46, 147456
  s_nop 0
  buffer_load_dwordx4 v3, s[68:71], s54 offen sc1 lds
  buffer_load_dwordx4 v3, s[68:71], s54 offen offset:1024 sc1 lds
  s_add_u32 s54, s54, 4096
  s_add_u32 m0, s55, 98304
  s_nop 0
  buffer_load_dwordx4 v10, s[20:23], s51 offen lds
  buffer_load_dwordx4 v11, s[20:23], s51 offen offset:1024 lds
  buffer_load_dwordx4 v12, s[20:23], s51 offen offset:2048 lds
  buffer_load_dwordx4 v13, s[20:23], s51 offen offset:3072 lds
  s_add_u32 s51, s51, s13
  s_add_u32 m0, s55, 32768
  s_nop 0
  buffer_load_dwordx4 v8, s[16:19], s48 offen sc1 lds
  buffer_load_dwordx4 v8, s[16:19], s48 offen offset:1024 sc1 lds
  buffer_load_dwordx4 v8, s[16:19], s48 offen offset:2048 sc1 lds
  buffer_load_dwordx4 v8, s[16:19], s48 offen offset:3072 sc1 lds
  s_add_u32 s48, s48, s12
  s_waitcnt vmcnt(10)
  s_barrier
  s_add_u32 m0, s55, 114688
  s_nop 0
  buffer_load_dwordx4 v10, s[20:23], s51 offen lds
  buffer_load_dwordx4 v11, s[20:23], s51 offen offset:1024 lds
  buffer_load_dwordx4 v12, s[20:23], s51 offen offset:2048 lds
  buffer_load_dwordx4 v13, s[20:23], s51 offen offset:3072 lds
  s_add_u32 s51, s51, s13
  s_add_u32 m0, s55, 49152
  s_nop 0
  buffer_load_dwordx4 v8, s[16:19], s48 offen sc1 lds
  buffer_load_dwordx4 v8, s[16:19], s48 offen offset:1024 sc1 lds
  buffer_load_dwordx4 v8, s[16:19], s48 offen offset:2048 sc1 lds
  buffer_load_dwordx4 v8, s[16:19], s48 offen offset:3072 sc1 lds
  s_add_u32 s48, s48, s12
  s_waitcnt vmcnt(8)
  s_barrier
  s_add_u32 m0, s55, 65536
  s_nop 0
  buffer_load_dwordx4 v10, s[20:23], s51 offen lds
  buffer_load_dwordx4 v11, s[20:23], s51 offen offset:1024 lds
  buffer_load_dwordx4 v12, s[20:23], s51 offen offset:2048 lds
  buffer_load_dwordx4 v13, s[20:23], s51 offen offset:3072 lds
  s_add_u32 s51, s51, s13
  s_add_u32 m0, s55, 0
  s_nop 0
  buffer_load_dwordx4 v8, s[16:19], s48 offen sc1 lds
  buffer_load_dwordx4 v8, s[16:19], s48 offen offset:1024 sc1 lds
  buffer_load_dwordx4 v8, s[16:19], s48 offen offset:2048 sc1 lds
  buffer_load_dwordx4 v8, s[16:19], s48 offen offset:3072 sc1 lds
  s_add_u32 s48, s48, s12
  s_waitcnt vmcnt(8)
  s_barrier
  s_add_u32 m0, s55, 81920
  s_nop 0
  buffer_load_dwordx4 v10, s[20:23], s51 offen lds
  buffer_load_dwordx4 v11, s[20:23], s51 offen offset:1024 lds
  buffer_load_dwordx4 v12, s[20:23], s51 offen offset:2048 lds
  buffer_load_dwordx4 v13, s[20:23], s51 offen offset:3072 lds
  s_add_u32 s51, s51, s13
  s_add_u32 m0, s55, 16384
  s_nop 0
  buffer_load_dwordx4 v8, s[16:19], s48 offen sc1 lds
  buffer_load_dwordx4 v8, s[16:19], s48 offen offset:1024 sc1 lds
  buffer_load_dwordx4 v8, s[16:19], s48 offen offset:2048 sc1 lds
  buffer_load_dwordx4 v8, s[16:19], s48 offen offset:3072 sc1 lds
  s_add_u32 s48, s48, s12
  s_waitcnt vmcnt(8)
  s_barrier
  s_add_u32 m0, s55, 98304
  s_nop 0
  buffer_load_dwordx4 v10, s[20:23], s51 offen lds
  buffer_load_dwordx4 v11, s[20:23], s51 offen offset:1024 lds
  buffer_load_dwordx4 v12, s[20:23], s51 offen offset:2048 lds
  buffer_load_dwordx4 v13, s[20:23], s51 offen offset:3072 lds
  s_add_u32 s51, s51, s13
  s_add_u32 m0, s55, 32768
  s_nop 0
  buffer_load_dwordx4 v8, s[16:19], s48 offen sc1 lds
  buffer_load_dwordx4 v8, s[16:19], s48 offen offset:1024 sc1 lds
  buffer_load_dwordx4 v8, s[16:19], s48 offen offset:2048 sc1 lds
  buffer_load_dwordx4 v8, s[16:19], s48 offen offset:3072 sc1 lds
  s_add_u32 s48, s48, s12
  s_waitcnt vmcnt(8)
  s_barrier
  s_cmp_lg_u32 s3, 0
  s_cbranch_scc1 L_fonA
  s_mov_b64 exec, 1
  buffer_store_dword v27, v23, s[32:35], s9 offen sc1
  s_mov_b64 exec, -1
L_fonA:
  s_add_u32 m0, s55, 114688
  s_nop 0
  buffer_load_dwordx4 v10, s[20:23], s51 offen lds
  buffer_load_dwordx4 v11, s[20:23], s51 offen offset:1024 lds
  buffer_load_dwordx4 v12, s[20:23], s51 offen offset:2048 lds
  buffer_load_dwordx4 v13, s[20:23], s51 offen offset:3072 lds
  s_add_u32 s51, s51, s13
  s_add_u32 m0, s55, 49152
  s_nop 0
  buffer_load_dwordx4 v8, s[16:19], s48 offen sc1 lds
  buffer_load_dwordx4 v8, s[16:19], s48 offen offset:1024 sc1 lds
  buffer_load_dwordx4 v8, s[16:19], s48 offen offset:2048 sc1 lds
  buffer_load_dwordx4 v8, s[16:19], s48 offen offset:3072 sc1 lds
  s_add_u32 s48, s48, s12
L_ld2:
  s_cmp_eq_u32 s14, 0
  s_cbranch_scc0 L_ldB
  s_sub_u32 s50, 8, s49
LA_LD0:
  s_waitcnt vmcnt(8)
  s_barrier
  s_add_u32 m0, s55, 65536
  s_nop 0
  buffer_load_dwordx4 v10, s[20:23], s51 offen lds
  buffer_load_dwordx4 v11, s[20:23], s51 offen offset:1024 lds
  buffer_load_dwordx4 v12, s[20:23], s51 offen offset:2048 lds
  buffer_load_dwordx4 v13, s[20:23], s51 offen offset:3072 lds
  s_add_u32 s51, s51, s13
  s_add_u32 m0, s55, 0
  s_nop 0
  buffer_load_dwordx4 v8, s[16:19], s48 offen sc1 lds
  buffer_load_dwordx4 v8, s[16:19], s48 offen offset:1024 sc1 lds
  buffer_load_dwordx4 v8, s[16:19], s48 offen offset:2048 sc1 lds
  buffer_load_dwordx4 v8, s[16:19], s48 offen offset:3072 sc1 lds
  s_add_u32 s48, s48, s12
  s_waitcnt vmcnt(8)
  s_barrier
  s_add_u32 m0, s55, 81920
  s_nop 0
  buffer_load_dwordx4 v10, s[20:23], s51 offen lds
  buffer_load_dwordx4 v11, s[20:23], s51 offen offset:1024 lds
  buffer_load_dwordx4 v12, s[20:23], s51 offen offset:2048 lds
  buffer_load_dwordx4 v13, s[20:23], s51 offen offset:3072 lds
  s_add_u32 s51, s51, s13
  s_add_u32 m0, s55, 16384
  s_nop 0
  buffer_load_dwordx4 v8, s[16:19], s48 offen sc1 lds
  buffer_load_dwordx4 v8, s[16:19], s48 offen offset:1024 sc1 lds
  buffer_load_dwordx4 v8, s[16:19], s48 offen offset:2048 sc1 lds
  buffer_load_dwordx4 v8, s[16:19], s48 offen offset:3072 sc1 lds
  s_add_u32 s48, s48, s12
  s_waitcnt vmcnt(8)
  s_barrier
  s_add_u32 m0, s55, 98304
  s_nop 0
  buffer_load_dwordx4 v10, s[20:23], s51 offen lds
  buffer_load_dwordx4 v11, s[20:23], s51 offen offset:1024 lds
  buffer_load_dwordx4 v12, s[20:23], s51 offen offset:2048 lds
  buffer_load_dwordx4 v13, s[20:23], s51 offen offset:3072 lds
  s_add_u32 s51, s51, s13
  s_add_u32 m0, s55, 32768
  s_nop 0
  buffer_load_dwordx4 v8, s[16:19], s48 offen sc1 lds
  buffer_load_dwordx4 v8, s[16:19], s48 offen offset:1024 sc1 lds
  buffer_load_dwordx4 v8, s[16:19], s48 offen offset:2048 sc1 lds
  buffer_load_dwordx4 v8, s[16:19], s48 offen offset:3072 sc1 lds
  s_add_u32 s48, s48, s12
  s_waitcnt vmcnt(8)
  s_barrier
  s_add_u32 m0, s55, 114688
  s_nop 0
  buffer_load_dwordx4 v10, s[20:23], s51 offen lds
  buffer_load_dwordx4 v11, s[20:23], s51 offen offset:1024 lds
  buffer_load_dwordx4 v12, s[20:23], s51 offen offset:2048 lds
  buffer_load_dwordx4 v13, s[20:23], s51 offen offset:3072 lds
  s_add_u32 s51, s51, s13
  s_add_u32 m0, s55, 49152
  s_nop 0
  buffer_load_dwordx4 v8, s[16:19], s48 offen sc1 lds
  buffer_load_dwordx4 v8, s[16:19], s48 offen offset:1024 sc1 lds
  buffer_load_dwordx4 v8, s[16:19], s48 offen offset:2048 sc1 lds
  buffer_load_dwordx4 v8, s[16:19], s48 offen offset:3072 sc1 lds
  s_add_u32 s48, s48, s12
  s_sub_u32 s50, s50, 1
  s_cmp_lg_u32 s50, 0
  s_cbranch_scc1 LA_LD0
  s_waitcnt vmcnt(8)
  s_barrier
  s_waitcnt vmcnt(0)
  s_barrier
  s_branch L_ldE
L_ldB:
  s_sub_u32 s50, 3, s49
LB_LD0:
  s_waitcnt vmcnt(8)
  s_barrier
  s_add_u32 m0, s55, 65536
  s_nop 0
  buffer_load_dwordx4 v10, s[20:23], s51 offen lds
  buffer_load_dwordx4 v11, s[20:23], s51 offen offset:1024 lds
  buffer_load_dwordx4 v12, s[20:23], s51 offen offset:2048 lds
  buffer_load_dwordx4 v13, s[20:23], s51 offen offset:3072 lds
  s_add_u32 s51, s51, s13
  s_add_u32 m0, s55, 0
  s_nop 0
  buffer_load_dwordx4 v8, s[16:19], s48 offen sc1 lds
  buffer_load_dwordx4 v8, s[16:19], s48 offen offset:1024 sc1 lds
  buffer_load_dwordx4 v8, s[16:19], s48 offen offset:2048 sc1 lds
  buffer_load_dwordx4 v8, s[16:19], s48 offen offset:3072 sc1 lds
  s_add_u32 s48, s48, s12
  s_waitcnt vmcnt(8)
  s_barrier
  s_add_u32 m0, s55, 81920
  s_nop 0
  buffer_load_dwordx4 v10, s[20:23], s51 offen lds
  buffer_load_dwordx4 v11, s[20:23], s51 offen offset:1024 lds
  buffer_load_dwordx4 v12, s[20:23], s51 offen offset:2048 lds
  buffer_load_dwordx4 v13, s[20:23], s51 offen offset:3072 lds
  s_add_u32 s51, s51, s13
  s_add_u32 m0, s55, 16384
  s_nop 0
  buffer_load_dwordx4 v8, s[16:19], s48 offen sc1 lds
  buffer_load_dwordx4 v8, s[16:19], s48 offen offset:1024 sc1 lds
  buffer_load_dwordx4 v8, s[16:19], s48 offen offset:2048 sc1 lds
  buffer_load_dwordx4 v8, s[16:19], s48 offen offset:3072 sc1 lds
  s_add_u32 s48, s48, s12
  s_waitcnt vmcnt(8)
  s_barrier
  s_add_u32 m0, s55, 98304
  s_nop 0
  buffer_load_dwordx4 v10, s[20:23], s51 offen lds
  buffer_load_dwordx4 v11, s[20:23], s51 offen offset:1024 lds
  buffer_load_dwordx4 v12, s[20:23], s51 offen offset:2048 lds
  buffer_load_dwordx4 v13, s[20:23], s51 offen offset:3072 lds
  s_add_u32 s51, s51, s13
  s_add_u32 m0, s55, 32768
  s_nop 0
  buffer_load_dwordx4 v8, s[16:19], s48 offen sc1 lds
  buffer_load_dwordx4 v8, s[16:19], s48 offen offset:1024 sc1 lds
  buffer_load_dwordx4 v8, s[16:19], s48 offen offset:2048 sc1 lds
  buffer_load_dwordx4 v8, s[16:19], s48 offen offset:3072 sc1 lds
  s_add_u32 s48, s48, s12
  s_waitcnt vmcnt(8)
  s_barrier
  s_add_u32 m0, s55, 114688
  s_nop 0
  buffer_load_dwordx4 v10, s[20:23], s51 offen lds
  buffer_load_dwordx4 v11, s[20:23], s51 offen offset:1024 lds
  buffer_load_dwordx4 v12, s[20:23], s51 offen offset:2048 lds
  buffer_load_dwordx4 v13, s[20:23], s51 offen offset:3072 lds
  s_add_u32 s51, s51, s13
  s_add_u32 m0, s55, 49152
  s_nop 0
  buffer_load_dwordx4 v8, s[16:19], s48 offen sc1 lds
  buffer_load_dwordx4 v8, s[16:19], s48 offen offset:1024 sc1 lds
  buffer_load_dwordx4 v8, s[16:19], s48 offen offset:2048 sc1 lds
  buffer_load_dwordx4 v8, s[16:19], s48 offen offset:3072 sc1 lds
  s_add_u32 s48, s48, s12
  s_sub_u32 s50, s50, 1
  s_cmp_lg_u32 s50, 0
  s_cbranch_scc1 LB_LD0
  s_waitcnt vmcnt(8)
  s_barrier
  s_add_u32 m0, s55, 65536
  s_nop 0
  buffer_load_dwordx4 v10, s[20:23], s51 offen lds
  buffer_load_dwordx4 v11, s[20:23], s51 offen offset:1024 lds
  buffer_load_dwordx4 v12, s[20:23], s51 offen offset:2048 lds
  buffer_load_dwordx4 v13, s[20:23], s51 offen offset:3072 lds
  s_add_u32 s51, s51, s13
  s_add_u32 m0, s55, 0
  s_nop 0
  buffer_load_dwordx4 v8, s[16:19], s48 offen sc1 lds
  buffer_load_dwordx4 v8, s[16:19], s48 offen offset:1024 sc1 lds
  buffer_load_dwordx4 v8, s[16:19], s48 offen offset:2048 sc1 lds
  buffer_load_dwordx4 v8, s[16:19], s48 offen offset:3072 sc1 lds
  s_add_u32 s48, s48, s12
  s_waitcnt vmcnt(8)
  s_barrier
  s_add_u32 m0, s55, 81920
  s_nop 0
  buffer_load_dwordx4 v10, s[20:23], s51 offen lds
  buffer_load_dwordx4 v11, s[20:23], s51 offen offset:1024 lds
  buffer_load_dwordx4 v12, s[20:23], s51 offen offset:2048 lds
  buffer_load_dwordx4 v13, s[20:23], s51 offen offset:3072 lds
  s_add_u32 s51, s51, s13
  s_add_u32 m0, s55, 16384
  s_nop 0
  buffer_load_dwordx4 v8, s[16:19], s48 offen sc1 lds
  buffer_load_dwordx4 v8, s[16:19], s48 offen offset:1024 sc1 lds
  buffer_load_dwordx4 v8, s[16:19], s48 offen offset:2048 sc1 lds
  buffer_load_dwordx4 v8, s[16:19], s48 offen offset:3072 sc1 lds
  s_add_u32 s48, s48, s12
  s_waitcnt vmcnt(8)
  s_barrier
  s_add_u32 m0, s55, 98304
  s_nop 0
  buffer_load_dwordx4 v10, s[20:23], s51 offen lds
  buffer_load_dwordx4 v11, s[20:23], s51 offen offset:1024 lds
  buffer_load_dwordx4 v12, s[20:23], s51 offen offset:2048 lds
  buffer_load_dwordx4 v13, s[20:23], s51 offen offset:3072 lds
  s_add_u32 s51, s51, s13
  s_add_u32 m0, s55, 32768
  s_nop 0
  buffer_load_dwordx4 v8, s[16:19], s48 offen sc1 lds
  buffer_load_dwordx4 v8, s[16:19], s48 offen offset:1024 sc1 lds
  buffer_load_dwordx4 v8, s[16:19], s48 offen offset:2048 sc1 lds
  buffer_load_dwordx4 v8, s[16:19], s48 offen offset:3072 sc1 lds
  s_add_u32 s48, s48, s12
  s_waitcnt vmcnt(8)
  s_barrier
  s_cmp_lg_u32 s3, 0
  s_cbranch_scc1 L_aonB
  buffer_load_dword v32, v34, s[32:35], 0 offen sc1
L_aonB:
  s_add_u32 m0, s55, 114688
  s_nop 0
  buffer_load_dwordx4 v10, s[20:23], s51 offen lds
  buffer_load_dwordx4 v11, s[20:23], s51 offen offset:1024 lds
  buffer_load_dwordx4 v12, s[20:23], s51 offen offset:2048 lds
  buffer_load_dwordx4 v13, s[20:23], s51 offen offset:3072 lds
  s_add_u32 s51, s51, s13
  s_add_u32 m0, s55, 49152
  s_nop 0
  buffer_load_dwordx4 v8, s[16:19], s48 offen sc1 lds
  buffer_load_dwordx4 v8, s[16:19], s48 offen offset:1024 sc1 lds
  buffer_load_dwordx4 v8, s[16:19], s48 offen offset:2048 sc1 lds
  buffer_load_dwordx4 v8, s[16:19], s48 offen offset:3072 sc1 lds
  s_add_u32 s48, s48, s12
  s_waitcnt vmcnt(8)
  s_cmp_lg_u32 s3, 0
  s_cbranch_scc1 L_conB
  s_mov_b32 s62, 0x40000
L_ponB:
  v_cmp_ne_u32 vcc, v27, v32
  s_nop 4
  s_cbranch_vccz L_conB
  s_sleep 6
  buffer_load_dword v32, v34, s[32:35], 0 offen sc1
  s_sub_u32 s62, s62, 1
  s_cmp_lg_u32 s62, 0
  s_waitcnt vmcnt(0)
  s_cbranch_scc1 L_ponB
L_conB:
  s_barrier
  s_add_u32 m0, s55, 0
  s_nop 0
  buffer_load_dwordx4 v36, s[24:27], s47 offen lds
  buffer_load_dwordx4 v37, s[24:27], s47 offen offset:1024 lds
  buffer_load_dwordx4 v38, s[24:27], s47 offen offset:2048 lds
  buffer_load_dwordx4 v39, s[24:27], s47 offen offset:3072 lds
  s_add_u32 s47, s47, 131072
  s_add_u32 m0, s55, 65536
  s_nop 0
  buffer_load_dwordx4 v9, s[4:7], s63 offen sc1 lds
  buffer_load_dwordx4 v9, s[4:7], s63 offen offset:1024 sc1 lds
  buffer_load_dwordx4 v9, s[4:7], s63 offen offset:2048 sc1 lds
  buffer_load_dwordx4 v9, s[4:7], s63 offen offset:3072 sc1 lds
  s_add_u32 s63, s63, 4096
  s_mov_b32 s50, 3
LB_LD1:
  s_waitcnt vmcnt(8)
  s_barrier
  s_add_u32 m0, s55, 16384
  s_nop 0
  buffer_load_dwordx4 v36, s[24:27], s47 offen lds
  buffer_load_dwordx4 v37, s[24:27], s47 offen offset:1024 lds
  buffer_load_dwordx4 v38, s[24:27], s47 offen offset:2048 lds
  buffer_load_dwordx4 v39, s[24:27], s47 offen offset:3072 lds
  s_add_u32 s47, s47, 131072
  s_add_u32 m0, s55, 81920
  s_nop 0
  buffer_load_dwordx4 v9, s[4:7], s63 offen sc1 lds
  buffer_load_dwordx4 v9, s[4:7], s63 offen offset:1024 sc1 lds
  buffer_load_dwordx4 v9, s[4:7], s63 offen offset:2048 sc1 lds
  buffer_load_dwordx4 v9, s[4:7], s63 offen offset:3072 sc1 lds
  s_add_u32 s63, s63, 4096
  s_waitcnt vmcnt(8)
  s_barrier
  s_add_u32 m0, s55, 32768
  s_nop 0
  buffer_load_dwordx4 v36, s[24:27], s47 offen lds
  buffer_load_dwordx4 v37, s[24:27], s47 offen offset:1024 lds
  buffer_load_dwordx4 v38, s[24:27], s47 offen offset:2048 lds
  buffer_load_dwordx4 v39, s[24:27], s47 offen offset:3072 lds
  s_add_u32 s47, s47, 131072
  s_add_u32 m0, s55, 98304
  s_nop 0
  buffer_load_dwordx4 v9, s[4:7], s63 offen sc1 lds
  buffer_load_dwordx4 v9, s[4:7], s63 offen offset:1024 sc1 lds
  buffer_load_dwordx4 v9, s[4:7], s63 offen offset:2048 sc1 lds
  buffer_load_dwordx4 v9, s[4:7], s63 offen offset:3072 sc1 lds
  s_add_u32 s63, s63, 4096
  s_waitcnt vmcnt(8)
  s_barrier
  s_add_u32 m0, s55, 49152
  s_nop 0
  buffer_load_dwordx4 v36, s[24:27], s47 offen lds
  buffer_load_dwordx4 v37, s[24:27], s47 offen offset:1024 lds
  buffer_load_dwordx4 v38, s[24:27], s47 offen offset:2048 lds
  buffer_load_dwordx4 v39, s[24:27], s47 offen offset:3072 lds
  s_add_u32 s47, s47, 131072
  s_add_u32 m0, s55, 114688
  s_nop 0
  buffer_load_dwordx4 v9, s[4:7], s63 offen sc1 lds
  buffer_load_dwordx4 v9, s[4:7], s63 offen offset:1024 sc1 lds
  buffer_load_dwordx4 v9, s[4:7], s63 offen offset:2048 sc1 lds
  buffer_load_dwordx4 v9, s[4:7], s63 offen offset:3072 sc1 lds
  s_add_u32 s63, s63, 4096
  s_waitcnt vmcnt(8)
  s_barrier
  s_add_u32 m0, s55, 0
  s_nop 0
  buffer_load_dwordx4 v36, s[24:27], s47 offen lds
  buffer_load_dwordx4 v37, s[24:27], s47 offen offset:1024 lds
  buffer_load_dwordx4 v38, s[24:27], s47 offen offset:2048 lds
  buffer_load_dwordx4 v39, s[24:27], s47 offen offset:3072 lds
  s_add_u32 s47, s47, 131072
  s_add_u32 m0, s55, 65536
  s_nop 0
  buffer_load_dwordx4 v9, s[4:7], s63 offen sc1 lds
  buffer_load_dwordx4 v9, s[4:7], s63 offen offset:1024 sc1 lds
  buffer_load_dwordx4 v9, s[4:7], s63 offen offset:2048 sc1 lds
  buffer_load_dwordx4 v9, s[4:7], s63 offen offset:3072 sc1 lds
  s_add_u32 s63, s63, 4096
  s_sub_u32 s50, s50, 1
  s_cmp_lg_u32 s50, 0
  s_cbranch_scc1 LB_LD1
  s_waitcnt vmcnt(8)
  s_barrier
  s_add_u32 m0, s55, 16384
  s_nop 0
  buffer_load_dwordx4 v36, s[24:27], s47 offen lds
  buffer_load_dwordx4 v37, s[24:27], s47 offen offset:1024 lds
  buffer_load_dwordx4 v38, s[24:27], s47 offen offset:2048 lds
  buffer_load_dwordx4 v39, s[24:27], s47 offen offset:3072 lds
  s_add_u32 s47, s47, 131072
  s_add_u32 m0, s55, 81920
  s_nop 0
  buffer_load_dwordx4 v9, s[4:7], s63 offen sc1 lds
  buffer_load_dwordx4 v9, s[4:7], s63 offen offset:1024 sc1 lds
  buffer_load_dwordx4 v9, s[4:7], s63 offen offset:2048 sc1 lds
  buffer_load_dwordx4 v9, s[4:7], s63 offen offset:3072 sc1 lds
  s_add_u32 s63, s63, 4096
  s_waitcnt vmcnt(8)
  s_barrier
  s_add_u32 m0, s55, 32768
  s_nop 0
  buffer_load_dwordx4 v36, s[24:27], s47 offen lds
  buffer_load_dwordx4 v37, s[24:27], s47 offen offset:1024 lds
  buffer_load_dwordx4 v38, s[24:27], s47 offen offset:2048 lds
  buffer_load_dwordx4 v39, s[24:27], s47 offen offset:3072 lds
  s_add_u32 s47, s47, 131072
  s_add_u32 m0, s55, 98304
  s_nop 0
  buffer_load_dwordx4 v9, s[4:7], s63 offen sc1 lds
  buffer_load_dwordx4 v9, s[4:7], s63 offen offset:1024 sc1 lds
  buffer_load_dwordx4 v9, s[4:7], s63 offen offset:2048 sc1 lds
  buffer_load_dwordx4 v9, s[4:7], s63 offen offset:3072 sc1 lds
  s_add_u32 s63, s63, 4096
  s_waitcnt vmcnt(8)
  s_barrier
  s_add_u32 m0, s55, 49152
  s_nop 0
  buffer_load_dwordx4 v36, s[24:27], s47 offen lds
  buffer_load_dwordx4 v37, s[24:27], s47 offen offset:1024 lds
  buffer_load_dwordx4 v38, s[24:27], s47 offen offset:2048 lds
  buffer_load_dwordx4 v39, s[24:27], s47 offen offset:3072 lds
  s_add_u32 s47, s47, 131072
  s_add_u32 m0, s55, 114688
  s_nop 0
  buffer_load_dwordx4 v9, s[4:7], s63 offen sc1 lds
  buffer_load_dwordx4 v9, s[4:7], s63 offen offset:1024 sc1 lds
  buffer_load_dwordx4 v9, s[4:7], s63 offen offset:2048 sc1 lds
  buffer_load_dwordx4 v9, s[4:7], s63 offen offset:3072 sc1 lds
  s_add_u32 s63, s63, 4096
  s_waitcnt vmcnt(8)
  s_barrier
  s_waitcnt vmcnt(0)
  s_barrier
L_ldE:
  s_endpgm
L_ldkv:
  s_lshl_b32 s62, s45, 7
  s_lshl_b32 s63, s44, 2
  v_lshrrev_b32 v4, 4, v2
  v_and_b32 v5, 15, v2
  v_lshlrev_b32 v16, 1, v4
  v_xor_b32 v5, v5, v16
  s_mov_b32 s60, 7168
  v_mul_lo_u32 v4, v4, s60
  s_mul_i32 s60, s3, 114688
  s_lshl_b32 s61, s62, 1
  s_add_u32 s60, s60, s61
  v_add_u32 v4, s60, v4
  v_lshl_add_u32 v16, v5, 4, v4
  v_xor_b32 v5, 8, v5
  v_lshl_add_u32 v4, v5, 4, v4
  v_add_u32 v17, 27648, v16
  v_add_u32 v18, 55296, v4
  v_add_u32 v19, 82944, v4
  s_add_u32 s60, s63, s3
  s_mul_i32 s60, s60, 131072
  v_lshlrev_b32 v20, 4, v2
  v_add_u32 v20, s60, v20
  s_mov_b32 s52, 0
  s_mov_b32 s53, 0
  s_cmp_lt_u32 s3, 2
  s_cselect_b32 s54, 0, 123904
  s_add_u32 s54, s54, s46
  s_mov_b32 s28, s12
  s_mov_b32 s29, s13
  s_mov_b32 s30, 14680064
  s_mov_b32 s31, 0x00020000
  s_mov_b32 s64, s38
  s_mov_b32 s65, s39
  s_mov_b32 s66, 4194304
  s_mov_b32 s67, 0x00020000
  s_add_u32 s68, s38, 4259840
  s_addc_u32 s69, s39, 0
  s_mov_b32 s70, 262144
  s_mov_b32 s71, 0x00020000
  s_mov_b32 s56, s36
  s_mov_b32 s57, s37
  s_mov_b32 s58, 256
  s_mov_b32 s59, 0x00020000
  s_add_u32 s32, s38, 4227072
  s_addc_u32 s33, s39, 0
  s_mov_b32 s34, 32768
  s_mov_b32 s35, 0x00020000
  v_mov_b32 v23, 0
  v_lshlrev_b32 v24, 7, v2
  v_and_b32 v25, 31, v2
  v_lshlrev_b32 v25, 7, v25
  v_add_u32 v25, 8192, v25
  s_sub_u32 s52, s2, 224
  s_lshl_b32 s52, s52, 7
  s_add_u32 s52, s52, 8192
  s_mov_b32 s50, 2
Lk_LD0:
  s_waitcnt vmcnt(5)
  s_barrier
  s_add_u32 m0, s47, 40960
  s_nop 0
  buffer_load_dwordx4 v26, s[24:27], s51 offen lds
  s_add_u32 s51, s51, 4096
  s_and_b32 s51, s51, 65535
  s_add_u32 m0, s55, 98304
  s_nop 0
  buffer_load_dwordx4 v10, s[20:23], s49 offen lds
  buffer_load_dwordx4 v11, s[20:23], s49 offen offset:1024 lds
  buffer_load_dwordx4 v12, s[20:23], s49 offen offset:2048 lds
  buffer_load_dwordx4 v13, s[20:23], s49 offen offset:3072 lds
  s_add_u32 s49, s49, 128
  s_and_b32 s49, s49, 2047
  s_waitcnt vmcnt(5)
  s_barrier
  s_add_u32 m0, s47, 57344
  s_nop 0
  buffer_load_dwordx4 v26, s[24:27], s51 offen lds
  s_add_u32 s51, s51, 4096
  s_and_b32 s51, s51, 65535
  s_add_u32 m0, s55, 114688
  s_nop 0
  buffer_load_dwordx4 v10, s[20:23], s49 offen lds
  buffer_load_dwordx4 v11, s[20:23], s49 offen offset:1024 lds
  buffer_load_dwordx4 v12, s[20:23], s49 offen offset:2048 lds
  buffer_load_dwordx4 v13, s[20:23], s49 offen offset:3072 lds
  s_add_u32 s49, s49, 128
  s_and_b32 s49, s49, 2047
  s_waitcnt vmcnt(5)
  s_barrier
  s_add_u32 m0, s47, 8192
  s_nop 0
  buffer_load_dwordx4 v26, s[24:27], s51 offen lds
  s_add_u32 s51, s51, 4096
  s_and_b32 s51, s51, 65535
  s_add_u32 m0, s55, 65536
  s_nop 0
  buffer_load_dwordx4 v10, s[20:23], s49 offen lds
  buffer_load_dwordx4 v11, s[20:23], s49 offen offset:1024 lds
  buffer_load_dwordx4 v12, s[20:23], s49 offen offset:2048 lds
  buffer_load_dwordx4 v13, s[20:23], s49 offen offset:3072 lds
  s_add_u32 s49, s49, 128
  s_and_b32 s49, s49, 2047
  s_waitcnt vmcnt(5)
  s_barrier
  s_add_u32 m0, s47, 24576
  s_nop 0
  buffer_load_dwordx4 v26, s[24:27], s51 offen lds
  s_add_u32 s51, s51, 4096
  s_and_b32 s51, s51, 65535
  s_add_u32 m0, s55, 81920
  s_nop 0
  buffer_load_dwordx4 v10, s[20:23], s49 offen lds
  buffer_load_dwordx4 v11, s[20:23], s49 offen offset:1024 lds
  buffer_load_dwordx4 v12, s[20:23], s49 offen offset:2048 lds
  buffer_load_dwordx4 v13, s[20:23], s49 offen offset:3072 lds
  s_add_u32 s49, s49, 128
  s_and_b32 s49, s49, 2047
  s_sub_u32 s50, s50, 1
  s_cmp_lg_u32 s50, 0
  s_cbranch_scc1 Lk_LD0
  s_waitcnt vmcnt(5)
  s_barrier
  v_mov_b32 v27, 163836
  ds_read_b32 v27, v27
  s_waitcnt lgkmcnt(0)
  s_add_u32 m0, s47, 40960
  s_nop 0
  buffer_load_dwordx4 v26, s[24:27], s51 offen lds
  s_add_u32 s51, s51, 4096
  s_and_b32 s51, s51, 65535
  s_add_u32 m0, s55, 98304
  s_nop 0
  buffer_load_dwordx4 v10, s[20:23], s49 offen lds
  buffer_load_dwordx4 v11, s[20:23], s49 offen offset:1024 lds
  buffer_load_dwordx4 v12, s[20:23], s49 offen offset:2048 lds
  buffer_load_dwordx4 v13, s[20:23], s49 offen offset:3072 lds
  s_add_u32 s49, s49, 128
  s_and_b32 s49, s49, 2047
  s_waitcnt vmcnt(5)
  s_barrier
  s_add_u32 m0, s47, 57344
  s_nop 0
  buffer_load_dwordx4 v26, s[24:27], s51 offen lds
  s_add_u32 s51, s51, 4096
  s_and_b32 s51, s51, 65535
  s_add_u32 m0, s55, 114688
  s_nop 0
  buffer_load_dwordx4 v10, s[20:23], s49 offen lds
  buffer_load_dwordx4 v11, s[20:23], s49 offen offset:1024 lds
  buffer_load_dwordx4 v12, s[20:23], s49 offen offset:2048 lds
  buffer_load_dwordx4 v13, s[20:23], s49 offen offset:3072 lds
  s_add_u32 s49, s49, 128
  s_and_b32 s49, s49, 2047
  s_waitcnt vmcnt(5)
  s_barrier
  s_add_u32 m0, s47, 8192
  s_nop 0
  buffer_load_dwordx4 v26, s[24:27], s51 offen lds
  s_add_u32 s51, s51, 4096
  s_and_b32 s51, s51, 65535
  s_add_u32 m0, s55, 65536
  s_nop 0
  buffer_load_dwordx4 v10, s[20:23], s49 offen lds
  buffer_load_dwordx4 v11, s[20:23], s49 offen offset:1024 lds
  buffer_load_dwordx4 v12, s[20:23], s49 offen offset:2048 lds
  buffer_load_dwordx4 v13, s[20:23], s49 offen offset:3072 lds
  s_add_u32 s49, s49, 128
  s_and_b32 s49, s49, 2047
  s_waitcnt vmcnt(5)
  s_barrier
  s_add_u32 m0, s47, 24576
  s_nop 0
  buffer_load_dwordx4 v26, s[24:27], s51 offen lds
  s_add_u32 s51, s51, 4096
  s_and_b32 s51, s51, 65535
  s_add_u32 m0, s55, 81920
  s_nop 0
  buffer_load_dwordx4 v10, s[20:23], s49 offen lds
  buffer_load_dwordx4 v11, s[20:23], s49 offen offset:1024 lds
  buffer_load_dwordx4 v12, s[20:23], s49 offen offset:2048 lds
  buffer_load_dwordx4 v13, s[20:23], s49 offen offset:3072 lds
  s_add_u32 s49, s49, 128
  s_and_b32 s49, s49, 2047
  s_waitcnt vmcnt(5)
  s_barrier
  s_add_u32 m0, s47, 40960
  s_nop 0
  buffer_load_dwordx4 v26, s[24:27], s51 offen lds
  s_add_u32 s51, s51, 4096
  s_and_b32 s51, s51, 65535
  s_add_u32 m0, s55, 98304
  s_nop 0
  buffer_load_dwordx4 v10, s[20:23], s49 offen lds
  buffer_load_dwordx4 v11, s[20:23], s49 offen offset:1024 lds
  buffer_load_dwordx4 v12, s[20:23], s49 offen offset:2048 lds
  buffer_load_dwordx4 v13, s[20:23], s49 offen offset:3072 lds
  s_add_u32 s49, s49, 128
  s_and_b32 s49, s49, 2047
  s_waitcnt vmcnt(5)
  s_barrier
  s_add_u32 m0, s47, 57344
  s_nop 0
  buffer_load_dwordx4 v26, s[24:27], s51 offen lds
  s_add_u32 s51, s51, 4096
  s_and_b32 s51, s51, 65535
  s_add_u32 m0, s55, 114688
  s_nop 0
  buffer_load_dwordx4 v10, s[20:23], s49 offen lds
  buffer_load_dwordx4 v11, s[20:23], s49 offen offset:1024 lds
  buffer_load_dwordx4 v12, s[20:23], s49 offen offset:2048 lds
  buffer_load_dwordx4 v13, s[20:23], s49 offen offset:3072 lds
  s_add_u32 s49, s49, 128
  s_and_b32 s49, s49, 2047
  s_waitcnt vmcnt(5)
  s_barrier
  s_waitcnt vmcnt(0)
  s_barrier
  s_waitcnt vmcnt(0)
  s_barrier
  s_waitcnt vmcnt(0)
  s_barrier
  s_cmp_lg_u32 s3, 0
  s_cbranch_scc1 L_fkkA
  s_mov_b64 exec, 1
  buffer_store_dword v27, v23, s[32:35], s52 offen sc1
  s_mov_b64 exec, -1
L_fkkA:
  s_waitcnt vmcnt(0)
  s_barrier
  s_add_u32 m0, s46, 0
  s_nop 0
  buffer_load_dwordx4 v8, s[16:19], s48 offen lds
  buffer_load_dwordx4 v9, s[16:19], s48 offen offset:1024 lds
  s_add_u32 s48, s48, 131072
  s_and_b32 s48, s48, 2097151
  s_add_u32 m0, s55, 65536
  s_nop 0
  buffer_load_dwordx4 v10, s[20:23], s49 offen lds
  buffer_load_dwordx4 v11, s[20:23], s49 offen offset:1024 lds
  buffer_load_dwordx4 v12, s[20:23], s49 offen offset:2048 lds
  buffer_load_dwordx4 v13, s[20:23], s49 offen offset:3072 lds
  s_add_u32 s49, s49, 128
  s_and_b32 s49, s49, 2047
  s_mov_b32 s50, 3
Lk_LD1:
  s_waitcnt vmcnt(6)
  s_barrier
  s_add_u32 m0, s46, 16384
  s_nop 0
  buffer_load_dwordx4 v8, s[16:19], s48 offen lds
  buffer_load_dwordx4 v9, s[16:19], s48 offen offset:1024 lds
  s_add_u32 s48, s48, 131072
  s_and_b32 s48, s48, 2097151
  s_add_u32 m0, s55, 81920
  s_nop 0
  buffer_load_dwordx4 v10, s[20:23], s49 offen lds
  buffer_load_dwordx4 v11, s[20:23], s49 offen offset:1024 lds
  buffer_load_dwordx4 v12, s[20:23], s49 offen offset:2048 lds
  buffer_load_dwordx4 v13, s[20:23], s49 offen offset:3072 lds
  s_add_u32 s49, s49, 128
  s_and_b32 s49, s49, 2047
  s_waitcnt vmcnt(6)
  s_barrier
  s_add_u32 m0, s46, 32768
  s_nop 0
  buffer_load_dwordx4 v8, s[16:19], s48 offen lds
  buffer_load_dwordx4 v9, s[16:19], s48 offen offset:1024 lds
  s_add_u32 s48, s48, 131072
  s_and_b32 s48, s48, 2097151
  s_add_u32 m0, s55, 98304
  s_nop 0
  buffer_load_dwordx4 v10, s[20:23], s49 offen lds
  buffer_load_dwordx4 v11, s[20:23], s49 offen offset:1024 lds
  buffer_load_dwordx4 v12, s[20:23], s49 offen offset:2048 lds
  buffer_load_dwordx4 v13, s[20:23], s49 offen offset:3072 lds
  s_add_u32 s49, s49, 128
  s_and_b32 s49, s49, 2047
  s_waitcnt vmcnt(6)
  s_barrier
  s_add_u32 m0, s46, 49152
  s_nop 0
  buffer_load_dwordx4 v8, s[16:19], s48 offen lds
  buffer_load_dwordx4 v9, s[16:19], s48 offen offset:1024 lds
  s_add_u32 s48, s48, 131072
  s_and_b32 s48, s48, 2097151
  s_add_u32 m0, s55, 114688
  s_nop 0
  buffer_load_dwordx4 v10, s[20:23], s49 offen lds
  buffer_load_dwordx4 v11, s[20:23], s49 offen offset:1024 lds
  buffer_load_dwordx4 v12, s[20:23], s49 offen offset:2048 lds
  buffer_load_dwordx4 v13, s[20:23], s49 offen offset:3072 lds
  s_add_u32 s49, s49, 128
  s_and_b32 s49, s49, 2047
  s_waitcnt vmcnt(6)
  s_barrier
  s_add_u32 m0, s46, 0
  s_nop 0
  buffer_load_dwordx4 v8, s[16:19], s48 offen lds
  buffer_load_dwordx4 v9, s[16:19], s48 offen offset:1024 lds
  s_add_u32 s48, s48, 131072
  s_and_b32 s48, s48, 2097151
  s_add_u32 m0, s55, 65536
  s_nop 0
  buffer_load_dwordx4 v10, s[20:23], s49 offen lds
  buffer_load_dwordx4 v11, s[20:23], s49 offen offset:1024 lds
  buffer_load_dwordx4 v12, s[20:23], s49 offen offset:2048 lds
  buffer_load_dwordx4 v13, s[20:23], s49 offen offset:3072 lds
  s_add_u32 s49, s49, 128
  s_and_b32 s49, s49, 2047
  s_sub_u32 s50, s50, 1
  s_cmp_lg_u32 s50, 0
  s_cbranch_scc1 Lk_LD1
  s_waitcnt vmcnt(6)
  s_barrier
  s_add_u32 m0, s46, 16384
  s_nop 0
  buffer_load_dwordx4 v8, s[16:19], s48 offen lds
  buffer_load_dwordx4 v9, s[16:19], s48 offen offset:1024 lds
  s_add_u32 s48, s48, 131072
  s_and_b32 s48, s48, 2097151
  s_add_u32 m0, s55, 81920
  s_nop 0
  buffer_load_dwordx4 v10, s[20:23], s49 offen lds
  buffer_load_dwordx4 v11, s[20:23], s49 offen offset:1024 lds
  buffer_load_dwordx4 v12, s[20:23], s49 offen offset:2048 lds
  buffer_load_dwordx4 v13, s[20:23], s49 offen offset:3072 lds
  s_add_u32 s49, s49, 128
  s_and_b32 s49, s49, 2047
  s_waitcnt vmcnt(6)
  s_barrier
  s_add_u32 m0, s46, 32768
  s_nop 0
  buffer_load_dwordx4 v8, s[16:19], s48 offen lds
  buffer_load_dwordx4 v9, s[16:19], s48 offen offset:1024 lds
  s_add_u32 s48, s48, 131072
  s_and_b32 s48, s48, 2097151
  s_add_u32 m0, s55, 98304
  s_nop 0
  buffer_load_dwordx4 v10, s[20:23], s49 offen lds
  buffer_load_dwordx4 v11, s[20:23], s49 offen offset:1024 lds
  buffer_load_dwordx4 v12, s[20:23], s49 offen offset:2048 lds
  buffer_load_dwordx4 v13, s[20:23], s49 offen offset:3072 lds
  s_add_u32 s49, s49, 128
  s_and_b32 s49, s49, 2047
  s_waitcnt vmcnt(6)
  s_barrier
  s_add_u32 m0, s46, 49152
  s_nop 0
  buffer_load_dwordx4 v8, s[16:19], s48 offen lds
  buffer_load_dwordx4 v9, s[16:19], s48 offen offset:1024 lds
  s_add_u32 s48, s48, 131072
  s_and_b32 s48, s48, 2097151
  s_add_u32 m0, s55, 114688
  s_nop 0
  buffer_load_dwordx4 v10, s[20:23], s49 offen lds
  buffer_load_dwordx4 v11, s[20:23], s49 offen offset:1024 lds
  buffer_load_dwordx4 v12, s[20:23], s49 offen offset:2048 lds
  buffer_load_dwordx4 v13, s[20:23], s49 offen offset:3072 lds
  s_add_u32 s49, s49, 128
  s_and_b32 s49, s49, 2047
  s_waitcnt vmcnt(6)
  s_barrier
  s_cmp_lg_u32 s3, 0
  s_cbranch_scc1 L_ahkA
  buffer_load_dwordx4 v[28:31], v24, s[32:35], 0 offen sc1
L_ahkA:
  s_waitcnt vmcnt(0)
  s_cmp_lg_u32 s3, 0
  s_cbranch_scc1 L_chkA
  s_mov_b32 s62, 0x40000
L_phkA:
  v_xor_b32 v28, v27, v28
  v_xor_b32 v29, v27, v29
  v_xor_b32 v30, v27, v30
  v_xor_b32 v31, v27, v31
  v_or3_b32 v28, v28, v29, v30
  v_or_b32 v28, v28, v31
  v_cmp_ne_u32 vcc, 0, v28
  s_nop 4
  s_cbranch_vccz L_chkA
  s_sleep 6
  buffer_load_dwordx4 v[28:31], v24, s[32:35], 0 offen sc1
  s_sub_u32 s62, s62, 1
  s_cmp_lg_u32 s62, 0
  s_waitcnt vmcnt(0)
  s_cbranch_scc1 L_phkA
L_chkA:
  s_barrier
  s_waitcnt vmcnt(0)
  s_barrier
  s_cmp_lg_u32 s3, 0
  s_cbranch_scc1 L_akkA
  buffer_load_dword v32, v25, s[32:35], 0 offen sc1
L_akkA:
  s_waitcnt vmcnt(0)
  s_cmp_lg_u32 s3, 0
  s_cbranch_scc1 L_ckkA
  s_mov_b32 s62, 0x40000
L_pkkA:
  v_cmp_ne_u32 vcc, v27, v32
  s_nop 4
  s_cbranch_vccz L_ckkA
  s_sleep 6
  buffer_load_dword v32, v25, s[32:35], 0 offen sc1
  s_sub_u32 s62, s62, 1
  s_cmp_lg_u32 s62, 0
  s_waitcnt vmcnt(0)
  s_cbranch_scc1 L_pkkA
L_ckkA:
  s_barrier
  s_add_u32 m0, s46, 147456
  s_nop 0
  buffer_load_dwordx4 v3, s[68:71], s54 offen sc1 lds
  buffer_load_dwordx4 v3, s[68:71], s54 offen offset:1024 sc1 lds
  s_add_u32 s54, s54, 4096
  s_add_u32 m0, s46, 155648
  s_nop 0
  buffer_load_dwordx4 v3, s[68:71], s54 offen sc1 lds
  buffer_load_dwordx4 v3, s[68:71], s54 offen offset:1024 sc1 lds
  s_add_u32 s54, s54, 4096
  s_waitcnt vmcnt(2)
  s_barrier
  s_add_u32 m0, s46, 131072
  s_nop 0
  buffer_load_dwordx4 v3, s[68:71], s54 offen sc1 lds
  buffer_load_dwordx4 v3, s[68:71], s54 offen offset:1024 sc1 lds
  s_add_u32 s54, s54, 4096
  s_waitcnt vmcnt(2)
  s_barrier
  s_add_u32 m0, s46, 139264
  s_nop 0
  buffer_load_dwordx4 v3, s[68:71], s54 offen sc1 lds
  buffer_load_dwordx4 v3, s[68:71], s54 offen offset:1024 sc1 lds
  s_add_u32 s54, s54, 4096
  s_waitcnt vmcnt(2)
  s_barrier
  s_lshl_b32 s8, s44, 3
  s_lshr_b32 s9, s45, 2
  s_add_u32 s8, s8, s9
  s_lshl_b32 s8, s8, 7
  s_and_b32 s9, s45, 3
  s_lshl_b32 s9, s9, 2
  s_add_u32 s8, s8, s9
  s_add_u32 s8, s8, 12288
  s_sub_u32 s9, s2, 224
  s_lshl_b32 s9, s9, 7
  s_add_u32 s9, s9, 8196
  s_cmp_lt_u32 s2, 224
  s_cselect_b32 s8, s8, s9
  s_lshl_b32 s9, s43, 7
  s_lshl_b32 s10, s42, 2
  s_add_u32 s9, s9, s10
  s_add_u32 s9, s9, 20480
  s_load_dwordx2 s[10:11], s[0:1], 64
  s_load_dwordx2 s[40:41], s[0:1], 32
  s_bfe_u32 s14, s2, 0x10002
  s_bfe_u32 s42, s2, 0x30003
  s_and_b32 s43, s2, 3
  s_lshl_b32 s43, s43, 2
  s_lshr_b32 s44, s2, 6
  s_add_u32 s43, s43, s44
  s_add_u32 s15, s42, s43
  s_add_u32 s15, s15, s14
  s_and_b32 s15, s15, 1
  s_mul_i32 s49, s15, 2
  s_lshl_b32 s44, s42, 7
  s_lshl_b32 s45, s43, 7
  s_lshl_b32 s62, s42, 2
  s_lshl_b32 s63, s43, 2
  s_add_u32 s60, s62, s3
  s_mul_i32 s60, s60, 229376
  v_lshlrev_b32 v8, 4, v2
  v_add_u32 v8, s60, v8
  v_lshrrev_b32 v4, 4, v2
  v_and_b32 v5, 15, v2
  v_lshlrev_b32 v10, 1, v4
  v_xor_b32 v5, v5, v10
  s_mov_b32 s60, 4096
  v_mul_lo_u32 v4, v4, s60
  s_mul_i32 s60, s3, 65536
  s_lshl_b32 s61, s45, 1
  s_add_u32 s60, s60, s61
  v_add_u32 v4, s60, v4
  v_lshl_add_u32 v10, v5, 4, v4
  v_xor_b32 v5, 8, v5
  v_lshl_add_u32 v4, v5, 4, v4
  v_add_u32 v11, 15360, v4
  v_add_u32 v12, 30720, v10
  v_add_u32 v13, 46080, v4
  v_lshrrev_b32 v4, 4, v2
  v_and_b32 v5, 15, v2
  v_lshlrev_b32 v36, 1, v4
  v_xor_b32 v5, v5, v36
  s_mov_b32 s60, 2048
  v_mul_lo_u32 v4, v4, s60
  s_mul_i32 s60, s3, 32768
  s_lshl_b32 s61, s44, 1
  s_add_u32 s60, s60, s61
  v_add_u32 v4, s60, v4
  v_lshl_add_u32 v36, v5, 4, v4
  v_xor_b32 v5, 8, v5
  v_lshl_add_u32 v4, v5, 4, v4
  v_add_u32 v37, 7168, v4
  v_add_u32 v38, 14336, v36
  v_add_u32 v39, 21504, v4
  s_add_u32 s60, s63, s3
  s_mul_i32 s60, s60, 65536
  v_lshlrev_b32 v9, 4, v2
  v_add_u32 v9, s60, v9
  s_lshl_b32 s60, s49, 2
  s_sub_u32 s48, 39, s60
  s_add_u32 s51, s60, 32
  s_cmp_eq_u32 s14, 0
  s_cselect_b32 s60, s48, s51
  s_cselect_b32 s13, -1, 1
  s_mul_i32 s48, s60, 4096
  s_mul_i32 s51, s60, 262144
  s_mul_i32 s12, s13, 4096
  s_mul_i32 s13, s13, 262144
  s_mov_b32 s47, 0
  s_mov_b32 s63, 0
  v_min_u32 v33, 6, v2
  v_lshlrev_b32 v33, 7, v33
  s_lshl_b32 s60, s42, 10
  s_add_u32 s60, s60, 12288
  v_add_u32 v33, s60, v33
  v_and_b32 v34, 15, v2
  v_lshlrev_b32 v34, 2, v34
  s_lshl_b32 s60, s43, 7
  s_add_u32 s60, s60, 20480
  v_add_u32 v34, s60, v34
  s_waitcnt lgkmcnt(0)
  s_add_u32 s16, s38, 16777216
  s_addc_u32 s17, s39, 0
  s_mov_b32 s18, 7340032
  s_mov_b32 s19, 0x00020000
  s_mov_b32 s20, s10
  s_mov_b32 s21, s11
  s_mov_b32 s22, 14680064
  s_mov_b32 s23, 0x00020000
  s_mov_b32 s24, s40
  s_mov_b32 s25, s41
  s_mov_b32 s26, 2097152
  s_mov_b32 s27, 0x00020000
  s_add_u32 s4, s38, 12582912
  s_addc_u32 s5, s39, 0
  s_mov_b32 s6, 4194304
  s_mov_b32 s7, 0x00020000
  s_add_u32 m0, s46, 147456
  s_nop 0
  buffer_load_dwordx4 v3, s[68:71], s54 offen sc1 lds
  buffer_load_dwordx4 v3, s[68:71], s54 offen offset:1024 sc1 lds
  s_add_u32 s54, s54, 4096
  s_waitcnt vmcnt(2)
  s_barrier
  s_add_u32 m0, s46, 155648
  s_nop 0
  buffer_load_dwordx4 v3, s[68:71], s54 offen sc1 lds
  buffer_load_dwordx4 v3, s[68:71], s54 offen offset:1024 sc1 lds
  s_add_u32 s54, s54, 4096
  s_add_u32 m0, s46, 131072
  s_nop 0
  buffer_load_dwordx4 v3, s[68:71], s54 offen sc1 lds
  buffer_load_dwordx4 v3, s[68:71], s54 offen offset:1024 sc1 lds
  s_add_u32 s54, s54, 4096
  s_mov_b32 s50, 3
Lk_LD2:
  s_waitcnt vmcnt(4)
  s_barrier
  s_add_u32 m0, s46, 139264
  s_nop 0
  buffer_load_dwordx4 v3, s[68:71], s54 offen sc1 lds
  buffer_load_dwordx4 v3, s[68:71], s54 offen offset:1024 sc1 lds
  s_add_u32 s54, s54, 4096
  s_waitcnt vmcnt(4)
  s_barrier
  s_add_u32 m0, s46, 147456
  s_nop 0
  buffer_load_dwordx4 v3, s[68:71], s54 offen sc1 lds
  buffer_load_dwordx4 v3, s[68:71], s54 offen offset:1024 sc1 lds
  s_add_u32 s54, s54, 4096
  s_waitcnt vmcnt(4)
  s_barrier
  s_add_u32 m0, s46, 155648
  s_nop 0
  buffer_load_dwordx4 v3, s[68:71], s54 offen sc1 lds
  buffer_load_dwordx4 v3, s[68:71], s54 offen offset:1024 sc1 lds
  s_add_u32 s54, s54, 4096
  s_waitcnt vmcnt(4)
  s_barrier
  s_add_u32 m0, s46, 131072
  s_nop 0
  buffer_load_dwordx4 v3, s[68:71], s54 offen sc1 lds
  buffer_load_dwordx4 v3, s[68:71], s54 offen offset:1024 sc1 lds
  s_add_u32 s54, s54, 4096
  s_sub_u32 s50, s50, 1
  s_cmp_lg_u32 s50, 0
  s_cbranch_scc1 Lk_LD2
  s_waitcnt vmcnt(4)
  s_barrier
  s_add_u32 m0, s46, 139264
  s_nop 0
  buffer_load_dwordx4 v3, s[68:71], s54 offen sc1 lds
  buffer_load_dwordx4 v3, s[68:71], s54 offen offset:1024 sc1 lds
  s_add_u32 s54, s54, 4096
  s_waitcnt vmcnt(4)
  s_barrier
  s_add_u32 m0, s46, 147456
  s_nop 0
  buffer_load_dwordx4 v3, s[68:71], s54 offen sc1 lds
  buffer_load_dwordx4 v3, s[68:71], s54 offen offset:1024 sc1 lds
  s_add_u32 s54, s54, 4096
  s_waitcnt vmcnt(4)
  s_barrier
  s_cmp_lg_u32 s3, 0
  s_cbranch_scc1 L_fukA
  s_mov_b64 exec, 1
  buffer_store_dword v27, v23, s[32:35], s8 offen sc1
  s_mov_b64 exec, -1
L_fukA:
  s_add_u32 m0, s46, 155648
  s_nop 0
  buffer_load_dwordx4 v3, s[68:71], s54 offen sc1 lds
  buffer_load_dwordx4 v3, s[68:71], s54 offen offset:1024 sc1 lds
  s_add_u32 s54, s54, 4096
  s_mov_b32 s50, 2
Lk_LD3:
  s_waitcnt vmcnt(4)
  s_barrier
  s_add_u32 m0, s46, 131072
  s_nop 0
  buffer_load_dwordx4 v3, s[68:71], s54 offen sc1 lds
  buffer_load_dwordx4 v3, s[68:71], s54 offen offset:1024 sc1 lds
  s_add_u32 s54, s54, 4096
  s_waitcnt vmcnt(4)
  s_barrier
  s_add_u32 m0, s46, 139264
  s_nop 0
  buffer_load_dwordx4 v3, s[68:71], s54 offen sc1 lds
  buffer_load_dwordx4 v3, s[68:71], s54 offen offset:1024 sc1 lds
  s_add_u32 s54, s54, 4096
  s_waitcnt vmcnt(4)
  s_barrier
  s_add_u32 m0, s46, 147456
  s_nop 0
  buffer_load_dwordx4 v3, s[68:71], s54 offen sc1 lds
  buffer_load_dwordx4 v3, s[68:71], s54 offen offset:1024 sc1 lds
  s_add_u32 s54, s54, 4096
  s_waitcnt vmcnt(4)
  s_barrier
  s_add_u32 m0, s46, 155648
  s_nop 0
  buffer_load_dwordx4 v3, s[68:71], s54 offen sc1 lds
  buffer_load_dwordx4 v3, s[68:71], s54 offen offset:1024 sc1 lds
  s_add_u32 s54, s54, 4096
  s_sub_u32 s50, s50, 1
  s_cmp_lg_u32 s50, 0
  s_cbranch_scc1 Lk_LD3
  s_waitcnt vmcnt(4)
  s_barrier
  s_add_u32 m0, s46, 131072
  s_nop 0
  buffer_load_dwordx4 v3, s[68:71], s54 offen sc1 lds
  buffer_load_dwordx4 v3, s[68:71], s54 offen offset:1024 sc1 lds
  s_add_u32 s54, s54, 4096
  s_waitcnt vmcnt(4)
  s_barrier
  s_add_u32 m0, s46, 139264
  s_nop 0
  buffer_load_dwordx4 v3, s[68:71], s54 offen sc1 lds
  buffer_load_dwordx4 v3, s[68:71], s54 offen offset:1024 sc1 lds
  s_add_u32 s54, s54, 4096
  s_waitcnt vmcnt(4)
  s_barrier
  s_add_u32 m0, s46, 147456
  s_nop 0
  buffer_load_dwordx4 v3, s[68:71], s54 offen sc1 lds
  buffer_load_dwordx4 v3, s[68:71], s54 offen offset:1024 sc1 lds
  s_add_u32 s54, s54, 4096
  s_waitcnt vmcnt(4)
  s_barrier
  s_cmp_lg_u32 s3, 0
  s_cbranch_scc1 L_askA
  buffer_load_dword v32, v25, s[32:35], 0 offen offset:4 sc1
L_askA:
  s_waitcnt vmcnt(0)
  s_cmp_lg_u32 s3, 0
  s_cbranch_scc1 L_cskA
  s_mov_b32 s62, 0x40000
L_pskA:
  v_cmp_ne_u32 vcc, v27, v32
  s_nop 4
  s_cbranch_vccz L_cskA
  s_sleep 6
  buffer_load_dword v32, v25, s[32:35], 0 offen offset:4 sc1
  s_sub_u32 s62, s62, 1
  s_cmp_lg_u32 s62, 0
  s_waitcnt vmcnt(0)
  s_cbranch_scc1 L_pskA
L_cskA:
  s_barrier
  s_waitcnt vmcnt(0)
  s_barrier
  s_cmp_lg_u32 s3, 0
  s_cbranch_scc1 L_aukA
  buffer_load_dwordx4 v[28:31], v33, s[32:35], 0 offen sc1
L_aukA:
  s_add_u32 m0, s55, 65536
  s_nop 0
  buffer_load_dwordx4 v10, s[20:23], s51 offen lds
  buffer_load_dwordx4 v11, s[20:23], s51 offen offset:1024 lds
  buffer_load_dwordx4 v12, s[20:23], s51 offen offset:2048 lds
  buffer_load_dwordx4 v13, s[20:23], s51 offen offset:3072 lds
  s_add_u32 s51, s51, s13
  s_waitcnt vmcnt(4)
  s_cmp_lg_u32 s3, 0
  s_cbranch_scc1 L_cukA
  s_mov_b32 s62, 0x40000
L_pukA:
  v_xor_b32 v28, v27, v28
  v_xor_b32 v29, v27, v29
  v_xor_b32 v30, v27, v30
  v_xor_b32 v31, v27, v31
  v_or3_b32 v28, v28, v29, v30
  v_or_b32 v28, v28, v31
  v_cmp_ne_u32 vcc, 0, v28
  s_nop 4
  s_cbranch_vccz L_cukA
  s_sleep 6
  buffer_load_dwordx4 v[28:31], v33, s[32:35], 0 offen sc1
  s_sub_u32 s62, s62, 1
  s_cmp_lg_u32 s62, 0
  s_waitcnt vmcnt(0)
  s_cbranch_scc1 L_pukA
L_cukA:
  s_barrier
  s_add_u32 m0, s55, 0
  s_nop 0
  buffer_load_dwordx4 v8, s[16:19], s48 offen sc1 lds
  buffer_load_dwordx4 v8, s[16:19], s48 offen offset:1024 sc1 lds
  buffer_load_dwordx4 v8, s[16:19], s48 offen offset:2048 sc1 lds
  buffer_load_dwordx4 v8, s[16:19], s48 offen offset:3072 sc1 lds
  s_add_u32 s48, s48, s12
  s_add_u32 m0, s55, 81920
  s_nop 0
  buffer_load_dwordx4 v10, s[20:23], s51 offen lds
  buffer_load_dwordx4 v11, s[20:23], s51 offen offset:1024 lds
  buffer_load_dwordx4 v12, s[20:23], s51 offen offset:2048 lds
  buffer_load_dwordx4 v13, s[20:23], s51 offen offset:3072 lds
  s_add_u32 s51, s51, s13
  s_add_u32 m0, s55, 16384
  s_nop 0
  buffer_load_dwordx4 v8, s[16:19], s48 offen sc1 lds
  buffer_load_dwordx4 v8, s[16:19], s48 offen offset:1024 sc1 lds
  buffer_load_dwordx4 v8, s[16:19], s48 offen offset:2048 sc1 lds
  buffer_load_dwordx4 v8, s[16:19], s48 offen offset:3072 sc1 lds
  s_add_u32 s48, s48, s12
  s_waitcnt vmcnt(8)
  s_barrier
  s_add_u32 m0, s55, 98304
  s_nop 0
  buffer_load_dwordx4 v10, s[20:23], s51 offen lds
  buffer_load_dwordx4 v11, s[20:23], s51 offen offset:1024 lds
  buffer_load_dwordx4 v12, s[20:23], s51 offen offset:2048 lds
  buffer_load_dwordx4 v13, s[20:23], s51 offen offset:3072 lds
  s_add_u32 s51, s51, s13
  s_add_u32 m0, s55, 32768
  s_nop 0
  buffer_load_dwordx4 v8, s[16:19], s48 offen sc1 lds
  buffer_load_dwordx4 v8, s[16:19], s48 offen offset:1024 sc1 lds
  buffer_load_dwordx4 v8, s[16:19], s48 offen offset:2048 sc1 lds
  buffer_load_dwordx4 v8, s[16:19], s48 offen offset:3072 sc1 lds
  s_add_u32 s48, s48, s12
  s_waitcnt vmcnt(8)
  s_barrier
  s_cmp_lg_u32 s3, 0
  s_cbranch_scc1 L_fokA
  s_mov_b64 exec, 1
  buffer_store_dword v27, v23, s[32:35], s9 offen sc1
  s_mov_b64 exec, -1
L_fokA:
  s_add_u32 m0, s55, 114688
  s_nop 0
  buffer_load_dwordx4 v10, s[20:23], s51 offen lds
  buffer_load_dwordx4 v11, s[20:23], s51 offen offset:1024 lds
  buffer_load_dwordx4 v12, s[20:23], s51 offen offset:2048 lds
  buffer_load_dwordx4 v13, s[20:23], s51 offen offset:3072 lds
  s_add_u32 s51, s51, s13
  s_add_u32 m0, s55, 49152
  s_nop 0
  buffer_load_dwordx4 v8, s[16:19], s48 offen sc1 lds
  buffer_load_dwordx4 v8, s[16:19], s48 offen offset:1024 sc1 lds
  buffer_load_dwordx4 v8, s[16:19], s48 offen offset:2048 sc1 lds
  buffer_load_dwordx4 v8, s[16:19], s48 offen offset:3072 sc1 lds
  s_add_u32 s48, s48, s12
  s_waitcnt vmcnt(8)
  s_barrier
  s_add_u32 m0, s55, 65536
  s_nop 0
  buffer_load_dwordx4 v10, s[20:23], s51 offen lds
  buffer_load_dwordx4 v11, s[20:23], s51 offen offset:1024 lds
  buffer_load_dwordx4 v12, s[20:23], s51 offen offset:2048 lds
  buffer_load_dwordx4 v13, s[20:23], s51 offen offset:3072 lds
  s_add_u32 s51, s51, s13
  s_add_u32 m0, s55, 0
  s_nop 0
  buffer_load_dwordx4 v8, s[16:19], s48 offen sc1 lds
  buffer_load_dwordx4 v8, s[16:19], s48 offen offset:1024 sc1 lds
  buffer_load_dwordx4 v8, s[16:19], s48 offen offset:2048 sc1 lds
  buffer_load_dwordx4 v8, s[16:19], s48 offen offset:3072 sc1 lds
  s_add_u32 s48, s48, s12
  s_waitcnt vmcnt(8)
  s_barrier
  s_add_u32 m0, s55, 81920
  s_nop 0
  buffer_load_dwordx4 v10, s[20:23], s51 offen lds
  buffer_load_dwordx4 v11, s[20:23], s51 offen offset:1024 lds
  buffer_load_dwordx4 v12, s[20:23], s51 offen offset:2048 lds
  buffer_load_dwordx4 v13, s[20:23], s51 offen offset:3072 lds
  s_add_u32 s51, s51, s13
  s_add_u32 m0, s55, 16384
  s_nop 0
  buffer_load_dwordx4 v8, s[16:19], s48 offen sc1 lds
  buffer_load_dwordx4 v8, s[16:19], s48 offen offset:1024 sc1 lds
  buffer_load_dwordx4 v8, s[16:19], s48 offen offset:2048 sc1 lds
  buffer_load_dwordx4 v8, s[16:19], s48 offen offset:3072 sc1 lds
  s_add_u32 s48, s48, s12
  s_waitcnt vmcnt(8)
  s_barrier
  s_add_u32 m0, s55, 98304
  s_nop 0
  buffer_load_dwordx4 v10, s[20:23], s51 offen lds
  buffer_load_dwordx4 v11, s[20:23], s51 offen offset:1024 lds
  buffer_load_dwordx4 v12, s[20:23], s51 offen offset:2048 lds
  buffer_load_dwordx4 v13, s[20:23], s51 offen offset:3072 lds
  s_add_u32 s51, s51, s13
  s_add_u32 m0, s55, 32768
  s_nop 0
  buffer_load_dwordx4 v8, s[16:19], s48 offen sc1 lds
  buffer_load_dwordx4 v8, s[16:19], s48 offen offset:1024 sc1 lds
  buffer_load_dwordx4 v8, s[16:19], s48 offen offset:2048 sc1 lds
  buffer_load_dwordx4 v8, s[16:19], s48 offen offset:3072 sc1 lds
  s_add_u32 s48, s48, s12
  s_waitcnt vmcnt(8)
  s_barrier
  s_add_u32 m0, s55, 114688
  s_nop 0
  buffer_load_dwordx4 v10, s[20:23], s51 offen lds
  buffer_load_dwordx4 v11, s[20:23], s51 offen offset:1024 lds
  buffer_load_dwordx4 v12, s[20:23], s51 offen offset:2048 lds
  buffer_load_dwordx4 v13, s[20:23], s51 offen offset:3072 lds
  s_add_u32 s51, s51, s13
  s_add_u32 m0, s55, 49152
  s_nop 0
  buffer_load_dwordx4 v8, s[16:19], s48 offen sc1 lds
  buffer_load_dwordx4 v8, s[16:19], s48 offen offset:1024 sc1 lds
  buffer_load_dwordx4 v8, s[16:19], s48 offen offset:2048 sc1 lds
  buffer_load_dwordx4 v8, s[16:19], s48 offen offset:3072 sc1 lds
  s_add_u32 s48, s48, s12
  s_branch L_ld2
L_nld:
  s_cmp_lt_u32 s3, 12
  s_cbranch_scc1 L_attn
  s_and_b32 s51, s3, 3
  v_bfe_u32 v16, v2, 2, 2
  v_lshrrev_b32 v17, 4, v2
  v_lshl_add_u32 v16, v17, 3, v16
  v_lshlrev_b32 v16, 7, v16
  v_and_b32 v17, 3, v2
  v_lshl_add_u32 v16, v17, 3, v16
  v_bfe_u32 v17, v2, 3, 2
  v_lshl_add_u32 v8, v17, 5, v16
  v_xor_b32 v18, 1, v17
  v_lshl_add_u32 v9, v18, 5, v16
  v_xor_b32 v18, 2, v17
  v_lshl_add_u32 v10, v18, 5, v16
  v_xor_b32 v18, 3, v17
  v_lshl_add_u32 v11, v18, 5, v16
  v_and_b32 v16, 15, v2
  v_lshlrev_b32 v16, 7, v16
  s_lshl_b32 s48, s51, 12
  s_add_u32 s48, s48, 65536
  v_add_u32 v16, s48, v16
  v_bfe_u32 v17, v2, 1, 3
  v_lshrrev_b32 v18, 4, v2
  v_xor_b32 v17, v17, v18
  v_lshl_add_u32 v12, v17, 4, v16
  v_xor_b32 v17, 4, v17
  v_lshl_add_u32 v13, v17, 4, v16
  v_lshrrev_b32 v16, 5, v2
  v_lshlrev_b32 v16, 10, v16
  v_bfe_u32 v17, v2, 4, 1
  v_lshl_add_u32 v0, v17, 9, v16
  v_and_b32 v17, 15, v2
  v_lshl_add_u32 v1, v17, 4, v0
  s_cmp_ge_u32 s2, 224
  s_cbranch_scc1 L_kvw
  s_and_b32 s46, s3, 1
  s_bfe_u32 s47, s3, 0x10001
  s_lshl_b32 s52, s45, 1
  s_add_u32 s52, s52, s46
  s_lshl_b32 s52, s52, 7
  s_add_u32 s53, s52, 64
  s_waitcnt lgkmcnt(0)
  s_load_dwordx16 s[16:31], s[14:15], s52
  s_load_dwordx16 s[56:71], s[14:15], s53
  s_add_u32 s32, s38, 16777216
  s_addc_u32 s33, s39, 0
  s_mov_b32 s34, 7340032
  s_mov_b32 s35, 0x00020000
  v_bfe_u32 v16, v2, 2, 2
  v_lshrrev_b32 v17, 4, v2
  v_lshl_add_u32 v16, v17, 3, v16
  v_lshlrev_b32 v16, 8, v16
  v_and_b32 v17, 3, v2
  v_lshl_add_u32 v16, v17, 3, v16
  v_bfe_u32 v17, v2, 2, 3
  s_lshl_b32 s48, s46, 2
  v_xor_b32 v17, s48, v17
  v_lshl_add_u32 v4, v17, 5, v16
  v_xor_b32 v18, 1, v17
  v_lshl_add_u32 v5, v18, 5, v16
  v_xor_b32 v18, 2, v17
  v_lshl_add_u32 v6, v18, 5, v16
  v_xor_b32 v18, 3, v17
  v_lshl_add_u32 v7, v18, 5, v16
  s_lshl_b32 s48, s47, 13
  s_add_u32 s48, s48, 65536
  v_lshlrev_b32 v15, 4, v2
  v_add_u32 v15, s48, v15
  s_lshl_b32 s54, s44, 1
  s_add_u32 s54, s54, s47
  s_mul_i32 s54, s54, 112
  s_lshl_b32 s55, s45, 1
  s_add_u32 s54, s54, s55
  s_add_u32 s54, s54, s46
  s_lshl_b32 s54, s54, 12
  s_add_u32 s55, s54, 229376
  s_mov_b32 s52, 0xbdd2d3e8
  s_mov_b32 s53, 0xbdd2d3e8
  v_mov_b32 v64, 0
  v_mov_b32 v65, 0
  v_mov_b32 v66, 0
  v_mov_b32 v67, 0
  v_mov_b32 v68, 0
  v_mov_b32 v69, 0
  v_mov_b32 v70, 0
  v_mov_b32 v71, 0
  v_mov_b32 v72, 0
  v_mov_b32 v73, 0
  v_mov_b32 v74, 0
  v_mov_b32 v75, 0
  v_mov_b32 v76, 0
  v_mov_b32 v77, 0
  v_mov_b32 v78, 0
  v_mov_b32 v79, 0
  v_mov_b32 v80, 0
  v_mov_b32 v81, 0
  v_mov_b32 v82, 0
  v_mov_b32 v83, 0
  v_mov_b32 v84, 0
  v_mov_b32 v85, 0
  v_mov_b32 v86, 0
  v_mov_b32 v87, 0
  v_mov_b32 v88, 0
  v_mov_b32 v89, 0
  v_mov_b32 v90, 0
  v_mov_b32 v91, 0
  v_mov_b32 v92, 0
  v_mov_b32 v93, 0
  v_mov_b32 v94, 0
  v_mov_b32 v95, 0
  s_waitcnt lgkmcnt(0)
  v_mov_b32 v112, s16
  v_mov_b32 v113, s17
  v_mov_b32 v114, s24
  v_mov_b32 v115, s25
  v_mov_b32 v116, s56
  v_mov_b32 v117, s57
  v_mov_b32 v118, s64
  v_mov_b32 v119, s65
  s_lshl_b64 exec, -1, 16
  v_mov_b32 v112, s18
  v_mov_b32 v113, s19
  v_mov_b32 v114, s26
  v_mov_b32 v115, s27
  v_mov_b32 v116, s58
  v_mov_b32 v117, s59
  v_mov_b32 v118, s66
  v_mov_b32 v119, s67
  s_lshl_b64 exec, -1, 32
  v_mov_b32 v112, s20
  v_mov_b32 v113, s21
  v_mov_b32 v114, s28
  v_mov_b32 v115, s29
  v_mov_b32 v116, s60
  v_mov_b32 v117, s61
  v_mov_b32 v118, s68
  v_mov_b32 v119, s69
  s_lshl_b64 exec, -1, 48
  v_mov_b32 v112, s22
  v_mov_b32 v113, s23
  v_mov_b32 v114, s30
  v_mov_b32 v115, s31
  v_mov_b32 v116, s62
  v_mov_b32 v117, s63
  v_mov_b32 v118, s70
  v_mov_b32 v119, s71
  s_mov_b64 exec, -1
  s_barrier
  ds_read_b128 v[48:51], v12 offset:0
  ds_read_b128 v[52:55], v13 offset:0
  ds_read_b128 v[56:59], v12 offset:2048
  ds_read_b128 v[60:63], v13 offset:2048
  ds_read_b64_tr_b16 v[16:17], v8 offset:0
  ds_read_b64_tr_b16 v[18:19], v8 offset:512
  ds_read_b64_tr_b16 v[20:21], v8 offset:4096
  ds_read_b64_tr_b16 v[22:23], v8 offset:4608
  ds_read_b64_tr_b16 v[24:25], v9 offset:0
  ds_read_b64_tr_b16 v[26:27], v9 offset:512
  ds_read_b64_tr_b16 v[28:29], v9 offset:4096
  ds_read_b64_tr_b16 v[30:31], v9 offset:4608
  ds_read_b64_tr_b16 v[32:33], v10 offset:0
  ds_read_b64_tr_b16 v[34:35], v10 offset:512
  ds_read_b64_tr_b16 v[36:37], v10 offset:4096
  ds_read_b64_tr_b16 v[38:39], v10 offset:4608
  ds_read_b64_tr_b16 v[40:41], v11 offset:0
  ds_read_b64_tr_b16 v[42:43], v11 offset:512
  ds_read_b64_tr_b16 v[44:45], v11 offset:4096
  ds_read_b64_tr_b16 v[46:47], v11 offset:4608
  s_waitcnt lgkmcnt(0)
  s_mov_b32 s50, 3
.p2align 6
Ln_LQ:
  s_waitcnt lgkmcnt(14)
  v_mfma_f32_16x16x32_bf16 v[64:67], v[16:19], v[48:51], v[64:67]
  s_waitcnt lgkmcnt(12)
  v_mfma_f32_16x16x32_bf16 v[64:67], v[20:23], v[52:55], v[64:67]
  v_mfma_f32_16x16x32_bf16 v[68:71], v[16:19], v[56:59], v[68:71]
  v_mfma_f32_16x16x32_bf16 v[68:71], v[20:23], v[60:63], v[68:71]
  s_waitcnt lgkmcnt(0)
  s_barrier
  v_mfma_f32_16x16x32_bf16 v[72:75], v[24:27], v[48:51], v[72:75]
  ds_read_b128 v[96:99], v12 offset:16384
  ds_read_b128 v[100:103], v13 offset:16384
  v_mfma_f32_16x16x32_bf16 v[72:75], v[28:31], v[52:55], v[72:75]
  ds_read_b128 v[104:107], v12 offset:18432
  ds_read_b128 v[108:111], v13 offset:18432
  v_mfma_f32_16x16x32_bf16 v[76:79], v[24:27], v[56:59], v[76:79]
  ds_read_b64_tr_b16 v[16:17], v8 offset:16384
  ds_read_b64_tr_b16 v[18:19], v8 offset:16896
  v_mfma_f32_16x16x32_bf16 v[76:79], v[28:31], v[60:63], v[76:79]
  ds_read_b64_tr_b16 v[20:21], v8 offset:20480
  ds_read_b64_tr_b16 v[22:23], v8 offset:20992
  v_mfma_f32_16x16x32_bf16 v[80:83], v[32:35], v[48:51], v[80:83]
  ds_read_b64_tr_b16 v[24:25], v9 offset:16384
  ds_read_b64_tr_b16 v[26:27], v9 offset:16896
  v_mfma_f32_16x16x32_bf16 v[80:83], v[36:39], v[52:55], v[80:83]
  ds_read_b64_tr_b16 v[28:29], v9 offset:20480
  ds_read_b64_tr_b16 v[30:31], v9 offset:20992
  v_mfma_f32_16x16x32_bf16 v[84:87], v[32:35], v[56:59], v[84:87]
  v_mfma_f32_16x16x32_bf16 v[84:87], v[36:39], v[60:63], v[84:87]
  v_mfma_f32_16x16x32_bf16 v[88:91], v[40:43], v[48:51], v[88:91]
  ds_read_b64_tr_b16 v[32:33], v10 offset:16384
  ds_read_b64_tr_b16 v[34:35], v10 offset:16896
  v_mfma_f32_16x16x32_bf16 v[88:91], v[44:47], v[52:55], v[88:91]
  ds_read_b64_tr_b16 v[36:37], v10 offset:20480
  ds_read_b64_tr_b16 v[38:39], v10 offset:20992
  v_mfma_f32_16x16x32_bf16 v[92:95], v[40:43], v[56:59], v[92:95]
  v_mfma_f32_16x16x32_bf16 v[92:95], v[44:47], v[60:63], v[92:95]
  ds_read_b64_tr_b16 v[40:41], v11 offset:16384
  ds_read_b64_tr_b16 v[42:43], v11 offset:16896
  ds_read_b64_tr_b16 v[44:45], v11 offset:20480
  ds_read_b64_tr_b16 v[46:47], v11 offset:20992
  s_waitcnt lgkmcnt(14)
  v_mfma_f32_16x16x32_bf16 v[64:67], v[16:19], v[96:99], v[64:67]
  s_waitcnt lgkmcnt(12)
  v_mfma_f32_16x16x32_bf16 v[64:67], v[20:23], v[100:103], v[64:67]
  v_mfma_f32_16x16x32_bf16 v[68:71], v[16:19], v[104:107], v[68:71]
  v_mfma_f32_16x16x32_bf16 v[68:71], v[20:23], v[108:111], v[68:71]
  s_waitcnt lgkmcnt(0)
  s_barrier
  v_mfma_f32_16x16x32_bf16 v[72:75], v[24:27], v[96:99], v[72:75]
  ds_read_b128 v[48:51], v12 offset:32768
  ds_read_b128 v[52:55], v13 offset:32768
  v_mfma_f32_16x16x32_bf16 v[72:75], v[28:31], v[100:103], v[72:75]
  ds_read_b128 v[56:59], v12 offset:34816
  ds_read_b128 v[60:63], v13 offset:34816
  v_mfma_f32_16x16x32_bf16 v[76:79], v[24:27], v[104:107], v[76:79]
  ds_read_b64_tr_b16 v[16:17], v8 offset:32768
  ds_read_b64_tr_b16 v[18:19], v8 offset:33280
  v_mfma_f32_16x16x32_bf16 v[76:79], v[28:31], v[108:111], v[76:79]
  ds_read_b64_tr_b16 v[20:21], v8 offset:36864
  ds_read_b64_tr_b16 v[22:23], v8 offset:37376
  v_mfma_f32_16x16x32_bf16 v[80:83], v[32:35], v[96:99], v[80:83]
  ds_read_b64_tr_b16 v[24:25], v9 offset:32768
  ds_read_b64_tr_b16 v[26:27], v9 offset:33280
  v_mfma_f32_16x16x32_bf16 v[80:83], v[36:39], v[100:103], v[80:83]
  ds_read_b64_tr_b16 v[28:29], v9 offset:36864
  ds_read_b64_tr_b16 v[30:31], v9 offset:37376
  v_mfma_f32_16x16x32_bf16 v[84:87], v[32:35], v[104:107], v[84:87]
  v_mfma_f32_16x16x32_bf16 v[84:87], v[36:39], v[108:111], v[84:87]
  v_mfma_f32_16x16x32_bf16 v[88:91], v[40:43], v[96:99], v[88:91]
  ds_read_b64_tr_b16 v[32:33], v10 offset:32768
  ds_read_b64_tr_b16 v[34:35], v10 offset:33280
  v_mfma_f32_16x16x32_bf16 v[88:91], v[44:47], v[100:103], v[88:91]
  ds_read_b64_tr_b16 v[36:37], v10 offset:36864
  ds_read_b64_tr_b16 v[38:39], v10 offset:37376
  v_mfma_f32_16x16x32_bf16 v[92:95], v[40:43], v[104:107], v[92:95]
  v_mfma_f32_16x16x32_bf16 v[92:95], v[44:47], v[108:111], v[92:95]
  ds_read_b64_tr_b16 v[40:41], v11 offset:32768
  ds_read_b64_tr_b16 v[42:43], v11 offset:33280
  ds_read_b64_tr_b16 v[44:45], v11 offset:36864
  ds_read_b64_tr_b16 v[46:47], v11 offset:37376
  s_waitcnt lgkmcnt(14)
  v_mfma_f32_16x16x32_bf16 v[64:67], v[16:19], v[48:51], v[64:67]
  s_waitcnt lgkmcnt(12)
  v_mfma_f32_16x16x32_bf16 v[64:67], v[20:23], v[52:55], v[64:67]
  v_mfma_f32_16x16x32_bf16 v[68:71], v[16:19], v[56:59], v[68:71]
  v_mfma_f32_16x16x32_bf16 v[68:71], v[20:23], v[60:63], v[68:71]
  s_waitcnt lgkmcnt(0)
  s_barrier
  v_mfma_f32_16x16x32_bf16 v[72:75], v[24:27], v[48:51], v[72:75]
  ds_read_b128 v[96:99], v12 offset:49152
  ds_read_b128 v[100:103], v13 offset:49152
  v_mfma_f32_16x16x32_bf16 v[72:75], v[28:31], v[52:55], v[72:75]
  ds_read_b128 v[104:107], v12 offset:51200
  ds_read_b128 v[108:111], v13 offset:51200
  v_mfma_f32_16x16x32_bf16 v[76:79], v[24:27], v[56:59], v[76:79]
  ds_read_b64_tr_b16 v[16:17], v8 offset:49152
  ds_read_b64_tr_b16 v[18:19], v8 offset:49664
  v_mfma_f32_16x16x32_bf16 v[76:79], v[28:31], v[60:63], v[76:79]
  ds_read_b64_tr_b16 v[20:21], v8 offset:53248
  ds_read_b64_tr_b16 v[22:23], v8 offset:53760
  v_mfma_f32_16x16x32_bf16 v[80:83], v[32:35], v[48:51], v[80:83]
  ds_read_b64_tr_b16 v[24:25], v9 offset:49152
  ds_read_b64_tr_b16 v[26:27], v9 offset:49664
  v_mfma_f32_16x16x32_bf16 v[80:83], v[36:39], v[52:55], v[80:83]
  ds_read_b64_tr_b16 v[28:29], v9 offset:53248
  ds_read_b64_tr_b16 v[30:31], v9 offset:53760
  v_mfma_f32_16x16x32_bf16 v[84:87], v[32:35], v[56:59], v[84:87]
  v_mfma_f32_16x16x32_bf16 v[84:87], v[36:39], v[60:63], v[84:87]
  v_mfma_f32_16x16x32_bf16 v[88:91], v[40:43], v[48:51], v[88:91]
  ds_read_b64_tr_b16 v[32:33], v10 offset:49152
  ds_read_b64_tr_b16 v[34:35], v10 offset:49664
  v_mfma_f32_16x16x32_bf16 v[88:91], v[44:47], v[52:55], v[88:91]
  ds_read_b64_tr_b16 v[36:37], v10 offset:53248
  ds_read_b64_tr_b16 v[38:39], v10 offset:53760
  v_mfma_f32_16x16x32_bf16 v[92:95], v[40:43], v[56:59], v[92:95]
  v_mfma_f32_16x16x32_bf16 v[92:95], v[44:47], v[60:63], v[92:95]
  ds_read_b64_tr_b16 v[40:41], v11 offset:49152
  ds_read_b64_tr_b16 v[42:43], v11 offset:49664
  ds_read_b64_tr_b16 v[44:45], v11 offset:53248
  ds_read_b64_tr_b16 v[46:47], v11 offset:53760
  s_waitcnt lgkmcnt(14)
  v_mfma_f32_16x16x32_bf16 v[64:67], v[16:19], v[96:99], v[64:67]
  s_waitcnt lgkmcnt(12)
  v_mfma_f32_16x16x32_bf16 v[64:67], v[20:23], v[100:103], v[64:67]
  v_mfma_f32_16x16x32_bf16 v[68:71], v[16:19], v[104:107], v[68:71]
  v_mfma_f32_16x16x32_bf16 v[68:71], v[20:23], v[108:111], v[68:71]
  s_waitcnt lgkmcnt(0)
  s_barrier
  v_mfma_f32_16x16x32_bf16 v[72:75], v[24:27], v[96:99], v[72:75]
  ds_read_b128 v[48:51], v12 offset:0
  ds_read_b128 v[52:55], v13 offset:0
  v_mfma_f32_16x16x32_bf16 v[72:75], v[28:31], v[100:103], v[72:75]
  ds_read_b128 v[56:59], v12 offset:2048
  ds_read_b128 v[60:63], v13 offset:2048
  v_mfma_f32_16x16x32_bf16 v[76:79], v[24:27], v[104:107], v[76:79]
  ds_read_b64_tr_b16 v[16:17], v8 offset:0
  ds_read_b64_tr_b16 v[18:19], v8 offset:512
  v_mfma_f32_16x16x32_bf16 v[76:79], v[28:31], v[108:111], v[76:79]
  ds_read_b64_tr_b16 v[20:21], v8 offset:4096
  ds_read_b64_tr_b16 v[22:23], v8 offset:4608
  s_sub_u32 s50, s50, 1
  s_cmp_lg_u32 s50, 0
  v_mfma_f32_16x16x32_bf16 v[80:83], v[32:35], v[96:99], v[80:83]
  ds_read_b64_tr_b16 v[24:25], v9 offset:0
  ds_read_b64_tr_b16 v[26:27], v9 offset:512
  v_mfma_f32_16x16x32_bf16 v[80:83], v[36:39], v[100:103], v[80:83]
  ds_read_b64_tr_b16 v[28:29], v9 offset:4096
  ds_read_b64_tr_b16 v[30:31], v9 offset:4608
  v_mfma_f32_16x16x32_bf16 v[84:87], v[32:35], v[104:107], v[84:87]
  v_mfma_f32_16x16x32_bf16 v[84:87], v[36:39], v[108:111], v[84:87]
  v_mfma_f32_16x16x32_bf16 v[88:91], v[40:43], v[96:99], v[88:91]
  ds_read_b64_tr_b16 v[32:33], v10 offset:0
  ds_read_b64_tr_b16 v[34:35], v10 offset:512
  v_mfma_f32_16x16x32_bf16 v[88:91], v[44:47], v[100:103], v[88:91]
  ds_read_b64_tr_b16 v[36:37], v10 offset:4096
  ds_read_b64_tr_b16 v[38:39], v10 offset:4608
  v_mfma_f32_16x16x32_bf16 v[92:95], v[40:43], v[104:107], v[92:95]
  v_mfma_f32_16x16x32_bf16 v[92:95], v[44:47], v[108:111], v[92:95]
  ds_read_b64_tr_b16 v[40:41], v11 offset:0
  ds_read_b64_tr_b16 v[42:43], v11 offset:512
  ds_read_b64_tr_b16 v[44:45], v11 offset:4096
  ds_read_b64_tr_b16 v[46:47], v11 offset:4608
  s_cbranch_scc1 Ln_LQ
  s_waitcnt lgkmcnt(14)
  v_mfma_f32_16x16x32_bf16 v[64:67], v[16:19], v[48:51], v[64:67]
  s_waitcnt lgkmcnt(12)
  v_mfma_f32_16x16x32_bf16 v[64:67], v[20:23], v[52:55], v[64:67]
  v_mfma_f32_16x16x32_bf16 v[68:71], v[16:19], v[56:59], v[68:71]
  v_mfma_f32_16x16x32_bf16 v[68:71], v[20:23], v[60:63], v[68:71]
  s_waitcnt lgkmcnt(0)
  s_barrier
  v_mfma_f32_16x16x32_bf16 v[72:75], v[24:27], v[48:51], v[72:75]
  ds_read_b128 v[96:99], v12 offset:16384
  ds_read_b128 v[100:103], v13 offset:16384
  v_mfma_f32_16x16x32_bf16 v[72:75], v[28:31], v[52:55], v[72:75]
  ds_read_b128 v[104:107], v12 offset:18432
  ds_read_b128 v[108:111], v13 offset:18432
  v_mfma_f32_16x16x32_bf16 v[76:79], v[24:27], v[56:59], v[76:79]
  ds_read_b64_tr_b16 v[16:17], v8 offset:16384
  ds_read_b64_tr_b16 v[18:19], v8 offset:16896
  v_mfma_f32_16x16x32_bf16 v[76:79], v[28:31], v[60:63], v[76:79]
  ds_read_b64_tr_b16 v[20:21], v8 offset:20480
  ds_read_b64_tr_b16 v[22:23], v8 offset:20992
  v_mfma_f32_16x16x32_bf16 v[80:83], v[32:35], v[48:51], v[80:83]
  ds_read_b64_tr_b16 v[24:25], v9 offset:16384
  ds_read_b64_tr_b16 v[26:27], v9 offset:16896
  v_mfma_f32_16x16x32_bf16 v[80:83], v[36:39], v[52:55], v[80:83]
  ds_read_b64_tr_b16 v[28:29], v9 offset:20480
  ds_read_b64_tr_b16 v[30:31], v9 offset:20992
  v_mfma_f32_16x16x32_bf16 v[84:87], v[32:35], v[56:59], v[84:87]
  v_mfma_f32_16x16x32_bf16 v[84:87], v[36:39], v[60:63], v[84:87]
  v_mfma_f32_16x16x32_bf16 v[88:91], v[40:43], v[48:51], v[88:91]
  ds_read_b64_tr_b16 v[32:33], v10 offset:16384
  ds_read_b64_tr_b16 v[34:35], v10 offset:16896
  v_mfma_f32_16x16x32_bf16 v[88:91], v[44:47], v[52:55], v[88:91]
  ds_read_b64_tr_b16 v[36:37], v10 offset:20480
  ds_read_b64_tr_b16 v[38:39], v10 offset:20992
  v_mfma_f32_16x16x32_bf16 v[92:95], v[40:43], v[56:59], v[92:95]
  v_mfma_f32_16x16x32_bf16 v[92:95], v[44:47], v[60:63], v[92:95]
  ds_read_b64_tr_b16 v[40:41], v11 offset:16384
  ds_read_b64_tr_b16 v[42:43], v11 offset:16896
  ds_read_b64_tr_b16 v[44:45], v11 offset:20480
  ds_read_b64_tr_b16 v[46:47], v11 offset:20992
  s_waitcnt lgkmcnt(14)
  v_mfma_f32_16x16x32_bf16 v[64:67], v[16:19], v[96:99], v[64:67]
  s_waitcnt lgkmcnt(12)
  v_mfma_f32_16x16x32_bf16 v[64:67], v[20:23], v[100:103], v[64:67]
  v_mfma_f32_16x16x32_bf16 v[68:71], v[16:19], v[104:107], v[68:71]
  v_mfma_f32_16x16x32_bf16 v[68:71], v[20:23], v[108:111], v[68:71]
  s_waitcnt lgkmcnt(0)
  s_barrier
  v_mfma_f32_16x16x32_bf16 v[72:75], v[24:27], v[96:99], v[72:75]
  ds_read_b128 v[48:51], v12 offset:32768
  ds_read_b128 v[52:55], v13 offset:32768
  v_mfma_f32_16x16x32_bf16 v[72:75], v[28:31], v[100:103], v[72:75]
  ds_read_b128 v[56:59], v12 offset:34816
  ds_read_b128 v[60:63], v13 offset:34816
  v_mfma_f32_16x16x32_bf16 v[76:79], v[24:27], v[104:107], v[76:79]
  ds_read_b64_tr_b16 v[16:17], v8 offset:32768
  ds_read_b64_tr_b16 v[18:19], v8 offset:33280
  v_mfma_f32_16x16x32_bf16 v[76:79], v[28:31], v[108:111], v[76:79]
  ds_read_b64_tr_b16 v[20:21], v8 offset:36864
  ds_read_b64_tr_b16 v[22:23], v8 offset:37376
  v_mfma_f32_16x16x32_bf16 v[80:83], v[32:35], v[96:99], v[80:83]
  ds_read_b64_tr_b16 v[24:25], v9 offset:32768
  ds_read_b64_tr_b16 v[26:27], v9 offset:33280
  v_mfma_f32_16x16x32_bf16 v[80:83], v[36:39], v[100:103], v[80:83]
  ds_read_b64_tr_b16 v[28:29], v9 offset:36864
  ds_read_b64_tr_b16 v[30:31], v9 offset:37376
  v_mfma_f32_16x16x32_bf16 v[84:87], v[32:35], v[104:107], v[84:87]
  v_mfma_f32_16x16x32_bf16 v[84:87], v[36:39], v[108:111], v[84:87]
  v_mfma_f32_16x16x32_bf16 v[88:91], v[40:43], v[96:99], v[88:91]
  ds_read_b64_tr_b16 v[32:33], v10 offset:32768
  ds_read_b64_tr_b16 v[34:35], v10 offset:33280
  v_mfma_f32_16x16x32_bf16 v[88:91], v[44:47], v[100:103], v[88:91]
  ds_read_b64_tr_b16 v[36:37], v10 offset:36864
  ds_read_b64_tr_b16 v[38:39], v10 offset:37376
  v_mfma_f32_16x16x32_bf16 v[92:95], v[40:43], v[104:107], v[92:95]
  v_mfma_f32_16x16x32_bf16 v[92:95], v[44:47], v[108:111], v[92:95]
  ds_read_b64_tr_b16 v[40:41], v11 offset:32768
  ds_read_b64_tr_b16 v[42:43], v11 offset:33280
  ds_read_b64_tr_b16 v[44:45], v11 offset:36864
  ds_read_b64_tr_b16 v[46:47], v11 offset:37376
  s_waitcnt lgkmcnt(14)
  v_mfma_f32_16x16x32_bf16 v[64:67], v[16:19], v[48:51], v[64:67]
  s_waitcnt lgkmcnt(12)
  v_mfma_f32_16x16x32_bf16 v[64:67], v[20:23], v[52:55], v[64:67]
  v_mfma_f32_16x16x32_bf16 v[68:71], v[16:19], v[56:59], v[68:71]
  v_mfma_f32_16x16x32_bf16 v[68:71], v[20:23], v[60:63], v[68:71]
  s_waitcnt lgkmcnt(0)
  s_barrier
  v_mfma_f32_16x16x32_bf16 v[72:75], v[24:27], v[48:51], v[72:75]
  ds_read_b128 v[96:99], v12 offset:49152
  ds_read_b128 v[100:103], v13 offset:49152
  v_mfma_f32_16x16x32_bf16 v[72:75], v[28:31], v[52:55], v[72:75]
  ds_read_b128 v[104:107], v12 offset:51200
  ds_read_b128 v[108:111], v13 offset:51200
  v_mfma_f32_16x16x32_bf16 v[76:79], v[24:27], v[56:59], v[76:79]
  ds_read_b64_tr_b16 v[16:17], v8 offset:49152
  ds_read_b64_tr_b16 v[18:19], v8 offset:49664
  v_mfma_f32_16x16x32_bf16 v[76:79], v[28:31], v[60:63], v[76:79]
  ds_read_b64_tr_b16 v[20:21], v8 offset:53248
  ds_read_b64_tr_b16 v[22:23], v8 offset:53760
  v_mfma_f32_16x16x32_bf16 v[80:83], v[32:35], v[48:51], v[80:83]
  ds_read_b64_tr_b16 v[24:25], v9 offset:49152
  ds_read_b64_tr_b16 v[26:27], v9 offset:49664
  v_mfma_f32_16x16x32_bf16 v[80:83], v[36:39], v[52:55], v[80:83]
  ds_read_b64_tr_b16 v[28:29], v9 offset:53248
  ds_read_b64_tr_b16 v[30:31], v9 offset:53760
  v_mfma_f32_16x16x32_bf16 v[84:87], v[32:35], v[56:59], v[84:87]
  v_mfma_f32_16x16x32_bf16 v[84:87], v[36:39], v[60:63], v[84:87]
  v_mfma_f32_16x16x32_bf16 v[88:91], v[40:43], v[48:51], v[88:91]
  ds_read_b64_tr_b16 v[32:33], v10 offset:49152
  ds_read_b64_tr_b16 v[34:35], v10 offset:49664
  v_mfma_f32_16x16x32_bf16 v[88:91], v[44:47], v[52:55], v[88:91]
  ds_read_b64_tr_b16 v[36:37], v10 offset:53248
  ds_read_b64_tr_b16 v[38:39], v10 offset:53760
  v_mfma_f32_16x16x32_bf16 v[92:95], v[40:43], v[56:59], v[92:95]
  v_mfma_f32_16x16x32_bf16 v[92:95], v[44:47], v[60:63], v[92:95]
  ds_read_b64_tr_b16 v[40:41], v11 offset:49152
  ds_read_b64_tr_b16 v[42:43], v11 offset:49664
  ds_read_b64_tr_b16 v[44:45], v11 offset:53248
  ds_read_b64_tr_b16 v[46:47], v11 offset:53760
  s_waitcnt lgkmcnt(14)
  v_mfma_f32_16x16x32_bf16 v[64:67], v[16:19], v[96:99], v[64:67]
  s_waitcnt lgkmcnt(12)
  v_mfma_f32_16x16x32_bf16 v[64:67], v[20:23], v[100:103], v[64:67]
  v_mfma_f32_16x16x32_bf16 v[68:71], v[16:19], v[104:107], v[68:71]
  v_mfma_f32_16x16x32_bf16 v[68:71], v[20:23], v[108:111], v[68:71]
  s_waitcnt lgkmcnt(0)
  s_barrier
  v_mfma_f32_16x16x32_bf16 v[72:75], v[24:27], v[96:99], v[72:75]
  v_mfma_f32_16x16x32_bf16 v[72:75], v[28:31], v[100:103], v[72:75]
  v_mfma_f32_16x16x32_bf16 v[76:79], v[24:27], v[104:107], v[76:79]
  v_mfma_f32_16x16x32_bf16 v[76:79], v[28:31], v[108:111], v[76:79]
  v_mfma_f32_16x16x32_bf16 v[80:83], v[32:35], v[96:99], v[80:83]
  v_mfma_f32_16x16x32_bf16 v[80:83], v[36:39], v[100:103], v[80:83]
  v_mfma_f32_16x16x32_bf16 v[84:87], v[32:35], v[104:107], v[84:87]
  v_mfma_f32_16x16x32_bf16 v[84:87], v[36:39], v[108:111], v[84:87]
  v_mfma_f32_16x16x32_bf16 v[88:91], v[40:43], v[96:99], v[88:91]
  v_mfma_f32_16x16x32_bf16 v[88:91], v[44:47], v[100:103], v[88:91]
  v_mfma_f32_16x16x32_bf16 v[92:95], v[40:43], v[104:107], v[92:95]
  v_mfma_f32_16x16x32_bf16 v[92:95], v[44:47], v[108:111], v[92:95]
  s_nop 1
  s_lshl_b32 s48, s51, 11
  s_add_u32 s48, s48, 0
  v_add_u32 v16, s48, v1
  v_cvt_pk_bf16_f32 v20, v64, v65
  v_cvt_pk_bf16_f32 v21, v66, v67
  v_cvt_pk_bf16_f32 v22, v72, v73
  v_cvt_pk_bf16_f32 v23, v74, v75
  ds_write_b128 v16, v[20:23] offset:0
  v_cvt_pk_bf16_f32 v24, v68, v69
  v_cvt_pk_bf16_f32 v25, v70, v71
  v_cvt_pk_bf16_f32 v26, v76, v77
  v_cvt_pk_bf16_f32 v27, v78, v79
  ds_write_b128 v16, v[24:27] offset:256
  v_cvt_pk_bf16_f32 v28, v80, v81
  v_cvt_pk_bf16_f32 v29, v82, v83
  v_cvt_pk_bf16_f32 v30, v88, v89
  v_cvt_pk_bf16_f32 v31, v90, v91
  ds_write_b128 v16, v[28:31] offset:8192
  v_cvt_pk_bf16_f32 v32, v84, v85
  v_cvt_pk_bf16_f32 v33, v86, v87
  v_cvt_pk_bf16_f32 v34, v92, v93
  v_cvt_pk_bf16_f32 v35, v94, v95
  ds_write_b128 v16, v[32:35] offset:8448
  v_mov_b32 v40, v112
  v_mov_b32 v41, v113
  v_mov_b32 v42, v114
  v_mov_b32 v43, v115
  v_mov_b32 v44, v116
  v_mov_b32 v45, v117
  v_mov_b32 v46, v118
  v_mov_b32 v47, v119
  v_lshlrev_b32 v64, 16, v40
  v_and_b32 v65, 0xffff0000, v40
  v_lshlrev_b32 v66, 16, v41
  v_and_b32 v67, 0xffff0000, v41
  v_lshlrev_b32 v68, 16, v40
  v_and_b32 v69, 0xffff0000, v40
  v_lshlrev_b32 v70, 16, v41
  v_and_b32 v71, 0xffff0000, v41
  v_lshlrev_b32 v72, 16, v40
  v_and_b32 v73, 0xffff0000, v40
  v_lshlrev_b32 v74, 16, v41
  v_and_b32 v75, 0xffff0000, v41
  v_lshlrev_b32 v76, 16, v40
  v_and_b32 v77, 0xffff0000, v40
  v_lshlrev_b32 v78, 16, v41
  v_and_b32 v79, 0xffff0000, v41
  v_lshlrev_b32 v80, 16, v42
  v_and_b32 v81, 0xffff0000, v42
  v_lshlrev_b32 v82, 16, v43
  v_and_b32 v83, 0xffff0000, v43
  v_lshlrev_b32 v84, 16, v42
  v_and_b32 v85, 0xffff0000, v42
  v_lshlrev_b32 v86, 16, v43
  v_and_b32 v87, 0xffff0000, v43
  v_lshlrev_b32 v88, 16, v42
  v_and_b32 v89, 0xffff0000, v42
  v_lshlrev_b32 v90, 16, v43
  v_and_b32 v91, 0xffff0000, v43
  v_lshlrev_b32 v92, 16, v42
  v_and_b32 v93, 0xffff0000, v42
  v_lshlrev_b32 v94, 16, v43
  v_and_b32 v95, 0xffff0000, v43
  v_lshlrev_b32 v96, 16, v44
  v_and_b32 v97, 0xffff0000, v44
  v_lshlrev_b32 v98, 16, v45
  v_and_b32 v99, 0xffff0000, v45
  v_lshlrev_b32 v100, 16, v44
  v_and_b32 v101, 0xffff0000, v44
  v_lshlrev_b32 v102, 16, v45
  v_and_b32 v103, 0xffff0000, v45
  v_lshlrev_b32 v104, 16, v44
  v_and_b32 v105, 0xffff0000, v44
  v_lshlrev_b32 v106, 16, v45
  v_and_b32 v107, 0xffff0000, v45
  v_lshlrev_b32 v108, 16, v44
  v_and_b32 v109, 0xffff0000, v44
  v_lshlrev_b32 v110, 16, v45
  v_and_b32 v111, 0xffff0000, v45
  v_lshlrev_b32 v112, 16, v46
  v_and_b32 v113, 0xffff0000, v46
  v_lshlrev_b32 v114, 16, v47
  v_and_b32 v115, 0xffff0000, v47
  v_lshlrev_b32 v116, 16, v46
  v_and_b32 v117, 0xffff0000, v46
  v_lshlrev_b32 v118, 16, v47
  v_and_b32 v119, 0xffff0000, v47
  v_lshlrev_b32 v120, 16, v46
  v_and_b32 v121, 0xffff0000, v46
  v_lshlrev_b32 v122, 16, v47
  v_and_b32 v123, 0xffff0000, v47
  v_lshlrev_b32 v124, 16, v46
  v_and_b32 v125, 0xffff0000, v46
  v_lshlrev_b32 v126, 16, v47
  v_and_b32 v127, 0xffff0000, v47
  s_waitcnt lgkmcnt(0)
  s_barrier
  ds_read_b64_tr_b16 v[16:17], v4 offset:16384
  ds_read_b64_tr_b16 v[18:19], v4 offset:17408
  ds_read_b64_tr_b16 v[20:21], v4 offset:24576
  ds_read_b64_tr_b16 v[22:23], v4 offset:25600
  ds_read_b128 v[32:35], v15 offset:16384
  ds_read_b128 v[36:39], v15 offset:17408
  ds_read_b128 v[40:43], v15 offset:18432
  ds_read_b128 v[44:47], v15 offset:19456
  ds_read_b128 v[48:51], v15 offset:20480
  ds_read_b128 v[52:55], v15 offset:21504
  ds_read_b128 v[56:59], v15 offset:22528
  ds_read_b128 v[60:63], v15 offset:23552
  s_mov_b32 s50, 7
  s_waitcnt lgkmcnt(0)
.p2align 6
L_L:
  s_waitcnt lgkmcnt(9)
  v_mfma_f32_16x16x32_bf16 v[64:67], v[16:19], v[32:35], v[64:67]
  ds_read_b64_tr_b16 v[24:25], v5 offset:16384
  s_waitcnt lgkmcnt(7)
  v_mfma_f32_16x16x32_bf16 v[64:67], v[20:23], v[36:39], v[64:67]
  ds_read_b64_tr_b16 v[26:27], v5 offset:17408
  s_waitcnt lgkmcnt(7)
  v_mfma_f32_16x16x32_bf16 v[68:71], v[16:19], v[40:43], v[68:71]
  ds_read_b64_tr_b16 v[28:29], v5 offset:24576
  s_waitcnt lgkmcnt(7)
  v_mfma_f32_16x16x32_bf16 v[68:71], v[20:23], v[44:47], v[68:71]
  ds_read_b64_tr_b16 v[30:31], v5 offset:25600
  s_waitcnt lgkmcnt(7)
  v_mfma_f32_16x16x32_bf16 v[72:75], v[16:19], v[48:51], v[72:75]
  s_waitcnt lgkmcnt(6)
  v_mfma_f32_16x16x32_bf16 v[72:75], v[20:23], v[52:55], v[72:75]
  s_waitcnt lgkmcnt(5)
  v_mfma_f32_16x16x32_bf16 v[76:79], v[16:19], v[56:59], v[76:79]
  s_waitcnt lgkmcnt(4)
  v_mfma_f32_16x16x32_bf16 v[76:79], v[20:23], v[60:63], v[76:79]
  s_waitcnt lgkmcnt(2)
  v_mfma_f32_16x16x32_bf16 v[80:83], v[24:27], v[32:35], v[80:83]
  ds_read_b64_tr_b16 v[16:17], v6 offset:16384
  s_waitcnt lgkmcnt(1)
  v_mfma_f32_16x16x32_bf16 v[80:83], v[28:31], v[36:39], v[80:83]
  ds_read_b64_tr_b16 v[18:19], v6 offset:17408
  v_mfma_f32_16x16x32_bf16 v[84:87], v[24:27], v[40:43], v[84:87]
  ds_read_b64_tr_b16 v[20:21], v6 offset:24576
  v_mfma_f32_16x16x32_bf16 v[84:87], v[28:31], v[44:47], v[84:87]
  ds_read_b64_tr_b16 v[22:23], v6 offset:25600
  v_mfma_f32_16x16x32_bf16 v[88:91], v[24:27], v[48:51], v[88:91]
  v_mfma_f32_16x16x32_bf16 v[88:91], v[28:31], v[52:55], v[88:91]
  v_mfma_f32_16x16x32_bf16 v[92:95], v[24:27], v[56:59], v[92:95]
  v_mfma_f32_16x16x32_bf16 v[92:95], v[28:31], v[60:63], v[92:95]
  s_waitcnt lgkmcnt(2)
  v_mfma_f32_16x16x32_bf16 v[96:99], v[16:19], v[32:35], v[96:99]
  ds_read_b64_tr_b16 v[24:25], v7 offset:16384
  s_waitcnt lgkmcnt(1)
  v_mfma_f32_16x16x32_bf16 v[96:99], v[20:23], v[36:39], v[96:99]
  ds_read_b64_tr_b16 v[26:27], v7 offset:17408
  v_mfma_f32_16x16x32_bf16 v[100:103], v[16:19], v[40:43], v[100:103]
  ds_read_b64_tr_b16 v[28:29], v7 offset:24576
  v_mfma_f32_16x16x32_bf16 v[100:103], v[20:23], v[44:47], v[100:103]
  ds_read_b64_tr_b16 v[30:31], v7 offset:25600
  v_mfma_f32_16x16x32_bf16 v[104:107], v[16:19], v[48:51], v[104:107]
  v_mfma_f32_16x16x32_bf16 v[104:107], v[20:23], v[52:55], v[104:107]
  v_mfma_f32_16x16x32_bf16 v[108:111], v[16:19], v[56:59], v[108:111]
  v_mfma_f32_16x16x32_bf16 v[108:111], v[20:23], v[60:63], v[108:111]
  s_waitcnt lgkmcnt(0)
  s_barrier
  v_mfma_f32_16x16x32_bf16 v[112:115], v[24:27], v[32:35], v[112:115]
  ds_read_b64_tr_b16 v[16:17], v4 offset:32768
  v_mfma_f32_16x16x32_bf16 v[112:115], v[28:31], v[36:39], v[112:115]
  ds_read_b64_tr_b16 v[18:19], v4 offset:33792
  ds_read_b128 v[32:35], v15 offset:32768
  ds_read_b128 v[36:39], v15 offset:33792
  v_mfma_f32_16x16x32_bf16 v[116:119], v[24:27], v[40:43], v[116:119]
  ds_read_b64_tr_b16 v[20:21], v4 offset:40960
  v_mfma_f32_16x16x32_bf16 v[116:119], v[28:31], v[44:47], v[116:119]
  ds_read_b64_tr_b16 v[22:23], v4 offset:41984
  ds_read_b128 v[40:43], v15 offset:34816
  ds_read_b128 v[44:47], v15 offset:35840
  v_mfma_f32_16x16x32_bf16 v[120:123], v[24:27], v[48:51], v[120:123]
  v_mfma_f32_16x16x32_bf16 v[120:123], v[28:31], v[52:55], v[120:123]
  ds_read_b128 v[48:51], v15 offset:36864
  ds_read_b128 v[52:55], v15 offset:37888
  v_mfma_f32_16x16x32_bf16 v[124:127], v[24:27], v[56:59], v[124:127]
  v_mfma_f32_16x16x32_bf16 v[124:127], v[28:31], v[60:63], v[124:127]
  ds_read_b128 v[56:59], v15 offset:38912
  ds_read_b128 v[60:63], v15 offset:39936
  s_waitcnt lgkmcnt(9)
  v_mfma_f32_16x16x32_bf16 v[64:67], v[16:19], v[32:35], v[64:67]
  ds_read_b64_tr_b16 v[24:25], v5 offset:32768
  s_waitcnt lgkmcnt(7)
  v_mfma_f32_16x16x32_bf16 v[64:67], v[20:23], v[36:39], v[64:67]
  ds_read_b64_tr_b16 v[26:27], v5 offset:33792
  s_waitcnt lgkmcnt(7)
  v_mfma_f32_16x16x32_bf16 v[68:71], v[16:19], v[40:43], v[68:71]
  ds_read_b64_tr_b16 v[28:29], v5 offset:40960
  s_waitcnt lgkmcnt(7)
  v_mfma_f32_16x16x32_bf16 v[68:71], v[20:23], v[44:47], v[68:71]
  ds_read_b64_tr_b16 v[30:31], v5 offset:41984
  s_waitcnt lgkmcnt(7)
  v_mfma_f32_16x16x32_bf16 v[72:75], v[16:19], v[48:51], v[72:75]
  s_waitcnt lgkmcnt(6)
  v_mfma_f32_16x16x32_bf16 v[72:75], v[20:23], v[52:55], v[72:75]
  s_waitcnt lgkmcnt(5)
  v_mfma_f32_16x16x32_bf16 v[76:79], v[16:19], v[56:59], v[76:79]
  s_waitcnt lgkmcnt(4)
  v_mfma_f32_16x16x32_bf16 v[76:79], v[20:23], v[60:63], v[76:79]
  s_waitcnt lgkmcnt(2)
  v_mfma_f32_16x16x32_bf16 v[80:83], v[24:27], v[32:35], v[80:83]
  ds_read_b64_tr_b16 v[16:17], v6 offset:32768
  s_waitcnt lgkmcnt(1)
  v_mfma_f32_16x16x32_bf16 v[80:83], v[28:31], v[36:39], v[80:83]
  ds_read_b64_tr_b16 v[18:19], v6 offset:33792
  v_mfma_f32_16x16x32_bf16 v[84:87], v[24:27], v[40:43], v[84:87]
  ds_read_b64_tr_b16 v[20:21], v6 offset:40960
  v_mfma_f32_16x16x32_bf16 v[84:87], v[28:31], v[44:47], v[84:87]
  ds_read_b64_tr_b16 v[22:23], v6 offset:41984
  v_mfma_f32_16x16x32_bf16 v[88:91], v[24:27], v[48:51], v[88:91]
  v_mfma_f32_16x16x32_bf16 v[88:91], v[28:31], v[52:55], v[88:91]
  v_mfma_f32_16x16x32_bf16 v[92:95], v[24:27], v[56:59], v[92:95]
  v_mfma_f32_16x16x32_bf16 v[92:95], v[28:31], v[60:63], v[92:95]
  s_waitcnt lgkmcnt(2)
  v_mfma_f32_16x16x32_bf16 v[96:99], v[16:19], v[32:35], v[96:99]
  ds_read_b64_tr_b16 v[24:25], v7 offset:32768
  s_waitcnt lgkmcnt(1)
  v_mfma_f32_16x16x32_bf16 v[96:99], v[20:23], v[36:39], v[96:99]
  ds_read_b64_tr_b16 v[26:27], v7 offset:33792
  v_mfma_f32_16x16x32_bf16 v[100:103], v[16:19], v[40:43], v[100:103]
  ds_read_b64_tr_b16 v[28:29], v7 offset:40960
  v_mfma_f32_16x16x32_bf16 v[100:103], v[20:23], v[44:47], v[100:103]
  ds_read_b64_tr_b16 v[30:31], v7 offset:41984
  v_mfma_f32_16x16x32_bf16 v[104:107], v[16:19], v[48:51], v[104:107]
  v_mfma_f32_16x16x32_bf16 v[104:107], v[20:23], v[52:55], v[104:107]
  v_mfma_f32_16x16x32_bf16 v[108:111], v[16:19], v[56:59], v[108:111]
  v_mfma_f32_16x16x32_bf16 v[108:111], v[20:23], v[60:63], v[108:111]
  s_waitcnt lgkmcnt(0)
  s_barrier
  v_mfma_f32_16x16x32_bf16 v[112:115], v[24:27], v[32:35], v[112:115]
  ds_read_b64_tr_b16 v[16:17], v4 offset:49152
  v_mfma_f32_16x16x32_bf16 v[112:115], v[28:31], v[36:39], v[112:115]
  ds_read_b64_tr_b16 v[18:19], v4 offset:50176
  ds_read_b128 v[32:35], v15 offset:49152
  ds_read_b128 v[36:39], v15 offset:50176
  v_mfma_f32_16x16x32_bf16 v[116:119], v[24:27], v[40:43], v[116:119]
  ds_read_b64_tr_b16 v[20:21], v4 offset:57344
  v_mfma_f32_16x16x32_bf16 v[116:119], v[28:31], v[44:47], v[116:119]
  ds_read_b64_tr_b16 v[22:23], v4 offset:58368
  ds_read_b128 v[40:43], v15 offset:51200
  ds_read_b128 v[44:47], v15 offset:52224
  v_mfma_f32_16x16x32_bf16 v[120:123], v[24:27], v[48:51], v[120:123]
  v_mfma_f32_16x16x32_bf16 v[120:123], v[28:31], v[52:55], v[120:123]
  ds_read_b128 v[48:51], v15 offset:53248
  ds_read_b128 v[52:55], v15 offset:54272
  v_mfma_f32_16x16x32_bf16 v[124:127], v[24:27], v[56:59], v[124:127]
  v_mfma_f32_16x16x32_bf16 v[124:127], v[28:31], v[60:63], v[124:127]
  ds_read_b128 v[56:59], v15 offset:55296
  ds_read_b128 v[60:63], v15 offset:56320
  s_waitcnt lgkmcnt(9)
  v_mfma_f32_16x16x32_bf16 v[64:67], v[16:19], v[32:35], v[64:67]
  ds_read_b64_tr_b16 v[24:25], v5 offset:49152
  s_waitcnt lgkmcnt(7)
  v_mfma_f32_16x16x32_bf16 v[64:67], v[20:23], v[36:39], v[64:67]
  ds_read_b64_tr_b16 v[26:27], v5 offset:50176
  s_waitcnt lgkmcnt(7)
  v_mfma_f32_16x16x32_bf16 v[68:71], v[16:19], v[40:43], v[68:71]
  ds_read_b64_tr_b16 v[28:29], v5 offset:57344
  s_waitcnt lgkmcnt(7)
  v_mfma_f32_16x16x32_bf16 v[68:71], v[20:23], v[44:47], v[68:71]
  ds_read_b64_tr_b16 v[30:31], v5 offset:58368
  s_waitcnt lgkmcnt(7)
  v_mfma_f32_16x16x32_bf16 v[72:75], v[16:19], v[48:51], v[72:75]
  s_waitcnt lgkmcnt(6)
  v_mfma_f32_16x16x32_bf16 v[72:75], v[20:23], v[52:55], v[72:75]
  s_waitcnt lgkmcnt(5)
  v_mfma_f32_16x16x32_bf16 v[76:79], v[16:19], v[56:59], v[76:79]
  s_waitcnt lgkmcnt(4)
  v_mfma_f32_16x16x32_bf16 v[76:79], v[20:23], v[60:63], v[76:79]
  s_waitcnt lgkmcnt(2)
  v_mfma_f32_16x16x32_bf16 v[80:83], v[24:27], v[32:35], v[80:83]
  ds_read_b64_tr_b16 v[16:17], v6 offset:49152
  s_waitcnt lgkmcnt(1)
  v_mfma_f32_16x16x32_bf16 v[80:83], v[28:31], v[36:39], v[80:83]
  ds_read_b64_tr_b16 v[18:19], v6 offset:50176
  v_mfma_f32_16x16x32_bf16 v[84:87], v[24:27], v[40:43], v[84:87]
  ds_read_b64_tr_b16 v[20:21], v6 offset:57344
  v_mfma_f32_16x16x32_bf16 v[84:87], v[28:31], v[44:47], v[84:87]
  ds_read_b64_tr_b16 v[22:23], v6 offset:58368
  v_mfma_f32_16x16x32_bf16 v[88:91], v[24:27], v[48:51], v[88:91]
  v_mfma_f32_16x16x32_bf16 v[88:91], v[28:31], v[52:55], v[88:91]
  v_mfma_f32_16x16x32_bf16 v[92:95], v[24:27], v[56:59], v[92:95]
  v_mfma_f32_16x16x32_bf16 v[92:95], v[28:31], v[60:63], v[92:95]
  s_waitcnt lgkmcnt(2)
  v_mfma_f32_16x16x32_bf16 v[96:99], v[16:19], v[32:35], v[96:99]
  ds_read_b64_tr_b16 v[24:25], v7 offset:49152
  s_waitcnt lgkmcnt(1)
  v_mfma_f32_16x16x32_bf16 v[96:99], v[20:23], v[36:39], v[96:99]
  ds_read_b64_tr_b16 v[26:27], v7 offset:50176
  v_mfma_f32_16x16x32_bf16 v[100:103], v[16:19], v[40:43], v[100:103]
  ds_read_b64_tr_b16 v[28:29], v7 offset:57344
  v_mfma_f32_16x16x32_bf16 v[100:103], v[20:23], v[44:47], v[100:103]
  ds_read_b64_tr_b16 v[30:31], v7 offset:58368
  v_mfma_f32_16x16x32_bf16 v[104:107], v[16:19], v[48:51], v[104:107]
  v_mfma_f32_16x16x32_bf16 v[104:107], v[20:23], v[52:55], v[104:107]
  v_mfma_f32_16x16x32_bf16 v[108:111], v[16:19], v[56:59], v[108:111]
  v_mfma_f32_16x16x32_bf16 v[108:111], v[20:23], v[60:63], v[108:111]
  s_waitcnt lgkmcnt(0)
  s_barrier
  v_mfma_f32_16x16x32_bf16 v[112:115], v[24:27], v[32:35], v[112:115]
  ds_read_b64_tr_b16 v[16:17], v4 offset:0
  v_mfma_f32_16x16x32_bf16 v[112:115], v[28:31], v[36:39], v[112:115]
  ds_read_b64_tr_b16 v[18:19], v4 offset:1024
  ds_read_b128 v[32:35], v15 offset:0
  ds_read_b128 v[36:39], v15 offset:1024
  v_mfma_f32_16x16x32_bf16 v[116:119], v[24:27], v[40:43], v[116:119]
  ds_read_b64_tr_b16 v[20:21], v4 offset:8192
  v_mfma_f32_16x16x32_bf16 v[116:119], v[28:31], v[44:47], v[116:119]
  ds_read_b64_tr_b16 v[22:23], v4 offset:9216
  ds_read_b128 v[40:43], v15 offset:2048
  ds_read_b128 v[44:47], v15 offset:3072
  v_mfma_f32_16x16x32_bf16 v[120:123], v[24:27], v[48:51], v[120:123]
  v_mfma_f32_16x16x32_bf16 v[120:123], v[28:31], v[52:55], v[120:123]
  ds_read_b128 v[48:51], v15 offset:4096
  ds_read_b128 v[52:55], v15 offset:5120
  v_mfma_f32_16x16x32_bf16 v[124:127], v[24:27], v[56:59], v[124:127]
  v_mfma_f32_16x16x32_bf16 v[124:127], v[28:31], v[60:63], v[124:127]
  ds_read_b128 v[56:59], v15 offset:6144
  ds_read_b128 v[60:63], v15 offset:7168
  s_waitcnt lgkmcnt(9)
  v_mfma_f32_16x16x32_bf16 v[64:67], v[16:19], v[32:35], v[64:67]
  ds_read_b64_tr_b16 v[24:25], v5 offset:0
  s_waitcnt lgkmcnt(7)
  v_mfma_f32_16x16x32_bf16 v[64:67], v[20:23], v[36:39], v[64:67]
  ds_read_b64_tr_b16 v[26:27], v5 offset:1024
  s_waitcnt lgkmcnt(7)
  v_mfma_f32_16x16x32_bf16 v[68:71], v[16:19], v[40:43], v[68:71]
  ds_read_b64_tr_b16 v[28:29], v5 offset:8192
  s_waitcnt lgkmcnt(7)
  v_mfma_f32_16x16x32_bf16 v[68:71], v[20:23], v[44:47], v[68:71]
  ds_read_b64_tr_b16 v[30:31], v5 offset:9216
  s_waitcnt lgkmcnt(7)
  v_mfma_f32_16x16x32_bf16 v[72:75], v[16:19], v[48:51], v[72:75]
  s_waitcnt lgkmcnt(6)
  v_mfma_f32_16x16x32_bf16 v[72:75], v[20:23], v[52:55], v[72:75]
  s_waitcnt lgkmcnt(5)
  v_mfma_f32_16x16x32_bf16 v[76:79], v[16:19], v[56:59], v[76:79]
  s_waitcnt lgkmcnt(4)
  v_mfma_f32_16x16x32_bf16 v[76:79], v[20:23], v[60:63], v[76:79]
  s_waitcnt lgkmcnt(2)
  v_mfma_f32_16x16x32_bf16 v[80:83], v[24:27], v[32:35], v[80:83]
  ds_read_b64_tr_b16 v[16:17], v6 offset:0
  s_waitcnt lgkmcnt(1)
  v_mfma_f32_16x16x32_bf16 v[80:83], v[28:31], v[36:39], v[80:83]
  ds_read_b64_tr_b16 v[18:19], v6 offset:1024
  v_mfma_f32_16x16x32_bf16 v[84:87], v[24:27], v[40:43], v[84:87]
  ds_read_b64_tr_b16 v[20:21], v6 offset:8192
  v_mfma_f32_16x16x32_bf16 v[84:87], v[28:31], v[44:47], v[84:87]
  ds_read_b64_tr_b16 v[22:23], v6 offset:9216
  v_mfma_f32_16x16x32_bf16 v[88:91], v[24:27], v[48:51], v[88:91]
  v_mfma_f32_16x16x32_bf16 v[88:91], v[28:31], v[52:55], v[88:91]
  v_mfma_f32_16x16x32_bf16 v[92:95], v[24:27], v[56:59], v[92:95]
  v_mfma_f32_16x16x32_bf16 v[92:95], v[28:31], v[60:63], v[92:95]
  s_waitcnt lgkmcnt(2)
  v_mfma_f32_16x16x32_bf16 v[96:99], v[16:19], v[32:35], v[96:99]
  ds_read_b64_tr_b16 v[24:25], v7 offset:0
  s_waitcnt lgkmcnt(1)
  v_mfma_f32_16x16x32_bf16 v[96:99], v[20:23], v[36:39], v[96:99]
  ds_read_b64_tr_b16 v[26:27], v7 offset:1024
  v_mfma_f32_16x16x32_bf16 v[100:103], v[16:19], v[40:43], v[100:103]
  ds_read_b64_tr_b16 v[28:29], v7 offset:8192
  v_mfma_f32_16x16x32_bf16 v[100:103], v[20:23], v[44:47], v[100:103]
  ds_read_b64_tr_b16 v[30:31], v7 offset:9216
  v_mfma_f32_16x16x32_bf16 v[104:107], v[16:19], v[48:51], v[104:107]
  v_mfma_f32_16x16x32_bf16 v[104:107], v[20:23], v[52:55], v[104:107]
  v_mfma_f32_16x16x32_bf16 v[108:111], v[16:19], v[56:59], v[108:111]
  v_mfma_f32_16x16x32_bf16 v[108:111], v[20:23], v[60:63], v[108:111]
  s_sub_u32 s50, s50, 1
  s_cmp_lg_u32 s50, 0
  s_waitcnt lgkmcnt(0)
  s_barrier
  v_mfma_f32_16x16x32_bf16 v[112:115], v[24:27], v[32:35], v[112:115]
  ds_read_b64_tr_b16 v[16:17], v4 offset:16384
  v_mfma_f32_16x16x32_bf16 v[112:115], v[28:31], v[36:39], v[112:115]
  ds_read_b64_tr_b16 v[18:19], v4 offset:17408
  ds_read_b128 v[32:35], v15 offset:16384
  ds_read_b128 v[36:39], v15 offset:17408
  v_mfma_f32_16x16x32_bf16 v[116:119], v[24:27], v[40:43], v[116:119]
  ds_read_b64_tr_b16 v[20:21], v4 offset:24576
  v_mfma_f32_16x16x32_bf16 v[116:119], v[28:31], v[44:47], v[116:119]
  ds_read_b64_tr_b16 v[22:23], v4 offset:25600
  ds_read_b128 v[40:43], v15 offset:18432
  ds_read_b128 v[44:47], v15 offset:19456
  v_mfma_f32_16x16x32_bf16 v[120:123], v[24:27], v[48:51], v[120:123]
  v_mfma_f32_16x16x32_bf16 v[120:123], v[28:31], v[52:55], v[120:123]
  ds_read_b128 v[48:51], v15 offset:20480
  ds_read_b128 v[52:55], v15 offset:21504
  v_mfma_f32_16x16x32_bf16 v[124:127], v[24:27], v[56:59], v[124:127]
  v_mfma_f32_16x16x32_bf16 v[124:127], v[28:31], v[60:63], v[124:127]
  ds_read_b128 v[56:59], v15 offset:22528
  ds_read_b128 v[60:63], v15 offset:23552
  s_cbranch_scc1 L_L
  s_waitcnt lgkmcnt(9)
  v_mfma_f32_16x16x32_bf16 v[64:67], v[16:19], v[32:35], v[64:67]
  ds_read_b64_tr_b16 v[24:25], v5 offset:16384
  s_waitcnt lgkmcnt(7)
  v_mfma_f32_16x16x32_bf16 v[64:67], v[20:23], v[36:39], v[64:67]
  ds_read_b64_tr_b16 v[26:27], v5 offset:17408
  s_waitcnt lgkmcnt(7)
  v_mfma_f32_16x16x32_bf16 v[68:71], v[16:19], v[40:43], v[68:71]
  ds_read_b64_tr_b16 v[28:29], v5 offset:24576
  s_waitcnt lgkmcnt(7)
  v_mfma_f32_16x16x32_bf16 v[68:71], v[20:23], v[44:47], v[68:71]
  ds_read_b64_tr_b16 v[30:31], v5 offset:25600
  s_waitcnt lgkmcnt(7)
  v_mfma_f32_16x16x32_bf16 v[72:75], v[16:19], v[48:51], v[72:75]
  s_waitcnt lgkmcnt(6)
  v_mfma_f32_16x16x32_bf16 v[72:75], v[20:23], v[52:55], v[72:75]
  s_waitcnt lgkmcnt(5)
  v_mfma_f32_16x16x32_bf16 v[76:79], v[16:19], v[56:59], v[76:79]
  s_waitcnt lgkmcnt(4)
  v_mfma_f32_16x16x32_bf16 v[76:79], v[20:23], v[60:63], v[76:79]
  s_waitcnt lgkmcnt(2)
  v_mfma_f32_16x16x32_bf16 v[80:83], v[24:27], v[32:35], v[80:83]
  ds_read_b64_tr_b16 v[16:17], v6 offset:16384
  s_waitcnt lgkmcnt(1)
  v_mfma_f32_16x16x32_bf16 v[80:83], v[28:31], v[36:39], v[80:83]
  ds_read_b64_tr_b16 v[18:19], v6 offset:17408
  v_mfma_f32_16x16x32_bf16 v[84:87], v[24:27], v[40:43], v[84:87]
  ds_read_b64_tr_b16 v[20:21], v6 offset:24576
  v_mfma_f32_16x16x32_bf16 v[84:87], v[28:31], v[44:47], v[84:87]
  ds_read_b64_tr_b16 v[22:23], v6 offset:25600
  v_mfma_f32_16x16x32_bf16 v[88:91], v[24:27], v[48:51], v[88:91]
  v_mfma_f32_16x16x32_bf16 v[88:91], v[28:31], v[52:55], v[88:91]
  v_mfma_f32_16x16x32_bf16 v[92:95], v[24:27], v[56:59], v[92:95]
  v_mfma_f32_16x16x32_bf16 v[92:95], v[28:31], v[60:63], v[92:95]
  s_waitcnt lgkmcnt(2)
  v_mfma_f32_16x16x32_bf16 v[96:99], v[16:19], v[32:35], v[96:99]
  ds_read_b64_tr_b16 v[24:25], v7 offset:16384
  s_waitcnt lgkmcnt(1)
  v_mfma_f32_16x16x32_bf16 v[96:99], v[20:23], v[36:39], v[96:99]
  ds_read_b64_tr_b16 v[26:27], v7 offset:17408
  v_mfma_f32_16x16x32_bf16 v[100:103], v[16:19], v[40:43], v[100:103]
  ds_read_b64_tr_b16 v[28:29], v7 offset:24576
  v_mfma_f32_16x16x32_bf16 v[100:103], v[20:23], v[44:47], v[100:103]
  ds_read_b64_tr_b16 v[30:31], v7 offset:25600
  v_mfma_f32_16x16x32_bf16 v[104:107], v[16:19], v[48:51], v[104:107]
  v_mfma_f32_16x16x32_bf16 v[104:107], v[20:23], v[52:55], v[104:107]
  v_mfma_f32_16x16x32_bf16 v[108:111], v[16:19], v[56:59], v[108:111]
  v_mfma_f32_16x16x32_bf16 v[108:111], v[20:23], v[60:63], v[108:111]
  s_waitcnt lgkmcnt(0)
  s_barrier
  v_mfma_f32_16x16x32_bf16 v[112:115], v[24:27], v[32:35], v[112:115]
  ds_read_b64_tr_b16 v[16:17], v4 offset:32768
  v_mfma_f32_16x16x32_bf16 v[112:115], v[28:31], v[36:39], v[112:115]
  ds_read_b64_tr_b16 v[18:19], v4 offset:33792
  ds_read_b128 v[32:35], v15 offset:32768
  ds_read_b128 v[36:39], v15 offset:33792
  v_mfma_f32_16x16x32_bf16 v[116:119], v[24:27], v[40:43], v[116:119]
  ds_read_b64_tr_b16 v[20:21], v4 offset:40960
  v_mfma_f32_16x16x32_bf16 v[116:119], v[28:31], v[44:47], v[116:119]
  ds_read_b64_tr_b16 v[22:23], v4 offset:41984
  ds_read_b128 v[40:43], v15 offset:34816
  ds_read_b128 v[44:47], v15 offset:35840
  v_mfma_f32_16x16x32_bf16 v[120:123], v[24:27], v[48:51], v[120:123]
  v_mfma_f32_16x16x32_bf16 v[120:123], v[28:31], v[52:55], v[120:123]
  ds_read_b128 v[48:51], v15 offset:36864
  ds_read_b128 v[52:55], v15 offset:37888
  v_mfma_f32_16x16x32_bf16 v[124:127], v[24:27], v[56:59], v[124:127]
  v_mfma_f32_16x16x32_bf16 v[124:127], v[28:31], v[60:63], v[124:127]
  ds_read_b128 v[56:59], v15 offset:38912
  ds_read_b128 v[60:63], v15 offset:39936
  s_waitcnt lgkmcnt(9)
  v_mfma_f32_16x16x32_bf16 v[64:67], v[16:19], v[32:35], v[64:67]
  ds_read_b64_tr_b16 v[24:25], v5 offset:32768
  s_waitcnt lgkmcnt(7)
  v_mfma_f32_16x16x32_bf16 v[64:67], v[20:23], v[36:39], v[64:67]
  ds_read_b64_tr_b16 v[26:27], v5 offset:33792
  s_waitcnt lgkmcnt(7)
  v_mfma_f32_16x16x32_bf16 v[68:71], v[16:19], v[40:43], v[68:71]
  ds_read_b64_tr_b16 v[28:29], v5 offset:40960
  s_waitcnt lgkmcnt(7)
  v_mfma_f32_16x16x32_bf16 v[68:71], v[20:23], v[44:47], v[68:71]
  ds_read_b64_tr_b16 v[30:31], v5 offset:41984
  s_waitcnt lgkmcnt(7)
  v_mfma_f32_16x16x32_bf16 v[72:75], v[16:19], v[48:51], v[72:75]
  s_waitcnt lgkmcnt(6)
  v_mfma_f32_16x16x32_bf16 v[72:75], v[20:23], v[52:55], v[72:75]
  s_waitcnt lgkmcnt(5)
  v_mfma_f32_16x16x32_bf16 v[76:79], v[16:19], v[56:59], v[76:79]
  s_waitcnt lgkmcnt(4)
  v_mfma_f32_16x16x32_bf16 v[76:79], v[20:23], v[60:63], v[76:79]
  s_waitcnt lgkmcnt(2)
  v_mfma_f32_16x16x32_bf16 v[80:83], v[24:27], v[32:35], v[80:83]
  ds_read_b64_tr_b16 v[16:17], v6 offset:32768
  s_waitcnt lgkmcnt(1)
  v_mfma_f32_16x16x32_bf16 v[80:83], v[28:31], v[36:39], v[80:83]
  ds_read_b64_tr_b16 v[18:19], v6 offset:33792
  v_mfma_f32_16x16x32_bf16 v[84:87], v[24:27], v[40:43], v[84:87]
  ds_read_b64_tr_b16 v[20:21], v6 offset:40960
  v_mfma_f32_16x16x32_bf16 v[84:87], v[28:31], v[44:47], v[84:87]
  ds_read_b64_tr_b16 v[22:23], v6 offset:41984
  v_mfma_f32_16x16x32_bf16 v[88:91], v[24:27], v[48:51], v[88:91]
  v_mfma_f32_16x16x32_bf16 v[88:91], v[28:31], v[52:55], v[88:91]
  v_mfma_f32_16x16x32_bf16 v[92:95], v[24:27], v[56:59], v[92:95]
  v_mfma_f32_16x16x32_bf16 v[92:95], v[28:31], v[60:63], v[92:95]
  s_waitcnt lgkmcnt(2)
  v_mfma_f32_16x16x32_bf16 v[96:99], v[16:19], v[32:35], v[96:99]
  ds_read_b64_tr_b16 v[24:25], v7 offset:32768
  s_waitcnt lgkmcnt(1)
  v_mfma_f32_16x16x32_bf16 v[96:99], v[20:23], v[36:39], v[96:99]
  ds_read_b64_tr_b16 v[26:27], v7 offset:33792
  v_mfma_f32_16x16x32_bf16 v[100:103], v[16:19], v[40:43], v[100:103]
  ds_read_b64_tr_b16 v[28:29], v7 offset:40960
  v_mfma_f32_16x16x32_bf16 v[100:103], v[20:23], v[44:47], v[100:103]
  ds_read_b64_tr_b16 v[30:31], v7 offset:41984
  v_mfma_f32_16x16x32_bf16 v[104:107], v[16:19], v[48:51], v[104:107]
  v_mfma_f32_16x16x32_bf16 v[104:107], v[20:23], v[52:55], v[104:107]
  v_mfma_f32_16x16x32_bf16 v[108:111], v[16:19], v[56:59], v[108:111]
  v_mfma_f32_16x16x32_bf16 v[108:111], v[20:23], v[60:63], v[108:111]
  s_waitcnt lgkmcnt(0)
  s_barrier
  v_mfma_f32_16x16x32_bf16 v[112:115], v[24:27], v[32:35], v[112:115]
  ds_read_b64_tr_b16 v[16:17], v4 offset:49152
  v_mfma_f32_16x16x32_bf16 v[112:115], v[28:31], v[36:39], v[112:115]
  ds_read_b64_tr_b16 v[18:19], v4 offset:50176
  ds_read_b128 v[32:35], v15 offset:49152
  ds_read_b128 v[36:39], v15 offset:50176
  v_mfma_f32_16x16x32_bf16 v[116:119], v[24:27], v[40:43], v[116:119]
  ds_read_b64_tr_b16 v[20:21], v4 offset:57344
  v_mfma_f32_16x16x32_bf16 v[116:119], v[28:31], v[44:47], v[116:119]
  ds_read_b64_tr_b16 v[22:23], v4 offset:58368
  ds_read_b128 v[40:43], v15 offset:51200
  ds_read_b128 v[44:47], v15 offset:52224
  v_mfma_f32_16x16x32_bf16 v[120:123], v[24:27], v[48:51], v[120:123]
  v_mfma_f32_16x16x32_bf16 v[120:123], v[28:31], v[52:55], v[120:123]
  ds_read_b128 v[48:51], v15 offset:53248
  ds_read_b128 v[52:55], v15 offset:54272
  v_mfma_f32_16x16x32_bf16 v[124:127], v[24:27], v[56:59], v[124:127]
  v_mfma_f32_16x16x32_bf16 v[124:127], v[28:31], v[60:63], v[124:127]
  ds_read_b128 v[56:59], v15 offset:55296
  ds_read_b128 v[60:63], v15 offset:56320
  s_waitcnt lgkmcnt(9)
  v_mfma_f32_16x16x32_bf16 v[64:67], v[16:19], v[32:35], v[64:67]
  ds_read_b64_tr_b16 v[24:25], v5 offset:49152
  s_waitcnt lgkmcnt(7)
  v_mfma_f32_16x16x32_bf16 v[64:67], v[20:23], v[36:39], v[64:67]
  ds_read_b64_tr_b16 v[26:27], v5 offset:50176
  s_waitcnt lgkmcnt(7)
  v_mfma_f32_16x16x32_bf16 v[68:71], v[16:19], v[40:43], v[68:71]
  ds_read_b64_tr_b16 v[28:29], v5 offset:57344
  s_waitcnt lgkmcnt(7)
  v_mfma_f32_16x16x32_bf16 v[68:71], v[20:23], v[44:47], v[68:71]
  ds_read_b64_tr_b16 v[30:31], v5 offset:58368
  s_waitcnt lgkmcnt(7)
  v_mfma_f32_16x16x32_bf16 v[72:75], v[16:19], v[48:51], v[72:75]
  s_waitcnt lgkmcnt(6)
  v_mfma_f32_16x16x32_bf16 v[72:75], v[20:23], v[52:55], v[72:75]
  s_waitcnt lgkmcnt(5)
  v_mfma_f32_16x16x32_bf16 v[76:79], v[16:19], v[56:59], v[76:79]
  s_waitcnt lgkmcnt(4)
  v_mfma_f32_16x16x32_bf16 v[76:79], v[20:23], v[60:63], v[76:79]
  s_waitcnt lgkmcnt(2)
  v_mfma_f32_16x16x32_bf16 v[80:83], v[24:27], v[32:35], v[80:83]
  ds_read_b64_tr_b16 v[16:17], v6 offset:49152
  s_waitcnt lgkmcnt(1)
  v_mfma_f32_16x16x32_bf16 v[80:83], v[28:31], v[36:39], v[80:83]
  ds_read_b64_tr_b16 v[18:19], v6 offset:50176
  v_mfma_f32_16x16x32_bf16 v[84:87], v[24:27], v[40:43], v[84:87]
  ds_read_b64_tr_b16 v[20:21], v6 offset:57344
  v_mfma_f32_16x16x32_bf16 v[84:87], v[28:31], v[44:47], v[84:87]
  ds_read_b64_tr_b16 v[22:23], v6 offset:58368
  v_mfma_f32_16x16x32_bf16 v[88:91], v[24:27], v[48:51], v[88:91]
  v_mfma_f32_16x16x32_bf16 v[88:91], v[28:31], v[52:55], v[88:91]
  v_mfma_f32_16x16x32_bf16 v[92:95], v[24:27], v[56:59], v[92:95]
  v_mfma_f32_16x16x32_bf16 v[92:95], v[28:31], v[60:63], v[92:95]
  s_waitcnt lgkmcnt(2)
  v_mfma_f32_16x16x32_bf16 v[96:99], v[16:19], v[32:35], v[96:99]
  ds_read_b64_tr_b16 v[24:25], v7 offset:49152
  s_waitcnt lgkmcnt(1)
  v_mfma_f32_16x16x32_bf16 v[96:99], v[20:23], v[36:39], v[96:99]
  ds_read_b64_tr_b16 v[26:27], v7 offset:50176
  v_mfma_f32_16x16x32_bf16 v[100:103], v[16:19], v[40:43], v[100:103]
  ds_read_b64_tr_b16 v[28:29], v7 offset:57344
  v_mfma_f32_16x16x32_bf16 v[100:103], v[20:23], v[44:47], v[100:103]
  ds_read_b64_tr_b16 v[30:31], v7 offset:58368
  v_mfma_f32_16x16x32_bf16 v[104:107], v[16:19], v[48:51], v[104:107]
  v_mfma_f32_16x16x32_bf16 v[104:107], v[20:23], v[52:55], v[104:107]
  v_mfma_f32_16x16x32_bf16 v[108:111], v[16:19], v[56:59], v[108:111]
  v_mfma_f32_16x16x32_bf16 v[108:111], v[20:23], v[60:63], v[108:111]
  s_waitcnt lgkmcnt(0)
  s_barrier
  v_mfma_f32_16x16x32_bf16 v[112:115], v[24:27], v[32:35], v[112:115]
  ds_read_b64_tr_b16 v[16:17], v4 offset:0
  v_mfma_f32_16x16x32_bf16 v[112:115], v[28:31], v[36:39], v[112:115]
  ds_read_b64_tr_b16 v[18:19], v4 offset:1024
  ds_read_b128 v[32:35], v15 offset:0
  ds_read_b128 v[36:39], v15 offset:1024
  v_mfma_f32_16x16x32_bf16 v[116:119], v[24:27], v[40:43], v[116:119]
  ds_read_b64_tr_b16 v[20:21], v4 offset:8192
  v_mfma_f32_16x16x32_bf16 v[116:119], v[28:31], v[44:47], v[116:119]
  ds_read_b64_tr_b16 v[22:23], v4 offset:9216
  ds_read_b128 v[40:43], v15 offset:2048
  ds_read_b128 v[44:47], v15 offset:3072
  v_mfma_f32_16x16x32_bf16 v[120:123], v[24:27], v[48:51], v[120:123]
  v_mfma_f32_16x16x32_bf16 v[120:123], v[28:31], v[52:55], v[120:123]
  ds_read_b128 v[48:51], v15 offset:4096
  ds_read_b128 v[52:55], v15 offset:5120
  v_mfma_f32_16x16x32_bf16 v[124:127], v[24:27], v[56:59], v[124:127]
  v_mfma_f32_16x16x32_bf16 v[124:127], v[28:31], v[60:63], v[124:127]
  ds_read_b128 v[56:59], v15 offset:6144
  ds_read_b128 v[60:63], v15 offset:7168
  s_waitcnt lgkmcnt(9)
  v_mfma_f32_16x16x32_bf16 v[64:67], v[16:19], v[32:35], v[64:67]
  ds_read_b64_tr_b16 v[24:25], v5 offset:0
  s_waitcnt lgkmcnt(7)
  v_mfma_f32_16x16x32_bf16 v[64:67], v[20:23], v[36:39], v[64:67]
  ds_read_b64_tr_b16 v[26:27], v5 offset:1024
  s_waitcnt lgkmcnt(7)
  v_mfma_f32_16x16x32_bf16 v[68:71], v[16:19], v[40:43], v[68:71]
  ds_read_b64_tr_b16 v[28:29], v5 offset:8192
  s_waitcnt lgkmcnt(7)
  v_mfma_f32_16x16x32_bf16 v[68:71], v[20:23], v[44:47], v[68:71]
  ds_read_b64_tr_b16 v[30:31], v5 offset:9216
  s_waitcnt lgkmcnt(7)
  v_mfma_f32_16x16x32_bf16 v[72:75], v[16:19], v[48:51], v[72:75]
  s_waitcnt lgkmcnt(6)
  v_mfma_f32_16x16x32_bf16 v[72:75], v[20:23], v[52:55], v[72:75]
  s_waitcnt lgkmcnt(5)
  v_mfma_f32_16x16x32_bf16 v[76:79], v[16:19], v[56:59], v[76:79]
  s_waitcnt lgkmcnt(4)
  v_mfma_f32_16x16x32_bf16 v[76:79], v[20:23], v[60:63], v[76:79]
  s_waitcnt lgkmcnt(2)
  v_mfma_f32_16x16x32_bf16 v[80:83], v[24:27], v[32:35], v[80:83]
  ds_read_b64_tr_b16 v[16:17], v6 offset:0
  s_waitcnt lgkmcnt(1)
  v_mfma_f32_16x16x32_bf16 v[80:83], v[28:31], v[36:39], v[80:83]
  ds_read_b64_tr_b16 v[18:19], v6 offset:1024
  v_mfma_f32_16x16x32_bf16 v[84:87], v[24:27], v[40:43], v[84:87]
  ds_read_b64_tr_b16 v[20:21], v6 offset:8192
  v_mfma_f32_16x16x32_bf16 v[84:87], v[28:31], v[44:47], v[84:87]
  ds_read_b64_tr_b16 v[22:23], v6 offset:9216
  v_mfma_f32_16x16x32_bf16 v[88:91], v[24:27], v[48:51], v[88:91]
  v_mfma_f32_16x16x32_bf16 v[88:91], v[28:31], v[52:55], v[88:91]
  v_mfma_f32_16x16x32_bf16 v[92:95], v[24:27], v[56:59], v[92:95]
  v_mfma_f32_16x16x32_bf16 v[92:95], v[28:31], v[60:63], v[92:95]
  s_waitcnt lgkmcnt(2)
  v_mfma_f32_16x16x32_bf16 v[96:99], v[16:19], v[32:35], v[96:99]
  ds_read_b64_tr_b16 v[24:25], v7 offset:0
  s_waitcnt lgkmcnt(1)
  v_mfma_f32_16x16x32_bf16 v[96:99], v[20:23], v[36:39], v[96:99]
  ds_read_b64_tr_b16 v[26:27], v7 offset:1024
  v_mfma_f32_16x16x32_bf16 v[100:103], v[16:19], v[40:43], v[100:103]
  ds_read_b64_tr_b16 v[28:29], v7 offset:8192
  v_mfma_f32_16x16x32_bf16 v[100:103], v[20:23], v[44:47], v[100:103]
  ds_read_b64_tr_b16 v[30:31], v7 offset:9216
  v_mfma_f32_16x16x32_bf16 v[104:107], v[16:19], v[48:51], v[104:107]
  v_mfma_f32_16x16x32_bf16 v[104:107], v[20:23], v[52:55], v[104:107]
  v_mfma_f32_16x16x32_bf16 v[108:111], v[16:19], v[56:59], v[108:111]
  v_mfma_f32_16x16x32_bf16 v[108:111], v[20:23], v[60:63], v[108:111]
  s_waitcnt lgkmcnt(0)
  s_barrier
  v_mfma_f32_16x16x32_bf16 v[112:115], v[24:27], v[32:35], v[112:115]
  v_mfma_f32_16x16x32_bf16 v[112:115], v[28:31], v[36:39], v[112:115]
  v_mfma_f32_16x16x32_bf16 v[116:119], v[24:27], v[40:43], v[116:119]
  v_mfma_f32_16x16x32_bf16 v[116:119], v[28:31], v[44:47], v[116:119]
  v_mfma_f32_16x16x32_bf16 v[120:123], v[24:27], v[48:51], v[120:123]
  v_mfma_f32_16x16x32_bf16 v[120:123], v[28:31], v[52:55], v[120:123]
  v_mfma_f32_16x16x32_bf16 v[124:127], v[24:27], v[56:59], v[124:127]
  v_mfma_f32_16x16x32_bf16 v[124:127], v[28:31], v[60:63], v[124:127]
  s_setprio 1
  v_mov_b32 v8, 0xc0135761
  v_mov_b32 v9, 0xc0135761
  v_mov_b32 v10, 1.0
  v_mov_b32 v11, 1.0
  s_nop 1
  v_pk_mul_f32 v[16:17], v[64:65], v[64:65]
  v_pk_mul_f32 v[18:19], v[66:67], v[66:67]
  v_pk_mul_f32 v[20:21], v[80:81], v[80:81]
  v_pk_mul_f32 v[22:23], v[82:83], v[82:83]
  v_pk_mul_f32 v[24:25], v[68:69], v[68:69]
  v_pk_mul_f32 v[26:27], v[70:71], v[70:71]
  v_pk_mul_f32 v[28:29], v[84:85], v[84:85]
  v_pk_mul_f32 v[30:31], v[86:87], v[86:87]
  v_pk_fma_f32 v[16:17], v[16:17], s[52:53], v[8:9]
  v_pk_fma_f32 v[18:19], v[18:19], s[52:53], v[8:9]
  v_pk_fma_f32 v[20:21], v[20:21], s[52:53], v[8:9]
  v_pk_fma_f32 v[22:23], v[22:23], s[52:53], v[8:9]
  v_pk_fma_f32 v[24:25], v[24:25], s[52:53], v[8:9]
  v_pk_fma_f32 v[26:27], v[26:27], s[52:53], v[8:9]
  v_pk_fma_f32 v[28:29], v[28:29], s[52:53], v[8:9]
  v_pk_fma_f32 v[30:31], v[30:31], s[52:53], v[8:9]
  v_pk_mul_f32 v[16:17], v[16:17], v[64:65]
  v_pk_mul_f32 v[18:19], v[18:19], v[66:67]
  v_pk_mul_f32 v[20:21], v[20:21], v[80:81]
  v_pk_mul_f32 v[22:23], v[22:23], v[82:83]
  v_pk_mul_f32 v[24:25], v[24:25], v[68:69]
  v_pk_mul_f32 v[26:27], v[26:27], v[70:71]
  v_pk_mul_f32 v[28:29], v[28:29], v[84:85]
  v_pk_mul_f32 v[30:31], v[30:31], v[86:87]
  v_exp_f32 v16, v16
  v_exp_f32 v17, v17
  v_exp_f32 v18, v18
  v_exp_f32 v19, v19
  v_exp_f32 v20, v20
  v_exp_f32 v21, v21
  v_exp_f32 v22, v22
  v_exp_f32 v23, v23
  v_exp_f32 v24, v24
  v_exp_f32 v25, v25
  v_exp_f32 v26, v26
  v_exp_f32 v27, v27
  v_exp_f32 v28, v28
  v_exp_f32 v29, v29
  v_exp_f32 v30, v30
  v_exp_f32 v31, v31
  v_pk_add_f32 v[16:17], v[16:17], v[10:11]
  v_pk_add_f32 v[18:19], v[18:19], v[10:11]
  v_pk_add_f32 v[20:21], v[20:21], v[10:11]
  v_pk_add_f32 v[22:23], v[22:23], v[10:11]
  v_pk_add_f32 v[24:25], v[24:25], v[10:11]
  v_pk_add_f32 v[26:27], v[26:27], v[10:11]
  v_pk_add_f32 v[28:29], v[28:29], v[10:11]
  v_pk_add_f32 v[30:31], v[30:31], v[10:11]
  v_rcp_f32 v16, v16
  v_rcp_f32 v17, v17
  v_rcp_f32 v18, v18
  v_rcp_f32 v19, v19
  v_rcp_f32 v20, v20
  v_rcp_f32 v21, v21
  v_rcp_f32 v22, v22
  v_rcp_f32 v23, v23
  v_rcp_f32 v24, v24
  v_rcp_f32 v25, v25
  v_rcp_f32 v26, v26
  v_rcp_f32 v27, v27
  v_rcp_f32 v28, v28
  v_rcp_f32 v29, v29
  v_rcp_f32 v30, v30
  v_rcp_f32 v31, v31
  v_pk_mul_f32 v[64:65], v[64:65], v[16:17]
  v_pk_mul_f32 v[66:67], v[66:67], v[18:19]
  v_pk_mul_f32 v[80:81], v[80:81], v[20:21]
  v_pk_mul_f32 v[82:83], v[82:83], v[22:23]
  v_pk_mul_f32 v[68:69], v[68:69], v[24:25]
  v_pk_mul_f32 v[70:71], v[70:71], v[26:27]
  v_pk_mul_f32 v[84:85], v[84:85], v[28:29]
  v_pk_mul_f32 v[86:87], v[86:87], v[30:31]
  v_cvt_pk_bf16_f32 v32, v64, v65
  v_cvt_pk_bf16_f32 v33, v66, v67
  v_cvt_pk_bf16_f32 v34, v80, v81
  v_cvt_pk_bf16_f32 v35, v82, v83
  buffer_store_dwordx4 v[32:35], v3, s[32:35], s54 offen offset:0 sc1
  v_cvt_pk_bf16_f32 v36, v68, v69
  v_cvt_pk_bf16_f32 v37, v70, v71
  v_cvt_pk_bf16_f32 v38, v84, v85
  v_cvt_pk_bf16_f32 v39, v86, v87
  buffer_store_dwordx4 v[36:39], v3, s[32:35], s54 offen offset:2048 sc1
  v_pk_mul_f32 v[16:17], v[72:73], v[72:73]
  v_pk_mul_f32 v[18:19], v[74:75], v[74:75]
  v_pk_mul_f32 v[20:21], v[88:89], v[88:89]
  v_pk_mul_f32 v[22:23], v[90:91], v[90:91]
  v_pk_mul_f32 v[24:25], v[76:77], v[76:77]
  v_pk_mul_f32 v[26:27], v[78:79], v[78:79]
  v_pk_mul_f32 v[28:29], v[92:93], v[92:93]
  v_pk_mul_f32 v[30:31], v[94:95], v[94:95]
  v_pk_fma_f32 v[16:17], v[16:17], s[52:53], v[8:9]
  v_pk_fma_f32 v[18:19], v[18:19], s[52:53], v[8:9]
  v_pk_fma_f32 v[20:21], v[20:21], s[52:53], v[8:9]
  v_pk_fma_f32 v[22:23], v[22:23], s[52:53], v[8:9]
  v_pk_fma_f32 v[24:25], v[24:25], s[52:53], v[8:9]
  v_pk_fma_f32 v[26:27], v[26:27], s[52:53], v[8:9]
  v_pk_fma_f32 v[28:29], v[28:29], s[52:53], v[8:9]
  v_pk_fma_f32 v[30:31], v[30:31], s[52:53], v[8:9]
  v_pk_mul_f32 v[16:17], v[16:17], v[72:73]
  v_pk_mul_f32 v[18:19], v[18:19], v[74:75]
  v_pk_mul_f32 v[20:21], v[20:21], v[88:89]
  v_pk_mul_f32 v[22:23], v[22:23], v[90:91]
  v_pk_mul_f32 v[24:25], v[24:25], v[76:77]
  v_pk_mul_f32 v[26:27], v[26:27], v[78:79]
  v_pk_mul_f32 v[28:29], v[28:29], v[92:93]
  v_pk_mul_f32 v[30:31], v[30:31], v[94:95]
  v_exp_f32 v16, v16
  v_exp_f32 v17, v17
  v_exp_f32 v18, v18
  v_exp_f32 v19, v19
  v_exp_f32 v20, v20
  v_exp_f32 v21, v21
  v_exp_f32 v22, v22
  v_exp_f32 v23, v23
  v_exp_f32 v24, v24
  v_exp_f32 v25, v25
  v_exp_f32 v26, v26
  v_exp_f32 v27, v27
  v_exp_f32 v28, v28
  v_exp_f32 v29, v29
  v_exp_f32 v30, v30
  v_exp_f32 v31, v31
  v_pk_add_f32 v[16:17], v[16:17], v[10:11]
  v_pk_add_f32 v[18:19], v[18:19], v[10:11]
  v_pk_add_f32 v[20:21], v[20:21], v[10:11]
  v_pk_add_f32 v[22:23], v[22:23], v[10:11]
  v_pk_add_f32 v[24:25], v[24:25], v[10:11]
  v_pk_add_f32 v[26:27], v[26:27], v[10:11]
  v_pk_add_f32 v[28:29], v[28:29], v[10:11]
  v_pk_add_f32 v[30:31], v[30:31], v[10:11]
  v_rcp_f32 v16, v16
  v_rcp_f32 v17, v17
  v_rcp_f32 v18, v18
  v_rcp_f32 v19, v19
  v_rcp_f32 v20, v20
  v_rcp_f32 v21, v21
  v_rcp_f32 v22, v22
  v_rcp_f32 v23, v23
  v_rcp_f32 v24, v24
  v_rcp_f32 v25, v25
  v_rcp_f32 v26, v26
  v_rcp_f32 v27, v27
  v_rcp_f32 v28, v28
  v_rcp_f32 v29, v29
  v_rcp_f32 v30, v30
  v_rcp_f32 v31, v31
  v_pk_mul_f32 v[72:73], v[72:73], v[16:17]
  v_pk_mul_f32 v[74:75], v[74:75], v[18:19]
  v_pk_mul_f32 v[88:89], v[88:89], v[20:21]
  v_pk_mul_f32 v[90:91], v[90:91], v[22:23]
  v_pk_mul_f32 v[76:77], v[76:77], v[24:25]
  v_pk_mul_f32 v[78:79], v[78:79], v[26:27]
  v_pk_mul_f32 v[92:93], v[92:93], v[28:29]
  v_pk_mul_f32 v[94:95], v[94:95], v[30:31]
  v_cvt_pk_bf16_f32 v40, v72, v73
  v_cvt_pk_bf16_f32 v41, v74, v75
  v_cvt_pk_bf16_f32 v42, v88, v89
  v_cvt_pk_bf16_f32 v43, v90, v91
  buffer_store_dwordx4 v[40:43], v3, s[32:35], s55 offen offset:0 sc1
  v_cvt_pk_bf16_f32 v44, v76, v77
  v_cvt_pk_bf16_f32 v45, v78, v79
  v_cvt_pk_bf16_f32 v46, v92, v93
  v_cvt_pk_bf16_f32 v47, v94, v95
  buffer_store_dwordx4 v[44:47], v3, s[32:35], s55 offen offset:2048 sc1
  s_barrier
  v_pk_mul_f32 v[16:17], v[96:97], v[96:97]
  v_pk_mul_f32 v[18:19], v[98:99], v[98:99]
  v_pk_mul_f32 v[20:21], v[112:113], v[112:113]
  v_pk_mul_f32 v[22:23], v[114:115], v[114:115]
  v_pk_mul_f32 v[24:25], v[100:101], v[100:101]
  v_pk_mul_f32 v[26:27], v[102:103], v[102:103]
  v_pk_mul_f32 v[28:29], v[116:117], v[116:117]
  v_pk_mul_f32 v[30:31], v[118:119], v[118:119]
  v_pk_fma_f32 v[16:17], v[16:17], s[52:53], v[8:9]
  v_pk_fma_f32 v[18:19], v[18:19], s[52:53], v[8:9]
  v_pk_fma_f32 v[20:21], v[20:21], s[52:53], v[8:9]
  v_pk_fma_f32 v[22:23], v[22:23], s[52:53], v[8:9]
  v_pk_fma_f32 v[24:25], v[24:25], s[52:53], v[8:9]
  v_pk_fma_f32 v[26:27], v[26:27], s[52:53], v[8:9]
  v_pk_fma_f32 v[28:29], v[28:29], s[52:53], v[8:9]
  v_pk_fma_f32 v[30:31], v[30:31], s[52:53], v[8:9]
  v_pk_mul_f32 v[16:17], v[16:17], v[96:97]
  v_pk_mul_f32 v[18:19], v[18:19], v[98:99]
  v_pk_mul_f32 v[20:21], v[20:21], v[112:113]
  v_pk_mul_f32 v[22:23], v[22:23], v[114:115]
  v_pk_mul_f32 v[24:25], v[24:25], v[100:101]
  v_pk_mul_f32 v[26:27], v[26:27], v[102:103]
  v_pk_mul_f32 v[28:29], v[28:29], v[116:117]
  v_pk_mul_f32 v[30:31], v[30:31], v[118:119]
  v_exp_f32 v16, v16
  v_exp_f32 v17, v17
  v_exp_f32 v18, v18
  v_exp_f32 v19, v19
  v_exp_f32 v20, v20
  v_exp_f32 v21, v21
  v_exp_f32 v22, v22
  v_exp_f32 v23, v23
  v_exp_f32 v24, v24
  v_exp_f32 v25, v25
  v_exp_f32 v26, v26
  v_exp_f32 v27, v27
  v_exp_f32 v28, v28
  v_exp_f32 v29, v29
  v_exp_f32 v30, v30
  v_exp_f32 v31, v31
  v_pk_add_f32 v[16:17], v[16:17], v[10:11]
  v_pk_add_f32 v[18:19], v[18:19], v[10:11]
  v_pk_add_f32 v[20:21], v[20:21], v[10:11]
  v_pk_add_f32 v[22:23], v[22:23], v[10:11]
  v_pk_add_f32 v[24:25], v[24:25], v[10:11]
  v_pk_add_f32 v[26:27], v[26:27], v[10:11]
  v_pk_add_f32 v[28:29], v[28:29], v[10:11]
  v_pk_add_f32 v[30:31], v[30:31], v[10:11]
  v_rcp_f32 v16, v16
  v_rcp_f32 v17, v17
  v_rcp_f32 v18, v18
  v_rcp_f32 v19, v19
  v_rcp_f32 v20, v20
  v_rcp_f32 v21, v21
  v_rcp_f32 v22, v22
  v_rcp_f32 v23, v23
  v_rcp_f32 v24, v24
  v_rcp_f32 v25, v25
  v_rcp_f32 v26, v26
  v_rcp_f32 v27, v27
  v_rcp_f32 v28, v28
  v_rcp_f32 v29, v29
  v_rcp_f32 v30, v30
  v_rcp_f32 v31, v31
  v_pk_mul_f32 v[96:97], v[96:97], v[16:17]
  v_pk_mul_f32 v[98:99], v[98:99], v[18:19]
  v_pk_mul_f32 v[112:113], v[112:113], v[20:21]
  v_pk_mul_f32 v[114:115], v[114:115], v[22:23]
  v_pk_mul_f32 v[100:101], v[100:101], v[24:25]
  v_pk_mul_f32 v[102:103], v[102:103], v[26:27]
  v_pk_mul_f32 v[116:117], v[116:117], v[28:29]
  v_pk_mul_f32 v[118:119], v[118:119], v[30:31]
  v_cvt_pk_bf16_f32 v48, v96, v97
  v_cvt_pk_bf16_f32 v49, v98, v99
  v_cvt_pk_bf16_f32 v50, v112, v113
  v_cvt_pk_bf16_f32 v51, v114, v115
  buffer_store_dwordx4 v[48:51], v3, s[32:35], s54 offen offset:1024 sc1
  v_cvt_pk_bf16_f32 v52, v100, v101
  v_cvt_pk_bf16_f32 v53, v102, v103
  v_cvt_pk_bf16_f32 v54, v116, v117
  v_cvt_pk_bf16_f32 v55, v118, v119
  buffer_store_dwordx4 v[52:55], v3, s[32:35], s54 offen offset:3072 sc1
  v_pk_mul_f32 v[16:17], v[104:105], v[104:105]
  v_pk_mul_f32 v[18:19], v[106:107], v[106:107]
  v_pk_mul_f32 v[20:21], v[120:121], v[120:121]
  v_pk_mul_f32 v[22:23], v[122:123], v[122:123]
  v_pk_mul_f32 v[24:25], v[108:109], v[108:109]
  v_pk_mul_f32 v[26:27], v[110:111], v[110:111]
  v_pk_mul_f32 v[28:29], v[124:125], v[124:125]
  v_pk_mul_f32 v[30:31], v[126:127], v[126:127]
  v_pk_fma_f32 v[16:17], v[16:17], s[52:53], v[8:9]
  v_pk_fma_f32 v[18:19], v[18:19], s[52:53], v[8:9]
  v_pk_fma_f32 v[20:21], v[20:21], s[52:53], v[8:9]
  v_pk_fma_f32 v[22:23], v[22:23], s[52:53], v[8:9]
  v_pk_fma_f32 v[24:25], v[24:25], s[52:53], v[8:9]
  v_pk_fma_f32 v[26:27], v[26:27], s[52:53], v[8:9]
  v_pk_fma_f32 v[28:29], v[28:29], s[52:53], v[8:9]
  v_pk_fma_f32 v[30:31], v[30:31], s[52:53], v[8:9]
  v_pk_mul_f32 v[16:17], v[16:17], v[104:105]
  v_pk_mul_f32 v[18:19], v[18:19], v[106:107]
  v_pk_mul_f32 v[20:21], v[20:21], v[120:121]
  v_pk_mul_f32 v[22:23], v[22:23], v[122:123]
  v_pk_mul_f32 v[24:25], v[24:25], v[108:109]
  v_pk_mul_f32 v[26:27], v[26:27], v[110:111]
  v_pk_mul_f32 v[28:29], v[28:29], v[124:125]
  v_pk_mul_f32 v[30:31], v[30:31], v[126:127]
  v_exp_f32 v16, v16
  v_exp_f32 v17, v17
  v_exp_f32 v18, v18
  v_exp_f32 v19, v19
  v_exp_f32 v20, v20
  v_exp_f32 v21, v21
  v_exp_f32 v22, v22
  v_exp_f32 v23, v23
  v_exp_f32 v24, v24
  v_exp_f32 v25, v25
  v_exp_f32 v26, v26
  v_exp_f32 v27, v27
  v_exp_f32 v28, v28
  v_exp_f32 v29, v29
  v_exp_f32 v30, v30
  v_exp_f32 v31, v31
  v_pk_add_f32 v[16:17], v[16:17], v[10:11]
  v_pk_add_f32 v[18:19], v[18:19], v[10:11]
  v_pk_add_f32 v[20:21], v[20:21], v[10:11]
  v_pk_add_f32 v[22:23], v[22:23], v[10:11]
  v_pk_add_f32 v[24:25], v[24:25], v[10:11]
  v_pk_add_f32 v[26:27], v[26:27], v[10:11]
  v_pk_add_f32 v[28:29], v[28:29], v[10:11]
  v_pk_add_f32 v[30:31], v[30:31], v[10:11]
  v_rcp_f32 v16, v16
  v_rcp_f32 v17, v17
  v_rcp_f32 v18, v18
  v_rcp_f32 v19, v19
  v_rcp_f32 v20, v20
  v_rcp_f32 v21, v21
  v_rcp_f32 v22, v22
  v_rcp_f32 v23, v23
  v_rcp_f32 v24, v24
  v_rcp_f32 v25, v25
  v_rcp_f32 v26, v26
  v_rcp_f32 v27, v27
  v_rcp_f32 v28, v28
  v_rcp_f32 v29, v29
  v_rcp_f32 v30, v30
  v_rcp_f32 v31, v31
  v_pk_mul_f32 v[104:105], v[104:105], v[16:17]
  v_pk_mul_f32 v[106:107], v[106:107], v[18:19]
  v_pk_mul_f32 v[120:121], v[120:121], v[20:21]
  v_pk_mul_f32 v[122:123], v[122:123], v[22:23]
  v_pk_mul_f32 v[108:109], v[108:109], v[24:25]
  v_pk_mul_f32 v[110:111], v[110:111], v[26:27]
  v_pk_mul_f32 v[124:125], v[124:125], v[28:29]
  v_pk_mul_f32 v[126:127], v[126:127], v[30:31]
  v_cvt_pk_bf16_f32 v56, v104, v105
  v_cvt_pk_bf16_f32 v57, v106, v107
  v_cvt_pk_bf16_f32 v58, v120, v121
  v_cvt_pk_bf16_f32 v59, v122, v123
  buffer_store_dwordx4 v[56:59], v3, s[32:35], s55 offen offset:1024 sc1
  v_cvt_pk_bf16_f32 v60, v108, v109
  v_cvt_pk_bf16_f32 v61, v110, v111
  v_cvt_pk_bf16_f32 v62, v124, v125
  v_cvt_pk_bf16_f32 v63, v126, v127
  buffer_store_dwordx4 v[60:63], v3, s[32:35], s55 offen offset:3072 sc1
  s_barrier
  s_load_dwordx2 s[6:7], s[0:1], 72
  s_load_dwordx2 s[12:13], s[0:1], 88
  s_bfe_u32 s14, s2, 0x10002
  s_bfe_u32 s42, s2, 0x30003
  s_and_b32 s43, s2, 3
  s_lshl_b32 s43, s43, 2
  s_lshr_b32 s44, s2, 6
  s_add_u32 s43, s43, s44
  s_add_u32 s15, s42, s43
  s_add_u32 s15, s15, s14
  s_and_b32 s15, s15, 1
  s_mul_i32 s49, s15, 2
  s_lshl_b32 s44, s42, 7
  s_lshl_b32 s45, s43, 7
  s_and_b32 s46, s3, 1
  s_bfe_u32 s47, s3, 0x10001
  s_lshl_b32 s60, s46, 13
  s_add_u32 s60, s60, 0
  v_lshlrev_b32 v1, 4, v2
  v_add_u32 v1, s60, v1
  v_bfe_u32 v16, v2, 2, 2
  v_lshrrev_b32 v17, 4, v2
  v_lshl_add_u32 v16, v17, 2, v16
  v_lshlrev_b32 v16, 8, v16
  v_and_b32 v17, 3, v2
  v_lshl_add_u32 v16, v17, 3, v16
  v_add_u32 v16, 65536, v16
  v_bfe_u32 v17, v2, 2, 3
  s_lshl_b32 s60, s47, 2
  v_xor_b32 v17, s60, v17
  v_lshl_add_u32 v4, v17, 5, v16
  v_xor_b32 v18, 1, v17
  v_lshl_add_u32 v5, v18, 5, v16
  v_xor_b32 v18, 2, v17
  v_lshl_add_u32 v6, v18, 5, v16
  v_xor_b32 v18, 3, v17
  v_lshl_add_u32 v7, v18, 5, v16
  v_mov_b32 v64, 0
  v_mov_b32 v65, 0
  v_mov_b32 v66, 0
  v_mov_b32 v67, 0
  v_mov_b32 v68, 0
  v_mov_b32 v69, 0
  v_mov_b32 v70, 0
  v_mov_b32 v71, 0
  v_mov_b32 v72, 0
  v_mov_b32 v73, 0
  v_mov_b32 v74, 0
  v_mov_b32 v75, 0
  v_mov_b32 v76, 0
  v_mov_b32 v77, 0
  v_mov_b32 v78, 0
  v_mov_b32 v79, 0
  v_mov_b32 v80, 0
  v_mov_b32 v81, 0
  v_mov_b32 v82, 0
  v_mov_b32 v83, 0
  v_mov_b32 v84, 0
  v_mov_b32 v85, 0
  v_mov_b32 v86, 0
  v_mov_b32 v87, 0
  v_mov_b32 v88, 0
  v_mov_b32 v89, 0
  v_mov_b32 v90, 0
  v_mov_b32 v91, 0
  v_mov_b32 v92, 0
  v_mov_b32 v93, 0
  v_mov_b32 v94, 0
  v_mov_b32 v95, 0
  v_mov_b32 v96, 0
  v_mov_b32 v97, 0
  v_mov_b32 v98, 0
  v_mov_b32 v99, 0
  v_mov_b32 v100, 0
  v_mov_b32 v101, 0
  v_mov_b32 v102, 0
  v_mov_b32 v103, 0
  v_mov_b32 v104, 0
  v_mov_b32 v105, 0
  v_mov_b32 v106, 0
  v_mov_b32 v107, 0
  v_mov_b32 v108, 0
  v_mov_b32 v109, 0
  v_mov_b32 v110, 0
  v_mov_b32 v111, 0
  v_mov_b32 v112, 0
  v_mov_b32 v113, 0
  v_mov_b32 v114, 0
  v_mov_b32 v115, 0
  v_mov_b32 v116, 0
  v_mov_b32 v117, 0
  v_mov_b32 v118, 0
  v_mov_b32 v119, 0
  v_mov_b32 v120, 0
  v_mov_b32 v121, 0
  v_mov_b32 v122, 0
  v_mov_b32 v123, 0
  v_mov_b32 v124, 0
  v_mov_b32 v125, 0
  v_mov_b32 v126, 0
  v_mov_b32 v127, 0
  s_lshl_b32 s48, s47, 6
  s_add_u32 s48, s48, s45
  s_lshl_b32 s52, s43, 3
  s_add_u32 s52, s52, s42
  s_lshl_b32 s52, s52, 2
  s_and_b32 s53, s3, 3
  s_add_u32 s52, s52, s53
  s_lshl_b32 s52, s52, 13
  s_add_u32 s53, s52, 4096
  v_and_b32 v16, 7, v2
  v_lshlrev_b32 v16, 11, v16
  v_bfe_u32 v17, v2, 3, 1
  v_lshl_add_u32 v16, v17, 6, v16
  v_bfe_u32 v17, v2, 4, 1
  v_lshl_add_u32 v16, v17, 5, v16
  v_lshrrev_b32 v17, 5, v2
  v_lshl_add_u32 v0, v17, 4, v16
  s_lshl_b32 s54, s48, 11
  s_lshl_b32 s55, s46, 6
  s_add_u32 s55, s55, s44
  s_lshl_b32 s55, s55, 1
  s_add_u32 s54, s54, s55
  v_and_b32 v16, 15, v2
  v_add_u32 v16, s48, v16
  v_lshlrev_b32 v17, 1, v16
  v_lshlrev_b32 v18, 2, v16
  s_waitcnt lgkmcnt(0)
  s_mov_b32 s16, s6
  s_mov_b32 s17, s7
  s_mov_b32 s18, 4096
  s_mov_b32 s19, 0x00020000
  s_add_u32 s20, s38, 4194304
  s_addc_u32 s21, s39, 0
  s_mov_b32 s22, 8192
  s_mov_b32 s23, 0x00020000
  s_add_u32 s32, s38, 25165824
  s_addc_u32 s33, s39, 0
  s_mov_b32 s34, 4194304
  s_mov_b32 s35, 0x00020000
  s_mov_b32 s24, s12
  s_mov_b32 s25, s13
  s_mov_b32 s26, 4194304
  s_mov_b32 s27, 0x00020000
  buffer_load_dword v8, v18, s[20:23], 0 offen offset:0 sc1
  buffer_load_dword v10, v18, s[20:23], 0 offen offset:64 sc1
  buffer_load_dword v12, v18, s[20:23], 0 offen offset:128 sc1
  buffer_load_dword v14, v18, s[20:23], 0 offen offset:192 sc1
  buffer_load_ushort v9, v17, s[16:19], 0 offen offset:0
  buffer_load_ushort v11, v17, s[16:19], 0 offen offset:32
  buffer_load_ushort v13, v17, s[16:19], 0 offen offset:64
  buffer_load_ushort v15, v17, s[16:19], 0 offen offset:96
  s_setprio 0
  s_waitcnt vmcnt(0)
  s_barrier
  s_barrier
  s_barrier
  s_barrier
  s_barrier
L_g2:
  s_waitcnt vmcnt(0)
  v_sub_f32 v8, 1.0, v8
  v_lshlrev_b32 v9, 16, v9
  v_sub_f32 v10, 1.0, v10
  v_lshlrev_b32 v11, 16, v11
  v_sub_f32 v12, 1.0, v12
  v_lshlrev_b32 v13, 16, v13
  v_sub_f32 v14, 1.0, v14
  v_lshlrev_b32 v15, 16, v15
  v_mul_f32 v9, v8, v9
  v_mul_f32 v11, v10, v11
  v_mul_f32 v13, v12, v13
  v_mul_f32 v15, v14, v15
  s_cmp_eq_u32 s14, 0
  s_cbranch_scc0 L_B
  ds_read_b64_tr_b16 v[16:17], v4 offset:0
  ds_read_b64_tr_b16 v[18:19], v4 offset:4096
  ds_read_b64_tr_b16 v[20:21], v4 offset:8192
  ds_read_b64_tr_b16 v[22:23], v4 offset:12288
  ds_read_b128 v[32:35], v1 offset:0
  ds_read_b128 v[36:39], v1 offset:1024
  ds_read_b128 v[40:43], v1 offset:2048
  ds_read_b128 v[44:47], v1 offset:3072
  ds_read_b128 v[48:51], v1 offset:4096
  ds_read_b128 v[52:55], v1 offset:5120
  ds_read_b128 v[56:59], v1 offset:6144
  ds_read_b128 v[60:63], v1 offset:7168
  s_sub_u32 s50, 9, s49
  s_waitcnt lgkmcnt(0)
.p2align 6
LA_L0:
  s_waitcnt lgkmcnt(9)
  v_mfma_f32_16x16x32_bf16 v[64:67], v[32:35], v[16:19], v[64:67]
  ds_read_b64_tr_b16 v[24:25], v5 offset:0
  s_waitcnt lgkmcnt(7)
  v_mfma_f32_16x16x32_bf16 v[64:67], v[36:39], v[20:23], v[64:67]
  ds_read_b64_tr_b16 v[26:27], v5 offset:4096
  s_waitcnt lgkmcnt(7)
  v_mfma_f32_16x16x32_bf16 v[80:83], v[40:43], v[16:19], v[80:83]
  ds_read_b64_tr_b16 v[28:29], v5 offset:8192
  s_waitcnt lgkmcnt(7)
  v_mfma_f32_16x16x32_bf16 v[80:83], v[44:47], v[20:23], v[80:83]
  ds_read_b64_tr_b16 v[30:31], v5 offset:12288
  s_waitcnt lgkmcnt(7)
  v_mfma_f32_16x16x32_bf16 v[96:99], v[48:51], v[16:19], v[96:99]
  s_waitcnt lgkmcnt(6)
  v_mfma_f32_16x16x32_bf16 v[96:99], v[52:55], v[20:23], v[96:99]
  s_waitcnt lgkmcnt(5)
  v_mfma_f32_16x16x32_bf16 v[112:115], v[56:59], v[16:19], v[112:115]
  s_waitcnt lgkmcnt(4)
  v_mfma_f32_16x16x32_bf16 v[112:115], v[60:63], v[20:23], v[112:115]
  s_waitcnt lgkmcnt(2)
  v_mfma_f32_16x16x32_bf16 v[68:71], v[32:35], v[24:27], v[68:71]
  ds_read_b64_tr_b16 v[16:17], v6 offset:0
  s_waitcnt lgkmcnt(1)
  v_mfma_f32_16x16x32_bf16 v[68:71], v[36:39], v[28:31], v[68:71]
  ds_read_b64_tr_b16 v[18:19], v6 offset:4096
  v_mfma_f32_16x16x32_bf16 v[84:87], v[40:43], v[24:27], v[84:87]
  ds_read_b64_tr_b16 v[20:21], v6 offset:8192
  v_mfma_f32_16x16x32_bf16 v[84:87], v[44:47], v[28:31], v[84:87]
  ds_read_b64_tr_b16 v[22:23], v6 offset:12288
  v_mfma_f32_16x16x32_bf16 v[100:103], v[48:51], v[24:27], v[100:103]
  v_mfma_f32_16x16x32_bf16 v[100:103], v[52:55], v[28:31], v[100:103]
  v_mfma_f32_16x16x32_bf16 v[116:119], v[56:59], v[24:27], v[116:119]
  v_mfma_f32_16x16x32_bf16 v[116:119], v[60:63], v[28:31], v[116:119]
  s_waitcnt lgkmcnt(2)
  v_mfma_f32_16x16x32_bf16 v[72:75], v[32:35], v[16:19], v[72:75]
  ds_read_b64_tr_b16 v[24:25], v7 offset:0
  s_waitcnt lgkmcnt(1)
  v_mfma_f32_16x16x32_bf16 v[72:75], v[36:39], v[20:23], v[72:75]
  ds_read_b64_tr_b16 v[26:27], v7 offset:4096
  v_mfma_f32_16x16x32_bf16 v[88:91], v[40:43], v[16:19], v[88:91]
  ds_read_b64_tr_b16 v[28:29], v7 offset:8192
  v_mfma_f32_16x16x32_bf16 v[88:91], v[44:47], v[20:23], v[88:91]
  ds_read_b64_tr_b16 v[30:31], v7 offset:12288
  v_mfma_f32_16x16x32_bf16 v[104:107], v[48:51], v[16:19], v[104:107]
  v_mfma_f32_16x16x32_bf16 v[104:107], v[52:55], v[20:23], v[104:107]
  v_mfma_f32_16x16x32_bf16 v[120:123], v[56:59], v[16:19], v[120:123]
  v_mfma_f32_16x16x32_bf16 v[120:123], v[60:63], v[20:23], v[120:123]
  s_waitcnt lgkmcnt(0)
  s_barrier
  v_mfma_f32_16x16x32_bf16 v[76:79], v[32:35], v[24:27], v[76:79]
  ds_read_b64_tr_b16 v[16:17], v4 offset:16384
  v_mfma_f32_16x16x32_bf16 v[76:79], v[36:39], v[28:31], v[76:79]
  ds_read_b64_tr_b16 v[18:19], v4 offset:20480
  ds_read_b128 v[32:35], v1 offset:16384
  ds_read_b128 v[36:39], v1 offset:17408
  v_mfma_f32_16x16x32_bf16 v[92:95], v[40:43], v[24:27], v[92:95]
  ds_read_b64_tr_b16 v[20:21], v4 offset:24576
  v_mfma_f32_16x16x32_bf16 v[92:95], v[44:47], v[28:31], v[92:95]
  ds_read_b64_tr_b16 v[22:23], v4 offset:28672
  ds_read_b128 v[40:43], v1 offset:18432
  ds_read_b128 v[44:47], v1 offset:19456
  v_mfma_f32_16x16x32_bf16 v[108:111], v[48:51], v[24:27], v[108:111]
  v_mfma_f32_16x16x32_bf16 v[108:111], v[52:55], v[28:31], v[108:111]
  ds_read_b128 v[48:51], v1 offset:20480
  ds_read_b128 v[52:55], v1 offset:21504
  v_mfma_f32_16x16x32_bf16 v[124:127], v[56:59], v[24:27], v[124:127]
  v_mfma_f32_16x16x32_bf16 v[124:127], v[60:63], v[28:31], v[124:127]
  ds_read_b128 v[56:59], v1 offset:22528
  ds_read_b128 v[60:63], v1 offset:23552
  s_waitcnt lgkmcnt(9)
  v_mfma_f32_16x16x32_bf16 v[64:67], v[32:35], v[16:19], v[64:67]
  ds_read_b64_tr_b16 v[24:25], v5 offset:16384
  s_waitcnt lgkmcnt(7)
  v_mfma_f32_16x16x32_bf16 v[64:67], v[36:39], v[20:23], v[64:67]
  ds_read_b64_tr_b16 v[26:27], v5 offset:20480
  s_waitcnt lgkmcnt(7)
  v_mfma_f32_16x16x32_bf16 v[80:83], v[40:43], v[16:19], v[80:83]
  ds_read_b64_tr_b16 v[28:29], v5 offset:24576
  s_waitcnt lgkmcnt(7)
  v_mfma_f32_16x16x32_bf16 v[80:83], v[44:47], v[20:23], v[80:83]
  ds_read_b64_tr_b16 v[30:31], v5 offset:28672
  s_waitcnt lgkmcnt(7)
  v_mfma_f32_16x16x32_bf16 v[96:99], v[48:51], v[16:19], v[96:99]
  s_waitcnt lgkmcnt(6)
  v_mfma_f32_16x16x32_bf16 v[96:99], v[52:55], v[20:23], v[96:99]
  s_waitcnt lgkmcnt(5)
  v_mfma_f32_16x16x32_bf16 v[112:115], v[56:59], v[16:19], v[112:115]
  s_waitcnt lgkmcnt(4)
  v_mfma_f32_16x16x32_bf16 v[112:115], v[60:63], v[20:23], v[112:115]
  s_waitcnt lgkmcnt(2)
  v_mfma_f32_16x16x32_bf16 v[68:71], v[32:35], v[24:27], v[68:71]
  ds_read_b64_tr_b16 v[16:17], v6 offset:16384
  s_waitcnt lgkmcnt(1)
  v_mfma_f32_16x16x32_bf16 v[68:71], v[36:39], v[28:31], v[68:71]
  ds_read_b64_tr_b16 v[18:19], v6 offset:20480
  v_mfma_f32_16x16x32_bf16 v[84:87], v[40:43], v[24:27], v[84:87]
  ds_read_b64_tr_b16 v[20:21], v6 offset:24576
  v_mfma_f32_16x16x32_bf16 v[84:87], v[44:47], v[28:31], v[84:87]
  ds_read_b64_tr_b16 v[22:23], v6 offset:28672
  v_mfma_f32_16x16x32_bf16 v[100:103], v[48:51], v[24:27], v[100:103]
  v_mfma_f32_16x16x32_bf16 v[100:103], v[52:55], v[28:31], v[100:103]
  v_mfma_f32_16x16x32_bf16 v[116:119], v[56:59], v[24:27], v[116:119]
  v_mfma_f32_16x16x32_bf16 v[116:119], v[60:63], v[28:31], v[116:119]
  s_waitcnt lgkmcnt(2)
  v_mfma_f32_16x16x32_bf16 v[72:75], v[32:35], v[16:19], v[72:75]
  ds_read_b64_tr_b16 v[24:25], v7 offset:16384
  s_waitcnt lgkmcnt(1)
  v_mfma_f32_16x16x32_bf16 v[72:75], v[36:39], v[20:23], v[72:75]
  ds_read_b64_tr_b16 v[26:27], v7 offset:20480
  v_mfma_f32_16x16x32_bf16 v[88:91], v[40:43], v[16:19], v[88:91]
  ds_read_b64_tr_b16 v[28:29], v7 offset:24576
  v_mfma_f32_16x16x32_bf16 v[88:91], v[44:47], v[20:23], v[88:91]
  ds_read_b64_tr_b16 v[30:31], v7 offset:28672
  v_mfma_f32_16x16x32_bf16 v[104:107], v[48:51], v[16:19], v[104:107]
  v_mfma_f32_16x16x32_bf16 v[104:107], v[52:55], v[20:23], v[104:107]
  v_mfma_f32_16x16x32_bf16 v[120:123], v[56:59], v[16:19], v[120:123]
  v_mfma_f32_16x16x32_bf16 v[120:123], v[60:63], v[20:23], v[120:123]
  s_waitcnt lgkmcnt(0)
  s_barrier
  v_mfma_f32_16x16x32_bf16 v[76:79], v[32:35], v[24:27], v[76:79]
  ds_read_b64_tr_b16 v[16:17], v4 offset:32768
  v_mfma_f32_16x16x32_bf16 v[76:79], v[36:39], v[28:31], v[76:79]
  ds_read_b64_tr_b16 v[18:19], v4 offset:36864
  ds_read_b128 v[32:35], v1 offset:32768
  ds_read_b128 v[36:39], v1 offset:33792
  v_mfma_f32_16x16x32_bf16 v[92:95], v[40:43], v[24:27], v[92:95]
  ds_read_b64_tr_b16 v[20:21], v4 offset:40960
  v_mfma_f32_16x16x32_bf16 v[92:95], v[44:47], v[28:31], v[92:95]
  ds_read_b64_tr_b16 v[22:23], v4 offset:45056
  ds_read_b128 v[40:43], v1 offset:34816
  ds_read_b128 v[44:47], v1 offset:35840
  v_mfma_f32_16x16x32_bf16 v[108:111], v[48:51], v[24:27], v[108:111]
  v_mfma_f32_16x16x32_bf16 v[108:111], v[52:55], v[28:31], v[108:111]
  ds_read_b128 v[48:51], v1 offset:36864
  ds_read_b128 v[52:55], v1 offset:37888
  v_mfma_f32_16x16x32_bf16 v[124:127], v[56:59], v[24:27], v[124:127]
  v_mfma_f32_16x16x32_bf16 v[124:127], v[60:63], v[28:31], v[124:127]
  ds_read_b128 v[56:59], v1 offset:38912
  ds_read_b128 v[60:63], v1 offset:39936
  s_waitcnt lgkmcnt(9)
  v_mfma_f32_16x16x32_bf16 v[64:67], v[32:35], v[16:19], v[64:67]
  ds_read_b64_tr_b16 v[24:25], v5 offset:32768
  s_waitcnt lgkmcnt(7)
  v_mfma_f32_16x16x32_bf16 v[64:67], v[36:39], v[20:23], v[64:67]
  ds_read_b64_tr_b16 v[26:27], v5 offset:36864
  s_waitcnt lgkmcnt(7)
  v_mfma_f32_16x16x32_bf16 v[80:83], v[40:43], v[16:19], v[80:83]
  ds_read_b64_tr_b16 v[28:29], v5 offset:40960
  s_waitcnt lgkmcnt(7)
  v_mfma_f32_16x16x32_bf16 v[80:83], v[44:47], v[20:23], v[80:83]
  ds_read_b64_tr_b16 v[30:31], v5 offset:45056
  s_waitcnt lgkmcnt(7)
  v_mfma_f32_16x16x32_bf16 v[96:99], v[48:51], v[16:19], v[96:99]
  s_waitcnt lgkmcnt(6)
  v_mfma_f32_16x16x32_bf16 v[96:99], v[52:55], v[20:23], v[96:99]
  s_waitcnt lgkmcnt(5)
  v_mfma_f32_16x16x32_bf16 v[112:115], v[56:59], v[16:19], v[112:115]
  s_waitcnt lgkmcnt(4)
  v_mfma_f32_16x16x32_bf16 v[112:115], v[60:63], v[20:23], v[112:115]
  s_waitcnt lgkmcnt(2)
  v_mfma_f32_16x16x32_bf16 v[68:71], v[32:35], v[24:27], v[68:71]
  ds_read_b64_tr_b16 v[16:17], v6 offset:32768
  s_waitcnt lgkmcnt(1)
  v_mfma_f32_16x16x32_bf16 v[68:71], v[36:39], v[28:31], v[68:71]
  ds_read_b64_tr_b16 v[18:19], v6 offset:36864
  v_mfma_f32_16x16x32_bf16 v[84:87], v[40:43], v[24:27], v[84:87]
  ds_read_b64_tr_b16 v[20:21], v6 offset:40960
  v_mfma_f32_16x16x32_bf16 v[84:87], v[44:47], v[28:31], v[84:87]
  ds_read_b64_tr_b16 v[22:23], v6 offset:45056
  v_mfma_f32_16x16x32_bf16 v[100:103], v[48:51], v[24:27], v[100:103]
  v_mfma_f32_16x16x32_bf16 v[100:103], v[52:55], v[28:31], v[100:103]
  v_mfma_f32_16x16x32_bf16 v[116:119], v[56:59], v[24:27], v[116:119]
  v_mfma_f32_16x16x32_bf16 v[116:119], v[60:63], v[28:31], v[116:119]
  s_waitcnt lgkmcnt(2)
  v_mfma_f32_16x16x32_bf16 v[72:75], v[32:35], v[16:19], v[72:75]
  ds_read_b64_tr_b16 v[24:25], v7 offset:32768
  s_waitcnt lgkmcnt(1)
  v_mfma_f32_16x16x32_bf16 v[72:75], v[36:39], v[20:23], v[72:75]
  ds_read_b64_tr_b16 v[26:27], v7 offset:36864
  v_mfma_f32_16x16x32_bf16 v[88:91], v[40:43], v[16:19], v[88:91]
  ds_read_b64_tr_b16 v[28:29], v7 offset:40960
  v_mfma_f32_16x16x32_bf16 v[88:91], v[44:47], v[20:23], v[88:91]
  ds_read_b64_tr_b16 v[30:31], v7 offset:45056
  v_mfma_f32_16x16x32_bf16 v[104:107], v[48:51], v[16:19], v[104:107]
  v_mfma_f32_16x16x32_bf16 v[104:107], v[52:55], v[20:23], v[104:107]
  v_mfma_f32_16x16x32_bf16 v[120:123], v[56:59], v[16:19], v[120:123]
  v_mfma_f32_16x16x32_bf16 v[120:123], v[60:63], v[20:23], v[120:123]
  s_waitcnt lgkmcnt(0)
  s_barrier
  v_mfma_f32_16x16x32_bf16 v[76:79], v[32:35], v[24:27], v[76:79]
  ds_read_b64_tr_b16 v[16:17], v4 offset:49152
  v_mfma_f32_16x16x32_bf16 v[76:79], v[36:39], v[28:31], v[76:79]
  ds_read_b64_tr_b16 v[18:19], v4 offset:53248
  ds_read_b128 v[32:35], v1 offset:49152
  ds_read_b128 v[36:39], v1 offset:50176
  v_mfma_f32_16x16x32_bf16 v[92:95], v[40:43], v[24:27], v[92:95]
  ds_read_b64_tr_b16 v[20:21], v4 offset:57344
  v_mfma_f32_16x16x32_bf16 v[92:95], v[44:47], v[28:31], v[92:95]
  ds_read_b64_tr_b16 v[22:23], v4 offset:61440
  ds_read_b128 v[40:43], v1 offset:51200
  ds_read_b128 v[44:47], v1 offset:52224
  v_mfma_f32_16x16x32_bf16 v[108:111], v[48:51], v[24:27], v[108:111]
  v_mfma_f32_16x16x32_bf16 v[108:111], v[52:55], v[28:31], v[108:111]
  ds_read_b128 v[48:51], v1 offset:53248
  ds_read_b128 v[52:55], v1 offset:54272
  v_mfma_f32_16x16x32_bf16 v[124:127], v[56:59], v[24:27], v[124:127]
  v_mfma_f32_16x16x32_bf16 v[124:127], v[60:63], v[28:31], v[124:127]
  ds_read_b128 v[56:59], v1 offset:55296
  ds_read_b128 v[60:63], v1 offset:56320
  s_waitcnt lgkmcnt(9)
  v_mfma_f32_16x16x32_bf16 v[64:67], v[32:35], v[16:19], v[64:67]
  ds_read_b64_tr_b16 v[24:25], v5 offset:49152
  s_waitcnt lgkmcnt(7)
  v_mfma_f32_16x16x32_bf16 v[64:67], v[36:39], v[20:23], v[64:67]
  ds_read_b64_tr_b16 v[26:27], v5 offset:53248
  s_waitcnt lgkmcnt(7)
  v_mfma_f32_16x16x32_bf16 v[80:83], v[40:43], v[16:19], v[80:83]
  ds_read_b64_tr_b16 v[28:29], v5 offset:57344
  s_waitcnt lgkmcnt(7)
  v_mfma_f32_16x16x32_bf16 v[80:83], v[44:47], v[20:23], v[80:83]
  ds_read_b64_tr_b16 v[30:31], v5 offset:61440
  s_waitcnt lgkmcnt(7)
  v_mfma_f32_16x16x32_bf16 v[96:99], v[48:51], v[16:19], v[96:99]
  s_waitcnt lgkmcnt(6)
  v_mfma_f32_16x16x32_bf16 v[96:99], v[52:55], v[20:23], v[96:99]
  s_waitcnt lgkmcnt(5)
  v_mfma_f32_16x16x32_bf16 v[112:115], v[56:59], v[16:19], v[112:115]
  s_waitcnt lgkmcnt(4)
  v_mfma_f32_16x16x32_bf16 v[112:115], v[60:63], v[20:23], v[112:115]
  s_waitcnt lgkmcnt(2)
  v_mfma_f32_16x16x32_bf16 v[68:71], v[32:35], v[24:27], v[68:71]
  ds_read_b64_tr_b16 v[16:17], v6 offset:49152
  s_waitcnt lgkmcnt(1)
  v_mfma_f32_16x16x32_bf16 v[68:71], v[36:39], v[28:31], v[68:71]
  ds_read_b64_tr_b16 v[18:19], v6 offset:53248
  v_mfma_f32_16x16x32_bf16 v[84:87], v[40:43], v[24:27], v[84:87]
  ds_read_b64_tr_b16 v[20:21], v6 offset:57344
  v_mfma_f32_16x16x32_bf16 v[84:87], v[44:47], v[28:31], v[84:87]
  ds_read_b64_tr_b16 v[22:23], v6 offset:61440
  v_mfma_f32_16x16x32_bf16 v[100:103], v[48:51], v[24:27], v[100:103]
  v_mfma_f32_16x16x32_bf16 v[100:103], v[52:55], v[28:31], v[100:103]
  v_mfma_f32_16x16x32_bf16 v[116:119], v[56:59], v[24:27], v[116:119]
  v_mfma_f32_16x16x32_bf16 v[116:119], v[60:63], v[28:31], v[116:119]
  s_waitcnt lgkmcnt(2)
  v_mfma_f32_16x16x32_bf16 v[72:75], v[32:35], v[16:19], v[72:75]
  ds_read_b64_tr_b16 v[24:25], v7 offset:49152
  s_waitcnt lgkmcnt(1)
  v_mfma_f32_16x16x32_bf16 v[72:75], v[36:39], v[20:23], v[72:75]
  ds_read_b64_tr_b16 v[26:27], v7 offset:53248
  v_mfma_f32_16x16x32_bf16 v[88:91], v[40:43], v[16:19], v[88:91]
  ds_read_b64_tr_b16 v[28:29], v7 offset:57344
  v_mfma_f32_16x16x32_bf16 v[88:91], v[44:47], v[20:23], v[88:91]
  ds_read_b64_tr_b16 v[30:31], v7 offset:61440
  v_mfma_f32_16x16x32_bf16 v[104:107], v[48:51], v[16:19], v[104:107]
  v_mfma_f32_16x16x32_bf16 v[104:107], v[52:55], v[20:23], v[104:107]
  v_mfma_f32_16x16x32_bf16 v[120:123], v[56:59], v[16:19], v[120:123]
  v_mfma_f32_16x16x32_bf16 v[120:123], v[60:63], v[20:23], v[120:123]
  s_sub_u32 s50, s50, 1
  s_cmp_lg_u32 s50, 0
  s_waitcnt lgkmcnt(0)
  s_barrier
  v_mfma_f32_16x16x32_bf16 v[76:79], v[32:35], v[24:27], v[76:79]
  ds_read_b64_tr_b16 v[16:17], v4 offset:0
  v_mfma_f32_16x16x32_bf16 v[76:79], v[36:39], v[28:31], v[76:79]
  ds_read_b64_tr_b16 v[18:19], v4 offset:4096
  ds_read_b128 v[32:35], v1 offset:0
  ds_read_b128 v[36:39], v1 offset:1024
  v_mfma_f32_16x16x32_bf16 v[92:95], v[40:43], v[24:27], v[92:95]
  ds_read_b64_tr_b16 v[20:21], v4 offset:8192
  v_mfma_f32_16x16x32_bf16 v[92:95], v[44:47], v[28:31], v[92:95]
  ds_read_b64_tr_b16 v[22:23], v4 offset:12288
  ds_read_b128 v[40:43], v1 offset:2048
  ds_read_b128 v[44:47], v1 offset:3072
  v_mfma_f32_16x16x32_bf16 v[108:111], v[48:51], v[24:27], v[108:111]
  v_mfma_f32_16x16x32_bf16 v[108:111], v[52:55], v[28:31], v[108:111]
  ds_read_b128 v[48:51], v1 offset:4096
  ds_read_b128 v[52:55], v1 offset:5120
  v_mfma_f32_16x16x32_bf16 v[124:127], v[56:59], v[24:27], v[124:127]
  v_mfma_f32_16x16x32_bf16 v[124:127], v[60:63], v[28:31], v[124:127]
  ds_read_b128 v[56:59], v1 offset:6144
  ds_read_b128 v[60:63], v1 offset:7168
  s_cbranch_scc1 LA_L0
  s_waitcnt lgkmcnt(9)
  v_mfma_f32_16x16x32_bf16 v[64:67], v[32:35], v[16:19], v[64:67]
  ds_read_b64_tr_b16 v[24:25], v5 offset:0
  s_waitcnt lgkmcnt(7)
  v_mfma_f32_16x16x32_bf16 v[64:67], v[36:39], v[20:23], v[64:67]
  ds_read_b64_tr_b16 v[26:27], v5 offset:4096
  s_waitcnt lgkmcnt(7)
  v_mfma_f32_16x16x32_bf16 v[80:83], v[40:43], v[16:19], v[80:83]
  ds_read_b64_tr_b16 v[28:29], v5 offset:8192
  s_waitcnt lgkmcnt(7)
  v_mfma_f32_16x16x32_bf16 v[80:83], v[44:47], v[20:23], v[80:83]
  ds_read_b64_tr_b16 v[30:31], v5 offset:12288
  s_waitcnt lgkmcnt(7)
  v_mfma_f32_16x16x32_bf16 v[96:99], v[48:51], v[16:19], v[96:99]
  s_waitcnt lgkmcnt(6)
  v_mfma_f32_16x16x32_bf16 v[96:99], v[52:55], v[20:23], v[96:99]
  s_waitcnt lgkmcnt(5)
  v_mfma_f32_16x16x32_bf16 v[112:115], v[56:59], v[16:19], v[112:115]
  s_waitcnt lgkmcnt(4)
  v_mfma_f32_16x16x32_bf16 v[112:115], v[60:63], v[20:23], v[112:115]
  s_waitcnt lgkmcnt(2)
  v_mfma_f32_16x16x32_bf16 v[68:71], v[32:35], v[24:27], v[68:71]
  ds_read_b64_tr_b16 v[16:17], v6 offset:0
  s_waitcnt lgkmcnt(1)
  v_mfma_f32_16x16x32_bf16 v[68:71], v[36:39], v[28:31], v[68:71]
  ds_read_b64_tr_b16 v[18:19], v6 offset:4096
  v_mfma_f32_16x16x32_bf16 v[84:87], v[40:43], v[24:27], v[84:87]
  ds_read_b64_tr_b16 v[20:21], v6 offset:8192
  v_mfma_f32_16x16x32_bf16 v[84:87], v[44:47], v[28:31], v[84:87]
  ds_read_b64_tr_b16 v[22:23], v6 offset:12288
  v_mfma_f32_16x16x32_bf16 v[100:103], v[48:51], v[24:27], v[100:103]
  v_mfma_f32_16x16x32_bf16 v[100:103], v[52:55], v[28:31], v[100:103]
  v_mfma_f32_16x16x32_bf16 v[116:119], v[56:59], v[24:27], v[116:119]
  v_mfma_f32_16x16x32_bf16 v[116:119], v[60:63], v[28:31], v[116:119]
  s_waitcnt lgkmcnt(2)
  v_mfma_f32_16x16x32_bf16 v[72:75], v[32:35], v[16:19], v[72:75]
  ds_read_b64_tr_b16 v[24:25], v7 offset:0
  s_waitcnt lgkmcnt(1)
  v_mfma_f32_16x16x32_bf16 v[72:75], v[36:39], v[20:23], v[72:75]
  ds_read_b64_tr_b16 v[26:27], v7 offset:4096
  v_mfma_f32_16x16x32_bf16 v[88:91], v[40:43], v[16:19], v[88:91]
  ds_read_b64_tr_b16 v[28:29], v7 offset:8192
  v_mfma_f32_16x16x32_bf16 v[88:91], v[44:47], v[20:23], v[88:91]
  ds_read_b64_tr_b16 v[30:31], v7 offset:12288
  v_mfma_f32_16x16x32_bf16 v[104:107], v[48:51], v[16:19], v[104:107]
  v_mfma_f32_16x16x32_bf16 v[104:107], v[52:55], v[20:23], v[104:107]
  v_mfma_f32_16x16x32_bf16 v[120:123], v[56:59], v[16:19], v[120:123]
  v_mfma_f32_16x16x32_bf16 v[120:123], v[60:63], v[20:23], v[120:123]
  s_waitcnt lgkmcnt(0)
  s_barrier
  v_mfma_f32_16x16x32_bf16 v[76:79], v[32:35], v[24:27], v[76:79]
  ds_read_b64_tr_b16 v[16:17], v4 offset:16384
  v_mfma_f32_16x16x32_bf16 v[76:79], v[36:39], v[28:31], v[76:79]
  ds_read_b64_tr_b16 v[18:19], v4 offset:20480
  ds_read_b128 v[32:35], v1 offset:16384
  ds_read_b128 v[36:39], v1 offset:17408
  v_mfma_f32_16x16x32_bf16 v[92:95], v[40:43], v[24:27], v[92:95]
  ds_read_b64_tr_b16 v[20:21], v4 offset:24576
  v_mfma_f32_16x16x32_bf16 v[92:95], v[44:47], v[28:31], v[92:95]
  ds_read_b64_tr_b16 v[22:23], v4 offset:28672
  ds_read_b128 v[40:43], v1 offset:18432
  ds_read_b128 v[44:47], v1 offset:19456
  v_mfma_f32_16x16x32_bf16 v[108:111], v[48:51], v[24:27], v[108:111]
  v_mfma_f32_16x16x32_bf16 v[108:111], v[52:55], v[28:31], v[108:111]
  ds_read_b128 v[48:51], v1 offset:20480
  ds_read_b128 v[52:55], v1 offset:21504
  v_mfma_f32_16x16x32_bf16 v[124:127], v[56:59], v[24:27], v[124:127]
  v_mfma_f32_16x16x32_bf16 v[124:127], v[60:63], v[28:31], v[124:127]
  ds_read_b128 v[56:59], v1 offset:22528
  ds_read_b128 v[60:63], v1 offset:23552
  s_waitcnt lgkmcnt(9)
  v_mfma_f32_16x16x32_bf16 v[64:67], v[32:35], v[16:19], v[64:67]
  ds_read_b64_tr_b16 v[24:25], v5 offset:16384
  s_waitcnt lgkmcnt(7)
  v_mfma_f32_16x16x32_bf16 v[64:67], v[36:39], v[20:23], v[64:67]
  ds_read_b64_tr_b16 v[26:27], v5 offset:20480
  s_waitcnt lgkmcnt(7)
  v_mfma_f32_16x16x32_bf16 v[80:83], v[40:43], v[16:19], v[80:83]
  ds_read_b64_tr_b16 v[28:29], v5 offset:24576
  s_waitcnt lgkmcnt(7)
  v_mfma_f32_16x16x32_bf16 v[80:83], v[44:47], v[20:23], v[80:83]
  ds_read_b64_tr_b16 v[30:31], v5 offset:28672
  s_waitcnt lgkmcnt(7)
  v_mfma_f32_16x16x32_bf16 v[96:99], v[48:51], v[16:19], v[96:99]
  s_waitcnt lgkmcnt(6)
  v_mfma_f32_16x16x32_bf16 v[96:99], v[52:55], v[20:23], v[96:99]
  s_waitcnt lgkmcnt(5)
  v_mfma_f32_16x16x32_bf16 v[112:115], v[56:59], v[16:19], v[112:115]
  s_waitcnt lgkmcnt(4)
  v_mfma_f32_16x16x32_bf16 v[112:115], v[60:63], v[20:23], v[112:115]
  s_waitcnt lgkmcnt(2)
  v_mfma_f32_16x16x32_bf16 v[68:71], v[32:35], v[24:27], v[68:71]
  ds_read_b64_tr_b16 v[16:17], v6 offset:16384
  s_waitcnt lgkmcnt(1)
  v_mfma_f32_16x16x32_bf16 v[68:71], v[36:39], v[28:31], v[68:71]
  ds_read_b64_tr_b16 v[18:19], v6 offset:20480
  v_mfma_f32_16x16x32_bf16 v[84:87], v[40:43], v[24:27], v[84:87]
  ds_read_b64_tr_b16 v[20:21], v6 offset:24576
  v_mfma_f32_16x16x32_bf16 v[84:87], v[44:47], v[28:31], v[84:87]
  ds_read_b64_tr_b16 v[22:23], v6 offset:28672
  v_mfma_f32_16x16x32_bf16 v[100:103], v[48:51], v[24:27], v[100:103]
  v_mfma_f32_16x16x32_bf16 v[100:103], v[52:55], v[28:31], v[100:103]
  v_mfma_f32_16x16x32_bf16 v[116:119], v[56:59], v[24:27], v[116:119]
  v_mfma_f32_16x16x32_bf16 v[116:119], v[60:63], v[28:31], v[116:119]
  s_waitcnt lgkmcnt(2)
  v_mfma_f32_16x16x32_bf16 v[72:75], v[32:35], v[16:19], v[72:75]
  ds_read_b64_tr_b16 v[24:25], v7 offset:16384
  s_waitcnt lgkmcnt(1)
  v_mfma_f32_16x16x32_bf16 v[72:75], v[36:39], v[20:23], v[72:75]
  ds_read_b64_tr_b16 v[26:27], v7 offset:20480
  v_mfma_f32_16x16x32_bf16 v[88:91], v[40:43], v[16:19], v[88:91]
  ds_read_b64_tr_b16 v[28:29], v7 offset:24576
  v_mfma_f32_16x16x32_bf16 v[88:91], v[44:47], v[20:23], v[88:91]
  ds_read_b64_tr_b16 v[30:31], v7 offset:28672
  v_mfma_f32_16x16x32_bf16 v[104:107], v[48:51], v[16:19], v[104:107]
  v_mfma_f32_16x16x32_bf16 v[104:107], v[52:55], v[20:23], v[104:107]
  v_mfma_f32_16x16x32_bf16 v[120:123], v[56:59], v[16:19], v[120:123]
  v_mfma_f32_16x16x32_bf16 v[120:123], v[60:63], v[20:23], v[120:123]
  s_waitcnt lgkmcnt(0)
  s_barrier
  v_mfma_f32_16x16x32_bf16 v[76:79], v[32:35], v[24:27], v[76:79]
  ds_read_b64_tr_b16 v[16:17], v4 offset:32768
  v_mfma_f32_16x16x32_bf16 v[76:79], v[36:39], v[28:31], v[76:79]
  ds_read_b64_tr_b16 v[18:19], v4 offset:36864
  ds_read_b128 v[32:35], v1 offset:32768
  ds_read_b128 v[36:39], v1 offset:33792
  v_mfma_f32_16x16x32_bf16 v[92:95], v[40:43], v[24:27], v[92:95]
  ds_read_b64_tr_b16 v[20:21], v4 offset:40960
  v_mfma_f32_16x16x32_bf16 v[92:95], v[44:47], v[28:31], v[92:95]
  ds_read_b64_tr_b16 v[22:23], v4 offset:45056
  ds_read_b128 v[40:43], v1 offset:34816
  ds_read_b128 v[44:47], v1 offset:35840
  v_mfma_f32_16x16x32_bf16 v[108:111], v[48:51], v[24:27], v[108:111]
  v_mfma_f32_16x16x32_bf16 v[108:111], v[52:55], v[28:31], v[108:111]
  ds_read_b128 v[48:51], v1 offset:36864
  ds_read_b128 v[52:55], v1 offset:37888
  v_mfma_f32_16x16x32_bf16 v[124:127], v[56:59], v[24:27], v[124:127]
  v_mfma_f32_16x16x32_bf16 v[124:127], v[60:63], v[28:31], v[124:127]
  ds_read_b128 v[56:59], v1 offset:38912
  ds_read_b128 v[60:63], v1 offset:39936
  s_waitcnt lgkmcnt(9)
  v_mfma_f32_16x16x32_bf16 v[64:67], v[32:35], v[16:19], v[64:67]
  ds_read_b64_tr_b16 v[24:25], v5 offset:32768
  s_waitcnt lgkmcnt(7)
  v_mfma_f32_16x16x32_bf16 v[64:67], v[36:39], v[20:23], v[64:67]
  ds_read_b64_tr_b16 v[26:27], v5 offset:36864
  s_waitcnt lgkmcnt(7)
  v_mfma_f32_16x16x32_bf16 v[80:83], v[40:43], v[16:19], v[80:83]
  ds_read_b64_tr_b16 v[28:29], v5 offset:40960
  s_waitcnt lgkmcnt(7)
  v_mfma_f32_16x16x32_bf16 v[80:83], v[44:47], v[20:23], v[80:83]
  ds_read_b64_tr_b16 v[30:31], v5 offset:45056
  s_waitcnt lgkmcnt(7)
  v_mfma_f32_16x16x32_bf16 v[96:99], v[48:51], v[16:19], v[96:99]
  s_waitcnt lgkmcnt(6)
  v_mfma_f32_16x16x32_bf16 v[96:99], v[52:55], v[20:23], v[96:99]
  s_waitcnt lgkmcnt(5)
  v_mfma_f32_16x16x32_bf16 v[112:115], v[56:59], v[16:19], v[112:115]
  s_waitcnt lgkmcnt(4)
  v_mfma_f32_16x16x32_bf16 v[112:115], v[60:63], v[20:23], v[112:115]
  s_waitcnt lgkmcnt(2)
  v_mfma_f32_16x16x32_bf16 v[68:71], v[32:35], v[24:27], v[68:71]
  ds_read_b64_tr_b16 v[16:17], v6 offset:32768
  s_waitcnt lgkmcnt(1)
  v_mfma_f32_16x16x32_bf16 v[68:71], v[36:39], v[28:31], v[68:71]
  ds_read_b64_tr_b16 v[18:19], v6 offset:36864
  v_mfma_f32_16x16x32_bf16 v[84:87], v[40:43], v[24:27], v[84:87]
  ds_read_b64_tr_b16 v[20:21], v6 offset:40960
  v_mfma_f32_16x16x32_bf16 v[84:87], v[44:47], v[28:31], v[84:87]
  ds_read_b64_tr_b16 v[22:23], v6 offset:45056
  v_mfma_f32_16x16x32_bf16 v[100:103], v[48:51], v[24:27], v[100:103]
  v_mfma_f32_16x16x32_bf16 v[100:103], v[52:55], v[28:31], v[100:103]
  v_mfma_f32_16x16x32_bf16 v[116:119], v[56:59], v[24:27], v[116:119]
  v_mfma_f32_16x16x32_bf16 v[116:119], v[60:63], v[28:31], v[116:119]
  s_waitcnt lgkmcnt(2)
  v_mfma_f32_16x16x32_bf16 v[72:75], v[32:35], v[16:19], v[72:75]
  ds_read_b64_tr_b16 v[24:25], v7 offset:32768
  s_waitcnt lgkmcnt(1)
  v_mfma_f32_16x16x32_bf16 v[72:75], v[36:39], v[20:23], v[72:75]
  ds_read_b64_tr_b16 v[26:27], v7 offset:36864
  v_mfma_f32_16x16x32_bf16 v[88:91], v[40:43], v[16:19], v[88:91]
  ds_read_b64_tr_b16 v[28:29], v7 offset:40960
  v_mfma_f32_16x16x32_bf16 v[88:91], v[44:47], v[20:23], v[88:91]
  ds_read_b64_tr_b16 v[30:31], v7 offset:45056
  v_mfma_f32_16x16x32_bf16 v[104:107], v[48:51], v[16:19], v[104:107]
  v_mfma_f32_16x16x32_bf16 v[104:107], v[52:55], v[20:23], v[104:107]
  v_mfma_f32_16x16x32_bf16 v[120:123], v[56:59], v[16:19], v[120:123]
  v_mfma_f32_16x16x32_bf16 v[120:123], v[60:63], v[20:23], v[120:123]
  s_waitcnt lgkmcnt(0)
  s_barrier
  v_mfma_f32_16x16x32_bf16 v[76:79], v[32:35], v[24:27], v[76:79]
  ds_read_b64_tr_b16 v[16:17], v4 offset:49152
  v_mfma_f32_16x16x32_bf16 v[76:79], v[36:39], v[28:31], v[76:79]
  ds_read_b64_tr_b16 v[18:19], v4 offset:53248
  ds_read_b128 v[32:35], v1 offset:49152
  ds_read_b128 v[36:39], v1 offset:50176
  v_mfma_f32_16x16x32_bf16 v[92:95], v[40:43], v[24:27], v[92:95]
  ds_read_b64_tr_b16 v[20:21], v4 offset:57344
  v_mfma_f32_16x16x32_bf16 v[92:95], v[44:47], v[28:31], v[92:95]
  ds_read_b64_tr_b16 v[22:23], v4 offset:61440
  ds_read_b128 v[40:43], v1 offset:51200
  ds_read_b128 v[44:47], v1 offset:52224
  v_mfma_f32_16x16x32_bf16 v[108:111], v[48:51], v[24:27], v[108:111]
  v_mfma_f32_16x16x32_bf16 v[108:111], v[52:55], v[28:31], v[108:111]
  ds_read_b128 v[48:51], v1 offset:53248
  ds_read_b128 v[52:55], v1 offset:54272
  v_mfma_f32_16x16x32_bf16 v[124:127], v[56:59], v[24:27], v[124:127]
  v_mfma_f32_16x16x32_bf16 v[124:127], v[60:63], v[28:31], v[124:127]
  ds_read_b128 v[56:59], v1 offset:55296
  ds_read_b128 v[60:63], v1 offset:56320
  s_waitcnt lgkmcnt(9)
  v_mfma_f32_16x16x32_bf16 v[64:67], v[32:35], v[16:19], v[64:67]
  ds_read_b64_tr_b16 v[24:25], v5 offset:49152
  s_waitcnt lgkmcnt(7)
  v_mfma_f32_16x16x32_bf16 v[64:67], v[36:39], v[20:23], v[64:67]
  ds_read_b64_tr_b16 v[26:27], v5 offset:53248
  s_waitcnt lgkmcnt(7)
  v_mfma_f32_16x16x32_bf16 v[80:83], v[40:43], v[16:19], v[80:83]
  ds_read_b64_tr_b16 v[28:29], v5 offset:57344
  s_waitcnt lgkmcnt(7)
  v_mfma_f32_16x16x32_bf16 v[80:83], v[44:47], v[20:23], v[80:83]
  ds_read_b64_tr_b16 v[30:31], v5 offset:61440
  s_waitcnt lgkmcnt(7)
  v_mfma_f32_16x16x32_bf16 v[96:99], v[48:51], v[16:19], v[96:99]
  s_waitcnt lgkmcnt(6)
  v_mfma_f32_16x16x32_bf16 v[96:99], v[52:55], v[20:23], v[96:99]
  s_waitcnt lgkmcnt(5)
  v_mfma_f32_16x16x32_bf16 v[112:115], v[56:59], v[16:19], v[112:115]
  s_waitcnt lgkmcnt(4)
  v_mfma_f32_16x16x32_bf16 v[112:115], v[60:63], v[20:23], v[112:115]
  s_waitcnt lgkmcnt(2)
  v_mfma_f32_16x16x32_bf16 v[68:71], v[32:35], v[24:27], v[68:71]
  ds_read_b64_tr_b16 v[16:17], v6 offset:49152
  s_waitcnt lgkmcnt(1)
  v_mfma_f32_16x16x32_bf16 v[68:71], v[36:39], v[28:31], v[68:71]
  ds_read_b64_tr_b16 v[18:19], v6 offset:53248
  v_mfma_f32_16x16x32_bf16 v[84:87], v[40:43], v[24:27], v[84:87]
  ds_read_b64_tr_b16 v[20:21], v6 offset:57344
  v_mfma_f32_16x16x32_bf16 v[84:87], v[44:47], v[28:31], v[84:87]
  ds_read_b64_tr_b16 v[22:23], v6 offset:61440
  v_mfma_f32_16x16x32_bf16 v[100:103], v[48:51], v[24:27], v[100:103]
  v_mfma_f32_16x16x32_bf16 v[100:103], v[52:55], v[28:31], v[100:103]
  v_mfma_f32_16x16x32_bf16 v[116:119], v[56:59], v[24:27], v[116:119]
  v_mfma_f32_16x16x32_bf16 v[116:119], v[60:63], v[28:31], v[116:119]
  s_waitcnt lgkmcnt(2)
  v_mfma_f32_16x16x32_bf16 v[72:75], v[32:35], v[16:19], v[72:75]
  ds_read_b64_tr_b16 v[24:25], v7 offset:49152
  s_waitcnt lgkmcnt(1)
  v_mfma_f32_16x16x32_bf16 v[72:75], v[36:39], v[20:23], v[72:75]
  ds_read_b64_tr_b16 v[26:27], v7 offset:53248
  v_mfma_f32_16x16x32_bf16 v[88:91], v[40:43], v[16:19], v[88:91]
  ds_read_b64_tr_b16 v[28:29], v7 offset:57344
  v_mfma_f32_16x16x32_bf16 v[88:91], v[44:47], v[20:23], v[88:91]
  ds_read_b64_tr_b16 v[30:31], v7 offset:61440
  v_mfma_f32_16x16x32_bf16 v[104:107], v[48:51], v[16:19], v[104:107]
  v_mfma_f32_16x16x32_bf16 v[104:107], v[52:55], v[20:23], v[104:107]
  v_mfma_f32_16x16x32_bf16 v[120:123], v[56:59], v[16:19], v[120:123]
  v_mfma_f32_16x16x32_bf16 v[120:123], v[60:63], v[20:23], v[120:123]
  s_waitcnt lgkmcnt(2)
  v_mfma_f32_16x16x32_bf16 v[76:79], v[32:35], v[24:27], v[76:79]
  s_waitcnt lgkmcnt(0)
  v_mfma_f32_16x16x32_bf16 v[76:79], v[36:39], v[28:31], v[76:79]
  v_mfma_f32_16x16x32_bf16 v[92:95], v[40:43], v[24:27], v[92:95]
  v_mfma_f32_16x16x32_bf16 v[92:95], v[44:47], v[28:31], v[92:95]
  v_mfma_f32_16x16x32_bf16 v[108:111], v[48:51], v[24:27], v[108:111]
  v_mfma_f32_16x16x32_bf16 v[108:111], v[52:55], v[28:31], v[108:111]
  v_mfma_f32_16x16x32_bf16 v[124:127], v[56:59], v[24:27], v[124:127]
  v_mfma_f32_16x16x32_bf16 v[124:127], v[60:63], v[28:31], v[124:127]
  s_branch L_epi
L_B:
  ds_read_b64_tr_b16 v[16:17], v4 offset:0
  ds_read_b64_tr_b16 v[18:19], v4 offset:4096
  ds_read_b64_tr_b16 v[20:21], v4 offset:8192
  ds_read_b64_tr_b16 v[22:23], v4 offset:12288
  ds_read_b128 v[32:35], v1 offset:0
  ds_read_b128 v[36:39], v1 offset:1024
  ds_read_b128 v[40:43], v1 offset:2048
  ds_read_b128 v[44:47], v1 offset:3072
  ds_read_b128 v[48:51], v1 offset:4096
  ds_read_b128 v[52:55], v1 offset:5120
  ds_read_b128 v[56:59], v1 offset:6144
  ds_read_b128 v[60:63], v1 offset:7168
  s_sub_u32 s50, 5, s49
  s_waitcnt lgkmcnt(0)
.p2align 6
LB_L0:
  s_waitcnt lgkmcnt(9)
  v_mfma_f32_16x16x32_bf16 v[64:67], v[32:35], v[16:19], v[64:67]
  ds_read_b64_tr_b16 v[24:25], v5 offset:0
  s_waitcnt lgkmcnt(7)
  v_mfma_f32_16x16x32_bf16 v[64:67], v[36:39], v[20:23], v[64:67]
  ds_read_b64_tr_b16 v[26:27], v5 offset:4096
  s_waitcnt lgkmcnt(7)
  v_mfma_f32_16x16x32_bf16 v[80:83], v[40:43], v[16:19], v[80:83]
  ds_read_b64_tr_b16 v[28:29], v5 offset:8192
  s_waitcnt lgkmcnt(7)
  v_mfma_f32_16x16x32_bf16 v[80:83], v[44:47], v[20:23], v[80:83]
  ds_read_b64_tr_b16 v[30:31], v5 offset:12288
  s_waitcnt lgkmcnt(7)
  v_mfma_f32_16x16x32_bf16 v[96:99], v[48:51], v[16:19], v[96:99]
  s_waitcnt lgkmcnt(6)
  v_mfma_f32_16x16x32_bf16 v[96:99], v[52:55], v[20:23], v[96:99]
  s_waitcnt lgkmcnt(5)
  v_mfma_f32_16x16x32_bf16 v[112:115], v[56:59], v[16:19], v[112:115]
  s_waitcnt lgkmcnt(4)
  v_mfma_f32_16x16x32_bf16 v[112:115], v[60:63], v[20:23], v[112:115]
  s_waitcnt lgkmcnt(2)
  v_mfma_f32_16x16x32_bf16 v[68:71], v[32:35], v[24:27], v[68:71]
  ds_read_b64_tr_b16 v[16:17], v6 offset:0
  s_waitcnt lgkmcnt(1)
  v_mfma_f32_16x16x32_bf16 v[68:71], v[36:39], v[28:31], v[68:71]
  ds_read_b64_tr_b16 v[18:19], v6 offset:4096
  v_mfma_f32_16x16x32_bf16 v[84:87], v[40:43], v[24:27], v[84:87]
  ds_read_b64_tr_b16 v[20:21], v6 offset:8192
  v_mfma_f32_16x16x32_bf16 v[84:87], v[44:47], v[28:31], v[84:87]
  ds_read_b64_tr_b16 v[22:23], v6 offset:12288
  v_mfma_f32_16x16x32_bf16 v[100:103], v[48:51], v[24:27], v[100:103]
  v_mfma_f32_16x16x32_bf16 v[100:103], v[52:55], v[28:31], v[100:103]
  v_mfma_f32_16x16x32_bf16 v[116:119], v[56:59], v[24:27], v[116:119]
  v_mfma_f32_16x16x32_bf16 v[116:119], v[60:63], v[28:31], v[116:119]
  s_waitcnt lgkmcnt(2)
  v_mfma_f32_16x16x32_bf16 v[72:75], v[32:35], v[16:19], v[72:75]
  ds_read_b64_tr_b16 v[24:25], v7 offset:0
  s_waitcnt lgkmcnt(1)
  v_mfma_f32_16x16x32_bf16 v[72:75], v[36:39], v[20:23], v[72:75]
  ds_read_b64_tr_b16 v[26:27], v7 offset:4096
  v_mfma_f32_16x16x32_bf16 v[88:91], v[40:43], v[16:19], v[88:91]
  ds_read_b64_tr_b16 v[28:29], v7 offset:8192
  v_mfma_f32_16x16x32_bf16 v[88:91], v[44:47], v[20:23], v[88:91]
  ds_read_b64_tr_b16 v[30:31], v7 offset:12288
  v_mfma_f32_16x16x32_bf16 v[104:107], v[48:51], v[16:19], v[104:107]
  v_mfma_f32_16x16x32_bf16 v[104:107], v[52:55], v[20:23], v[104:107]
  v_mfma_f32_16x16x32_bf16 v[120:123], v[56:59], v[16:19], v[120:123]
  v_mfma_f32_16x16x32_bf16 v[120:123], v[60:63], v[20:23], v[120:123]
  s_waitcnt lgkmcnt(0)
  s_barrier
  v_mfma_f32_16x16x32_bf16 v[76:79], v[32:35], v[24:27], v[76:79]
  ds_read_b64_tr_b16 v[16:17], v4 offset:16384
  v_mfma_f32_16x16x32_bf16 v[76:79], v[36:39], v[28:31], v[76:79]
  ds_read_b64_tr_b16 v[18:19], v4 offset:20480
  ds_read_b128 v[32:35], v1 offset:16384
  ds_read_b128 v[36:39], v1 offset:17408
  v_mfma_f32_16x16x32_bf16 v[92:95], v[40:43], v[24:27], v[92:95]
  ds_read_b64_tr_b16 v[20:21], v4 offset:24576
  v_mfma_f32_16x16x32_bf16 v[92:95], v[44:47], v[28:31], v[92:95]
  ds_read_b64_tr_b16 v[22:23], v4 offset:28672
  ds_read_b128 v[40:43], v1 offset:18432
  ds_read_b128 v[44:47], v1 offset:19456
  v_mfma_f32_16x16x32_bf16 v[108:111], v[48:51], v[24:27], v[108:111]
  v_mfma_f32_16x16x32_bf16 v[108:111], v[52:55], v[28:31], v[108:111]
  ds_read_b128 v[48:51], v1 offset:20480
  ds_read_b128 v[52:55], v1 offset:21504
  v_mfma_f32_16x16x32_bf16 v[124:127], v[56:59], v[24:27], v[124:127]
  v_mfma_f32_16x16x32_bf16 v[124:127], v[60:63], v[28:31], v[124:127]
  ds_read_b128 v[56:59], v1 offset:22528
  ds_read_b128 v[60:63], v1 offset:23552
  s_waitcnt lgkmcnt(9)
  v_mfma_f32_16x16x32_bf16 v[64:67], v[32:35], v[16:19], v[64:67]
  ds_read_b64_tr_b16 v[24:25], v5 offset:16384
  s_waitcnt lgkmcnt(7)
  v_mfma_f32_16x16x32_bf16 v[64:67], v[36:39], v[20:23], v[64:67]
  ds_read_b64_tr_b16 v[26:27], v5 offset:20480
  s_waitcnt lgkmcnt(7)
  v_mfma_f32_16x16x32_bf16 v[80:83], v[40:43], v[16:19], v[80:83]
  ds_read_b64_tr_b16 v[28:29], v5 offset:24576
  s_waitcnt lgkmcnt(7)
  v_mfma_f32_16x16x32_bf16 v[80:83], v[44:47], v[20:23], v[80:83]
  ds_read_b64_tr_b16 v[30:31], v5 offset:28672
  s_waitcnt lgkmcnt(7)
  v_mfma_f32_16x16x32_bf16 v[96:99], v[48:51], v[16:19], v[96:99]
  s_waitcnt lgkmcnt(6)
  v_mfma_f32_16x16x32_bf16 v[96:99], v[52:55], v[20:23], v[96:99]
  s_waitcnt lgkmcnt(5)
  v_mfma_f32_16x16x32_bf16 v[112:115], v[56:59], v[16:19], v[112:115]
  s_waitcnt lgkmcnt(4)
  v_mfma_f32_16x16x32_bf16 v[112:115], v[60:63], v[20:23], v[112:115]
  s_waitcnt lgkmcnt(2)
  v_mfma_f32_16x16x32_bf16 v[68:71], v[32:35], v[24:27], v[68:71]
  ds_read_b64_tr_b16 v[16:17], v6 offset:16384
  s_waitcnt lgkmcnt(1)
  v_mfma_f32_16x16x32_bf16 v[68:71], v[36:39], v[28:31], v[68:71]
  ds_read_b64_tr_b16 v[18:19], v6 offset:20480
  v_mfma_f32_16x16x32_bf16 v[84:87], v[40:43], v[24:27], v[84:87]
  ds_read_b64_tr_b16 v[20:21], v6 offset:24576
  v_mfma_f32_16x16x32_bf16 v[84:87], v[44:47], v[28:31], v[84:87]
  ds_read_b64_tr_b16 v[22:23], v6 offset:28672
  v_mfma_f32_16x16x32_bf16 v[100:103], v[48:51], v[24:27], v[100:103]
  v_mfma_f32_16x16x32_bf16 v[100:103], v[52:55], v[28:31], v[100:103]
  v_mfma_f32_16x16x32_bf16 v[116:119], v[56:59], v[24:27], v[116:119]
  v_mfma_f32_16x16x32_bf16 v[116:119], v[60:63], v[28:31], v[116:119]
  s_waitcnt lgkmcnt(2)
  v_mfma_f32_16x16x32_bf16 v[72:75], v[32:35], v[16:19], v[72:75]
  ds_read_b64_tr_b16 v[24:25], v7 offset:16384
  s_waitcnt lgkmcnt(1)
  v_mfma_f32_16x16x32_bf16 v[72:75], v[36:39], v[20:23], v[72:75]
  ds_read_b64_tr_b16 v[26:27], v7 offset:20480
  v_mfma_f32_16x16x32_bf16 v[88:91], v[40:43], v[16:19], v[88:91]
  ds_read_b64_tr_b16 v[28:29], v7 offset:24576
  v_mfma_f32_16x16x32_bf16 v[88:91], v[44:47], v[20:23], v[88:91]
  ds_read_b64_tr_b16 v[30:31], v7 offset:28672
  v_mfma_f32_16x16x32_bf16 v[104:107], v[48:51], v[16:19], v[104:107]
  v_mfma_f32_16x16x32_bf16 v[104:107], v[52:55], v[20:23], v[104:107]
  v_mfma_f32_16x16x32_bf16 v[120:123], v[56:59], v[16:19], v[120:123]
  v_mfma_f32_16x16x32_bf16 v[120:123], v[60:63], v[20:23], v[120:123]
  s_waitcnt lgkmcnt(0)
  s_barrier
  v_mfma_f32_16x16x32_bf16 v[76:79], v[32:35], v[24:27], v[76:79]
  ds_read_b64_tr_b16 v[16:17], v4 offset:32768
  v_mfma_f32_16x16x32_bf16 v[76:79], v[36:39], v[28:31], v[76:79]
  ds_read_b64_tr_b16 v[18:19], v4 offset:36864
  ds_read_b128 v[32:35], v1 offset:32768
  ds_read_b128 v[36:39], v1 offset:33792
  v_mfma_f32_16x16x32_bf16 v[92:95], v[40:43], v[24:27], v[92:95]
  ds_read_b64_tr_b16 v[20:21], v4 offset:40960
  v_mfma_f32_16x16x32_bf16 v[92:95], v[44:47], v[28:31], v[92:95]
  ds_read_b64_tr_b16 v[22:23], v4 offset:45056
  ds_read_b128 v[40:43], v1 offset:34816
  ds_read_b128 v[44:47], v1 offset:35840
  v_mfma_f32_16x16x32_bf16 v[108:111], v[48:51], v[24:27], v[108:111]
  v_mfma_f32_16x16x32_bf16 v[108:111], v[52:55], v[28:31], v[108:111]
  ds_read_b128 v[48:51], v1 offset:36864
  ds_read_b128 v[52:55], v1 offset:37888
  v_mfma_f32_16x16x32_bf16 v[124:127], v[56:59], v[24:27], v[124:127]
  v_mfma_f32_16x16x32_bf16 v[124:127], v[60:63], v[28:31], v[124:127]
  ds_read_b128 v[56:59], v1 offset:38912
  ds_read_b128 v[60:63], v1 offset:39936
  s_waitcnt lgkmcnt(9)
  v_mfma_f32_16x16x32_bf16 v[64:67], v[32:35], v[16:19], v[64:67]
  ds_read_b64_tr_b16 v[24:25], v5 offset:32768
  s_waitcnt lgkmcnt(7)
  v_mfma_f32_16x16x32_bf16 v[64:67], v[36:39], v[20:23], v[64:67]
  ds_read_b64_tr_b16 v[26:27], v5 offset:36864
  s_waitcnt lgkmcnt(7)
  v_mfma_f32_16x16x32_bf16 v[80:83], v[40:43], v[16:19], v[80:83]
  ds_read_b64_tr_b16 v[28:29], v5 offset:40960
  s_waitcnt lgkmcnt(7)
  v_mfma_f32_16x16x32_bf16 v[80:83], v[44:47], v[20:23], v[80:83]
  ds_read_b64_tr_b16 v[30:31], v5 offset:45056
  s_waitcnt lgkmcnt(7)
  v_mfma_f32_16x16x32_bf16 v[96:99], v[48:51], v[16:19], v[96:99]
  s_waitcnt lgkmcnt(6)
  v_mfma_f32_16x16x32_bf16 v[96:99], v[52:55], v[20:23], v[96:99]
  s_waitcnt lgkmcnt(5)
  v_mfma_f32_16x16x32_bf16 v[112:115], v[56:59], v[16:19], v[112:115]
  s_waitcnt lgkmcnt(4)
  v_mfma_f32_16x16x32_bf16 v[112:115], v[60:63], v[20:23], v[112:115]
  s_waitcnt lgkmcnt(2)
  v_mfma_f32_16x16x32_bf16 v[68:71], v[32:35], v[24:27], v[68:71]
  ds_read_b64_tr_b16 v[16:17], v6 offset:32768
  s_waitcnt lgkmcnt(1)
  v_mfma_f32_16x16x32_bf16 v[68:71], v[36:39], v[28:31], v[68:71]
  ds_read_b64_tr_b16 v[18:19], v6 offset:36864
  v_mfma_f32_16x16x32_bf16 v[84:87], v[40:43], v[24:27], v[84:87]
  ds_read_b64_tr_b16 v[20:21], v6 offset:40960
  v_mfma_f32_16x16x32_bf16 v[84:87], v[44:47], v[28:31], v[84:87]
  ds_read_b64_tr_b16 v[22:23], v6 offset:45056
  v_mfma_f32_16x16x32_bf16 v[100:103], v[48:51], v[24:27], v[100:103]
  v_mfma_f32_16x16x32_bf16 v[100:103], v[52:55], v[28:31], v[100:103]
  v_mfma_f32_16x16x32_bf16 v[116:119], v[56:59], v[24:27], v[116:119]
  v_mfma_f32_16x16x32_bf16 v[116:119], v[60:63], v[28:31], v[116:119]
  s_waitcnt lgkmcnt(2)
  v_mfma_f32_16x16x32_bf16 v[72:75], v[32:35], v[16:19], v[72:75]
  ds_read_b64_tr_b16 v[24:25], v7 offset:32768
  s_waitcnt lgkmcnt(1)
  v_mfma_f32_16x16x32_bf16 v[72:75], v[36:39], v[20:23], v[72:75]
  ds_read_b64_tr_b16 v[26:27], v7 offset:36864
  v_mfma_f32_16x16x32_bf16 v[88:91], v[40:43], v[16:19], v[88:91]
  ds_read_b64_tr_b16 v[28:29], v7 offset:40960
  v_mfma_f32_16x16x32_bf16 v[88:91], v[44:47], v[20:23], v[88:91]
  ds_read_b64_tr_b16 v[30:31], v7 offset:45056
  v_mfma_f32_16x16x32_bf16 v[104:107], v[48:51], v[16:19], v[104:107]
  v_mfma_f32_16x16x32_bf16 v[104:107], v[52:55], v[20:23], v[104:107]
  v_mfma_f32_16x16x32_bf16 v[120:123], v[56:59], v[16:19], v[120:123]
  v_mfma_f32_16x16x32_bf16 v[120:123], v[60:63], v[20:23], v[120:123]
  s_waitcnt lgkmcnt(0)
  s_barrier
  v_mfma_f32_16x16x32_bf16 v[76:79], v[32:35], v[24:27], v[76:79]
  ds_read_b64_tr_b16 v[16:17], v4 offset:49152
  v_mfma_f32_16x16x32_bf16 v[76:79], v[36:39], v[28:31], v[76:79]
  ds_read_b64_tr_b16 v[18:19], v4 offset:53248
  ds_read_b128 v[32:35], v1 offset:49152
  ds_read_b128 v[36:39], v1 offset:50176
  v_mfma_f32_16x16x32_bf16 v[92:95], v[40:43], v[24:27], v[92:95]
  ds_read_b64_tr_b16 v[20:21], v4 offset:57344
  v_mfma_f32_16x16x32_bf16 v[92:95], v[44:47], v[28:31], v[92:95]
  ds_read_b64_tr_b16 v[22:23], v4 offset:61440
  ds_read_b128 v[40:43], v1 offset:51200
  ds_read_b128 v[44:47], v1 offset:52224
  v_mfma_f32_16x16x32_bf16 v[108:111], v[48:51], v[24:27], v[108:111]
  v_mfma_f32_16x16x32_bf16 v[108:111], v[52:55], v[28:31], v[108:111]
  ds_read_b128 v[48:51], v1 offset:53248
  ds_read_b128 v[52:55], v1 offset:54272
  v_mfma_f32_16x16x32_bf16 v[124:127], v[56:59], v[24:27], v[124:127]
  v_mfma_f32_16x16x32_bf16 v[124:127], v[60:63], v[28:31], v[124:127]
  ds_read_b128 v[56:59], v1 offset:55296
  ds_read_b128 v[60:63], v1 offset:56320
  s_waitcnt lgkmcnt(9)
  v_mfma_f32_16x16x32_bf16 v[64:67], v[32:35], v[16:19], v[64:67]
  ds_read_b64_tr_b16 v[24:25], v5 offset:49152
  s_waitcnt lgkmcnt(7)
  v_mfma_f32_16x16x32_bf16 v[64:67], v[36:39], v[20:23], v[64:67]
  ds_read_b64_tr_b16 v[26:27], v5 offset:53248
  s_waitcnt lgkmcnt(7)
  v_mfma_f32_16x16x32_bf16 v[80:83], v[40:43], v[16:19], v[80:83]
  ds_read_b64_tr_b16 v[28:29], v5 offset:57344
  s_waitcnt lgkmcnt(7)
  v_mfma_f32_16x16x32_bf16 v[80:83], v[44:47], v[20:23], v[80:83]
  ds_read_b64_tr_b16 v[30:31], v5 offset:61440
  s_waitcnt lgkmcnt(7)
  v_mfma_f32_16x16x32_bf16 v[96:99], v[48:51], v[16:19], v[96:99]
  s_waitcnt lgkmcnt(6)
  v_mfma_f32_16x16x32_bf16 v[96:99], v[52:55], v[20:23], v[96:99]
  s_waitcnt lgkmcnt(5)
  v_mfma_f32_16x16x32_bf16 v[112:115], v[56:59], v[16:19], v[112:115]
  s_waitcnt lgkmcnt(4)
  v_mfma_f32_16x16x32_bf16 v[112:115], v[60:63], v[20:23], v[112:115]
  s_waitcnt lgkmcnt(2)
  v_mfma_f32_16x16x32_bf16 v[68:71], v[32:35], v[24:27], v[68:71]
  ds_read_b64_tr_b16 v[16:17], v6 offset:49152
  s_waitcnt lgkmcnt(1)
  v_mfma_f32_16x16x32_bf16 v[68:71], v[36:39], v[28:31], v[68:71]
  ds_read_b64_tr_b16 v[18:19], v6 offset:53248
  v_mfma_f32_16x16x32_bf16 v[84:87], v[40:43], v[24:27], v[84:87]
  ds_read_b64_tr_b16 v[20:21], v6 offset:57344
  v_mfma_f32_16x16x32_bf16 v[84:87], v[44:47], v[28:31], v[84:87]
  ds_read_b64_tr_b16 v[22:23], v6 offset:61440
  v_mfma_f32_16x16x32_bf16 v[100:103], v[48:51], v[24:27], v[100:103]
  v_mfma_f32_16x16x32_bf16 v[100:103], v[52:55], v[28:31], v[100:103]
  v_mfma_f32_16x16x32_bf16 v[116:119], v[56:59], v[24:27], v[116:119]
  v_mfma_f32_16x16x32_bf16 v[116:119], v[60:63], v[28:31], v[116:119]
  s_waitcnt lgkmcnt(2)
  v_mfma_f32_16x16x32_bf16 v[72:75], v[32:35], v[16:19], v[72:75]
  ds_read_b64_tr_b16 v[24:25], v7 offset:49152
  s_waitcnt lgkmcnt(1)
  v_mfma_f32_16x16x32_bf16 v[72:75], v[36:39], v[20:23], v[72:75]
  ds_read_b64_tr_b16 v[26:27], v7 offset:53248
  v_mfma_f32_16x16x32_bf16 v[88:91], v[40:43], v[16:19], v[88:91]
  ds_read_b64_tr_b16 v[28:29], v7 offset:57344
  v_mfma_f32_16x16x32_bf16 v[88:91], v[44:47], v[20:23], v[88:91]
  ds_read_b64_tr_b16 v[30:31], v7 offset:61440
  v_mfma_f32_16x16x32_bf16 v[104:107], v[48:51], v[16:19], v[104:107]
  v_mfma_f32_16x16x32_bf16 v[104:107], v[52:55], v[20:23], v[104:107]
  v_mfma_f32_16x16x32_bf16 v[120:123], v[56:59], v[16:19], v[120:123]
  v_mfma_f32_16x16x32_bf16 v[120:123], v[60:63], v[20:23], v[120:123]
  s_sub_u32 s50, s50, 1
  s_cmp_lg_u32 s50, 0
  s_waitcnt lgkmcnt(0)
  s_barrier
  v_mfma_f32_16x16x32_bf16 v[76:79], v[32:35], v[24:27], v[76:79]
  ds_read_b64_tr_b16 v[16:17], v4 offset:0
  v_mfma_f32_16x16x32_bf16 v[76:79], v[36:39], v[28:31], v[76:79]
  ds_read_b64_tr_b16 v[18:19], v4 offset:4096
  ds_read_b128 v[32:35], v1 offset:0
  ds_read_b128 v[36:39], v1 offset:1024
  v_mfma_f32_16x16x32_bf16 v[92:95], v[40:43], v[24:27], v[92:95]
  ds_read_b64_tr_b16 v[20:21], v4 offset:8192
  v_mfma_f32_16x16x32_bf16 v[92:95], v[44:47], v[28:31], v[92:95]
  ds_read_b64_tr_b16 v[22:23], v4 offset:12288
  ds_read_b128 v[40:43], v1 offset:2048
  ds_read_b128 v[44:47], v1 offset:3072
  v_mfma_f32_16x16x32_bf16 v[108:111], v[48:51], v[24:27], v[108:111]
  v_mfma_f32_16x16x32_bf16 v[108:111], v[52:55], v[28:31], v[108:111]
  ds_read_b128 v[48:51], v1 offset:4096
  ds_read_b128 v[52:55], v1 offset:5120
  v_mfma_f32_16x16x32_bf16 v[124:127], v[56:59], v[24:27], v[124:127]
  v_mfma_f32_16x16x32_bf16 v[124:127], v[60:63], v[28:31], v[124:127]
  ds_read_b128 v[56:59], v1 offset:6144
  ds_read_b128 v[60:63], v1 offset:7168
  s_cbranch_scc1 LB_L0
  s_waitcnt lgkmcnt(9)
  v_mfma_f32_16x16x32_bf16 v[64:67], v[32:35], v[16:19], v[64:67]
  ds_read_b64_tr_b16 v[24:25], v5 offset:0
  s_waitcnt lgkmcnt(7)
  v_mfma_f32_16x16x32_bf16 v[64:67], v[36:39], v[20:23], v[64:67]
  ds_read_b64_tr_b16 v[26:27], v5 offset:4096
  s_waitcnt lgkmcnt(7)
  v_mfma_f32_16x16x32_bf16 v[80:83], v[40:43], v[16:19], v[80:83]
  ds_read_b64_tr_b16 v[28:29], v5 offset:8192
  s_waitcnt lgkmcnt(7)
  v_mfma_f32_16x16x32_bf16 v[80:83], v[44:47], v[20:23], v[80:83]
  ds_read_b64_tr_b16 v[30:31], v5 offset:12288
  s_waitcnt lgkmcnt(7)
  v_mfma_f32_16x16x32_bf16 v[96:99], v[48:51], v[16:19], v[96:99]
  s_waitcnt lgkmcnt(6)
  v_mfma_f32_16x16x32_bf16 v[96:99], v[52:55], v[20:23], v[96:99]
  s_waitcnt lgkmcnt(5)
  v_mfma_f32_16x16x32_bf16 v[112:115], v[56:59], v[16:19], v[112:115]
  s_waitcnt lgkmcnt(4)
  v_mfma_f32_16x16x32_bf16 v[112:115], v[60:63], v[20:23], v[112:115]
  s_waitcnt lgkmcnt(2)
  v_mfma_f32_16x16x32_bf16 v[68:71], v[32:35], v[24:27], v[68:71]
  ds_read_b64_tr_b16 v[16:17], v6 offset:0
  s_waitcnt lgkmcnt(1)
  v_mfma_f32_16x16x32_bf16 v[68:71], v[36:39], v[28:31], v[68:71]
  ds_read_b64_tr_b16 v[18:19], v6 offset:4096
  v_mfma_f32_16x16x32_bf16 v[84:87], v[40:43], v[24:27], v[84:87]
  ds_read_b64_tr_b16 v[20:21], v6 offset:8192
  v_mfma_f32_16x16x32_bf16 v[84:87], v[44:47], v[28:31], v[84:87]
  ds_read_b64_tr_b16 v[22:23], v6 offset:12288
  v_mfma_f32_16x16x32_bf16 v[100:103], v[48:51], v[24:27], v[100:103]
  v_mfma_f32_16x16x32_bf16 v[100:103], v[52:55], v[28:31], v[100:103]
  v_mfma_f32_16x16x32_bf16 v[116:119], v[56:59], v[24:27], v[116:119]
  v_mfma_f32_16x16x32_bf16 v[116:119], v[60:63], v[28:31], v[116:119]
  s_waitcnt lgkmcnt(2)
  v_mfma_f32_16x16x32_bf16 v[72:75], v[32:35], v[16:19], v[72:75]
  ds_read_b64_tr_b16 v[24:25], v7 offset:0
  s_waitcnt lgkmcnt(1)
  v_mfma_f32_16x16x32_bf16 v[72:75], v[36:39], v[20:23], v[72:75]
  ds_read_b64_tr_b16 v[26:27], v7 offset:4096
  v_mfma_f32_16x16x32_bf16 v[88:91], v[40:43], v[16:19], v[88:91]
  ds_read_b64_tr_b16 v[28:29], v7 offset:8192
  v_mfma_f32_16x16x32_bf16 v[88:91], v[44:47], v[20:23], v[88:91]
  ds_read_b64_tr_b16 v[30:31], v7 offset:12288
  v_mfma_f32_16x16x32_bf16 v[104:107], v[48:51], v[16:19], v[104:107]
  v_mfma_f32_16x16x32_bf16 v[104:107], v[52:55], v[20:23], v[104:107]
  v_mfma_f32_16x16x32_bf16 v[120:123], v[56:59], v[16:19], v[120:123]
  v_mfma_f32_16x16x32_bf16 v[120:123], v[60:63], v[20:23], v[120:123]
  s_waitcnt lgkmcnt(0)
  s_barrier
  v_mfma_f32_16x16x32_bf16 v[76:79], v[32:35], v[24:27], v[76:79]
  ds_read_b64_tr_b16 v[16:17], v4 offset:16384
  v_mfma_f32_16x16x32_bf16 v[76:79], v[36:39], v[28:31], v[76:79]
  ds_read_b64_tr_b16 v[18:19], v4 offset:20480
  ds_read_b128 v[32:35], v1 offset:16384
  ds_read_b128 v[36:39], v1 offset:17408
  v_mfma_f32_16x16x32_bf16 v[92:95], v[40:43], v[24:27], v[92:95]
  ds_read_b64_tr_b16 v[20:21], v4 offset:24576
  v_mfma_f32_16x16x32_bf16 v[92:95], v[44:47], v[28:31], v[92:95]
  ds_read_b64_tr_b16 v[22:23], v4 offset:28672
  ds_read_b128 v[40:43], v1 offset:18432
  ds_read_b128 v[44:47], v1 offset:19456
  v_mfma_f32_16x16x32_bf16 v[108:111], v[48:51], v[24:27], v[108:111]
  v_mfma_f32_16x16x32_bf16 v[108:111], v[52:55], v[28:31], v[108:111]
  ds_read_b128 v[48:51], v1 offset:20480
  ds_read_b128 v[52:55], v1 offset:21504
  v_mfma_f32_16x16x32_bf16 v[124:127], v[56:59], v[24:27], v[124:127]
  v_mfma_f32_16x16x32_bf16 v[124:127], v[60:63], v[28:31], v[124:127]
  ds_read_b128 v[56:59], v1 offset:22528
  ds_read_b128 v[60:63], v1 offset:23552
  s_waitcnt lgkmcnt(9)
  v_mfma_f32_16x16x32_bf16 v[64:67], v[32:35], v[16:19], v[64:67]
  ds_read_b64_tr_b16 v[24:25], v5 offset:16384
  s_waitcnt lgkmcnt(7)
  v_mfma_f32_16x16x32_bf16 v[64:67], v[36:39], v[20:23], v[64:67]
  ds_read_b64_tr_b16 v[26:27], v5 offset:20480
  s_waitcnt lgkmcnt(7)
  v_mfma_f32_16x16x32_bf16 v[80:83], v[40:43], v[16:19], v[80:83]
  ds_read_b64_tr_b16 v[28:29], v5 offset:24576
  s_waitcnt lgkmcnt(7)
  v_mfma_f32_16x16x32_bf16 v[80:83], v[44:47], v[20:23], v[80:83]
  ds_read_b64_tr_b16 v[30:31], v5 offset:28672
  s_waitcnt lgkmcnt(7)
  v_mfma_f32_16x16x32_bf16 v[96:99], v[48:51], v[16:19], v[96:99]
  s_waitcnt lgkmcnt(6)
  v_mfma_f32_16x16x32_bf16 v[96:99], v[52:55], v[20:23], v[96:99]
  s_waitcnt lgkmcnt(5)
  v_mfma_f32_16x16x32_bf16 v[112:115], v[56:59], v[16:19], v[112:115]
  s_waitcnt lgkmcnt(4)
  v_mfma_f32_16x16x32_bf16 v[112:115], v[60:63], v[20:23], v[112:115]
  s_waitcnt lgkmcnt(2)
  v_mfma_f32_16x16x32_bf16 v[68:71], v[32:35], v[24:27], v[68:71]
  ds_read_b64_tr_b16 v[16:17], v6 offset:16384
  s_waitcnt lgkmcnt(1)
  v_mfma_f32_16x16x32_bf16 v[68:71], v[36:39], v[28:31], v[68:71]
  ds_read_b64_tr_b16 v[18:19], v6 offset:20480
  v_mfma_f32_16x16x32_bf16 v[84:87], v[40:43], v[24:27], v[84:87]
  ds_read_b64_tr_b16 v[20:21], v6 offset:24576
  v_mfma_f32_16x16x32_bf16 v[84:87], v[44:47], v[28:31], v[84:87]
  ds_read_b64_tr_b16 v[22:23], v6 offset:28672
  v_mfma_f32_16x16x32_bf16 v[100:103], v[48:51], v[24:27], v[100:103]
  v_mfma_f32_16x16x32_bf16 v[100:103], v[52:55], v[28:31], v[100:103]
  v_mfma_f32_16x16x32_bf16 v[116:119], v[56:59], v[24:27], v[116:119]
  v_mfma_f32_16x16x32_bf16 v[116:119], v[60:63], v[28:31], v[116:119]
  s_waitcnt lgkmcnt(2)
  v_mfma_f32_16x16x32_bf16 v[72:75], v[32:35], v[16:19], v[72:75]
  ds_read_b64_tr_b16 v[24:25], v7 offset:16384
  s_waitcnt lgkmcnt(1)
  v_mfma_f32_16x16x32_bf16 v[72:75], v[36:39], v[20:23], v[72:75]
  ds_read_b64_tr_b16 v[26:27], v7 offset:20480
  v_mfma_f32_16x16x32_bf16 v[88:91], v[40:43], v[16:19], v[88:91]
  ds_read_b64_tr_b16 v[28:29], v7 offset:24576
  v_mfma_f32_16x16x32_bf16 v[88:91], v[44:47], v[20:23], v[88:91]
  ds_read_b64_tr_b16 v[30:31], v7 offset:28672
  v_mfma_f32_16x16x32_bf16 v[104:107], v[48:51], v[16:19], v[104:107]
  v_mfma_f32_16x16x32_bf16 v[104:107], v[52:55], v[20:23], v[104:107]
  v_mfma_f32_16x16x32_bf16 v[120:123], v[56:59], v[16:19], v[120:123]
  v_mfma_f32_16x16x32_bf16 v[120:123], v[60:63], v[20:23], v[120:123]
  s_waitcnt lgkmcnt(0)
  s_barrier
  v_mfma_f32_16x16x32_bf16 v[76:79], v[32:35], v[24:27], v[76:79]
  ds_read_b64_tr_b16 v[16:17], v4 offset:32768
  v_mfma_f32_16x16x32_bf16 v[76:79], v[36:39], v[28:31], v[76:79]
  ds_read_b64_tr_b16 v[18:19], v4 offset:36864
  ds_read_b128 v[32:35], v1 offset:32768
  ds_read_b128 v[36:39], v1 offset:33792
  v_mfma_f32_16x16x32_bf16 v[92:95], v[40:43], v[24:27], v[92:95]
  ds_read_b64_tr_b16 v[20:21], v4 offset:40960
  v_mfma_f32_16x16x32_bf16 v[92:95], v[44:47], v[28:31], v[92:95]
  ds_read_b64_tr_b16 v[22:23], v4 offset:45056
  ds_read_b128 v[40:43], v1 offset:34816
  ds_read_b128 v[44:47], v1 offset:35840
  v_mfma_f32_16x16x32_bf16 v[108:111], v[48:51], v[24:27], v[108:111]
  v_mfma_f32_16x16x32_bf16 v[108:111], v[52:55], v[28:31], v[108:111]
  ds_read_b128 v[48:51], v1 offset:36864
  ds_read_b128 v[52:55], v1 offset:37888
  v_mfma_f32_16x16x32_bf16 v[124:127], v[56:59], v[24:27], v[124:127]
  v_mfma_f32_16x16x32_bf16 v[124:127], v[60:63], v[28:31], v[124:127]
  ds_read_b128 v[56:59], v1 offset:38912
  ds_read_b128 v[60:63], v1 offset:39936
  s_waitcnt lgkmcnt(9)
  v_mfma_f32_16x16x32_bf16 v[64:67], v[32:35], v[16:19], v[64:67]
  ds_read_b64_tr_b16 v[24:25], v5 offset:32768
  s_waitcnt lgkmcnt(7)
  v_mfma_f32_16x16x32_bf16 v[64:67], v[36:39], v[20:23], v[64:67]
  ds_read_b64_tr_b16 v[26:27], v5 offset:36864
  s_waitcnt lgkmcnt(7)
  v_mfma_f32_16x16x32_bf16 v[80:83], v[40:43], v[16:19], v[80:83]
  ds_read_b64_tr_b16 v[28:29], v5 offset:40960
  s_waitcnt lgkmcnt(7)
  v_mfma_f32_16x16x32_bf16 v[80:83], v[44:47], v[20:23], v[80:83]
  ds_read_b64_tr_b16 v[30:31], v5 offset:45056
  s_waitcnt lgkmcnt(7)
  v_mfma_f32_16x16x32_bf16 v[96:99], v[48:51], v[16:19], v[96:99]
  s_waitcnt lgkmcnt(6)
  v_mfma_f32_16x16x32_bf16 v[96:99], v[52:55], v[20:23], v[96:99]
  s_waitcnt lgkmcnt(5)
  v_mfma_f32_16x16x32_bf16 v[112:115], v[56:59], v[16:19], v[112:115]
  s_waitcnt lgkmcnt(4)
  v_mfma_f32_16x16x32_bf16 v[112:115], v[60:63], v[20:23], v[112:115]
  s_waitcnt lgkmcnt(2)
  v_mfma_f32_16x16x32_bf16 v[68:71], v[32:35], v[24:27], v[68:71]
  ds_read_b64_tr_b16 v[16:17], v6 offset:32768
  s_waitcnt lgkmcnt(1)
  v_mfma_f32_16x16x32_bf16 v[68:71], v[36:39], v[28:31], v[68:71]
  ds_read_b64_tr_b16 v[18:19], v6 offset:36864
  v_mfma_f32_16x16x32_bf16 v[84:87], v[40:43], v[24:27], v[84:87]
  ds_read_b64_tr_b16 v[20:21], v6 offset:40960
  v_mfma_f32_16x16x32_bf16 v[84:87], v[44:47], v[28:31], v[84:87]
  ds_read_b64_tr_b16 v[22:23], v6 offset:45056
  v_mfma_f32_16x16x32_bf16 v[100:103], v[48:51], v[24:27], v[100:103]
  v_mfma_f32_16x16x32_bf16 v[100:103], v[52:55], v[28:31], v[100:103]
  v_mfma_f32_16x16x32_bf16 v[116:119], v[56:59], v[24:27], v[116:119]
  v_mfma_f32_16x16x32_bf16 v[116:119], v[60:63], v[28:31], v[116:119]
  s_waitcnt lgkmcnt(2)
  v_mfma_f32_16x16x32_bf16 v[72:75], v[32:35], v[16:19], v[72:75]
  ds_read_b64_tr_b16 v[24:25], v7 offset:32768
  s_waitcnt lgkmcnt(1)
  v_mfma_f32_16x16x32_bf16 v[72:75], v[36:39], v[20:23], v[72:75]
  ds_read_b64_tr_b16 v[26:27], v7 offset:36864
  v_mfma_f32_16x16x32_bf16 v[88:91], v[40:43], v[16:19], v[88:91]
  ds_read_b64_tr_b16 v[28:29], v7 offset:40960
  v_mfma_f32_16x16x32_bf16 v[88:91], v[44:47], v[20:23], v[88:91]
  ds_read_b64_tr_b16 v[30:31], v7 offset:45056
  v_mfma_f32_16x16x32_bf16 v[104:107], v[48:51], v[16:19], v[104:107]
  v_mfma_f32_16x16x32_bf16 v[104:107], v[52:55], v[20:23], v[104:107]
  v_mfma_f32_16x16x32_bf16 v[120:123], v[56:59], v[16:19], v[120:123]
  v_mfma_f32_16x16x32_bf16 v[120:123], v[60:63], v[20:23], v[120:123]
  s_waitcnt lgkmcnt(0)
  s_barrier
  v_mfma_f32_16x16x32_bf16 v[76:79], v[32:35], v[24:27], v[76:79]
  ds_read_b64_tr_b16 v[16:17], v4 offset:49152
  v_mfma_f32_16x16x32_bf16 v[76:79], v[36:39], v[28:31], v[76:79]
  ds_read_b64_tr_b16 v[18:19], v4 offset:53248
  ds_read_b128 v[32:35], v1 offset:49152
  ds_read_b128 v[36:39], v1 offset:50176
  v_mfma_f32_16x16x32_bf16 v[92:95], v[40:43], v[24:27], v[92:95]
  ds_read_b64_tr_b16 v[20:21], v4 offset:57344
  v_mfma_f32_16x16x32_bf16 v[92:95], v[44:47], v[28:31], v[92:95]
  ds_read_b64_tr_b16 v[22:23], v4 offset:61440
  ds_read_b128 v[40:43], v1 offset:51200
  ds_read_b128 v[44:47], v1 offset:52224
  v_mfma_f32_16x16x32_bf16 v[108:111], v[48:51], v[24:27], v[108:111]
  v_mfma_f32_16x16x32_bf16 v[108:111], v[52:55], v[28:31], v[108:111]
  ds_read_b128 v[48:51], v1 offset:53248
  ds_read_b128 v[52:55], v1 offset:54272
  v_mfma_f32_16x16x32_bf16 v[124:127], v[56:59], v[24:27], v[124:127]
  v_mfma_f32_16x16x32_bf16 v[124:127], v[60:63], v[28:31], v[124:127]
  ds_read_b128 v[56:59], v1 offset:55296
  ds_read_b128 v[60:63], v1 offset:56320
  s_waitcnt lgkmcnt(9)
  v_mfma_f32_16x16x32_bf16 v[64:67], v[32:35], v[16:19], v[64:67]
  ds_read_b64_tr_b16 v[24:25], v5 offset:49152
  s_waitcnt lgkmcnt(7)
  v_mfma_f32_16x16x32_bf16 v[64:67], v[36:39], v[20:23], v[64:67]
  ds_read_b64_tr_b16 v[26:27], v5 offset:53248
  s_waitcnt lgkmcnt(7)
  v_mfma_f32_16x16x32_bf16 v[80:83], v[40:43], v[16:19], v[80:83]
  ds_read_b64_tr_b16 v[28:29], v5 offset:57344
  s_waitcnt lgkmcnt(7)
  v_mfma_f32_16x16x32_bf16 v[80:83], v[44:47], v[20:23], v[80:83]
  ds_read_b64_tr_b16 v[30:31], v5 offset:61440
  s_waitcnt lgkmcnt(7)
  v_mfma_f32_16x16x32_bf16 v[96:99], v[48:51], v[16:19], v[96:99]
  s_waitcnt lgkmcnt(6)
  v_mfma_f32_16x16x32_bf16 v[96:99], v[52:55], v[20:23], v[96:99]
  s_waitcnt lgkmcnt(5)
  v_mfma_f32_16x16x32_bf16 v[112:115], v[56:59], v[16:19], v[112:115]
  s_waitcnt lgkmcnt(4)
  v_mfma_f32_16x16x32_bf16 v[112:115], v[60:63], v[20:23], v[112:115]
  s_waitcnt lgkmcnt(2)
  v_mfma_f32_16x16x32_bf16 v[68:71], v[32:35], v[24:27], v[68:71]
  ds_read_b64_tr_b16 v[16:17], v6 offset:49152
  s_waitcnt lgkmcnt(1)
  v_mfma_f32_16x16x32_bf16 v[68:71], v[36:39], v[28:31], v[68:71]
  ds_read_b64_tr_b16 v[18:19], v6 offset:53248
  v_mfma_f32_16x16x32_bf16 v[84:87], v[40:43], v[24:27], v[84:87]
  ds_read_b64_tr_b16 v[20:21], v6 offset:57344
  v_mfma_f32_16x16x32_bf16 v[84:87], v[44:47], v[28:31], v[84:87]
  ds_read_b64_tr_b16 v[22:23], v6 offset:61440
  v_mfma_f32_16x16x32_bf16 v[100:103], v[48:51], v[24:27], v[100:103]
  v_mfma_f32_16x16x32_bf16 v[100:103], v[52:55], v[28:31], v[100:103]
  v_mfma_f32_16x16x32_bf16 v[116:119], v[56:59], v[24:27], v[116:119]
  v_mfma_f32_16x16x32_bf16 v[116:119], v[60:63], v[28:31], v[116:119]
  s_waitcnt lgkmcnt(2)
  v_mfma_f32_16x16x32_bf16 v[72:75], v[32:35], v[16:19], v[72:75]
  ds_read_b64_tr_b16 v[24:25], v7 offset:49152
  s_waitcnt lgkmcnt(1)
  v_mfma_f32_16x16x32_bf16 v[72:75], v[36:39], v[20:23], v[72:75]
  ds_read_b64_tr_b16 v[26:27], v7 offset:53248
  v_mfma_f32_16x16x32_bf16 v[88:91], v[40:43], v[16:19], v[88:91]
  ds_read_b64_tr_b16 v[28:29], v7 offset:57344
  v_mfma_f32_16x16x32_bf16 v[88:91], v[44:47], v[20:23], v[88:91]
  ds_read_b64_tr_b16 v[30:31], v7 offset:61440
  v_mfma_f32_16x16x32_bf16 v[104:107], v[48:51], v[16:19], v[104:107]
  v_mfma_f32_16x16x32_bf16 v[104:107], v[52:55], v[20:23], v[104:107]
  v_mfma_f32_16x16x32_bf16 v[120:123], v[56:59], v[16:19], v[120:123]
  v_mfma_f32_16x16x32_bf16 v[120:123], v[60:63], v[20:23], v[120:123]
  s_waitcnt lgkmcnt(0)
  s_barrier
  v_mfma_f32_16x16x32_bf16 v[76:79], v[32:35], v[24:27], v[76:79]
  v_mfma_f32_16x16x32_bf16 v[76:79], v[36:39], v[28:31], v[76:79]
  v_mfma_f32_16x16x32_bf16 v[92:95], v[40:43], v[24:27], v[92:95]
  v_mfma_f32_16x16x32_bf16 v[92:95], v[44:47], v[28:31], v[92:95]
  v_mfma_f32_16x16x32_bf16 v[108:111], v[48:51], v[24:27], v[108:111]
  v_mfma_f32_16x16x32_bf16 v[108:111], v[52:55], v[28:31], v[108:111]
  v_mfma_f32_16x16x32_bf16 v[124:127], v[56:59], v[24:27], v[124:127]
  v_mfma_f32_16x16x32_bf16 v[124:127], v[60:63], v[28:31], v[124:127]
  v_bfe_u32 v16, v2, 2, 2
  v_lshrrev_b32 v17, 4, v2
  v_and_b32 v18, 1, v17
  v_lshl_add_u32 v16, v18, 2, v16
  v_lshrrev_b32 v18, 1, v17
  v_lshl_add_u32 v16, v18, 4, v16
  v_lshlrev_b32 v16, 8, v16
  v_and_b32 v17, 3, v2
  v_lshl_add_u32 v16, v17, 3, v16
  v_bfe_u32 v17, v2, 2, 3
  s_lshl_b32 s60, s46, 2
  v_xor_b32 v17, s60, v17
  v_lshl_add_u32 v4, v17, 5, v16
  v_xor_b32 v18, 1, v17
  v_lshl_add_u32 v5, v18, 5, v16
  v_xor_b32 v18, 2, v17
  v_lshl_add_u32 v6, v18, 5, v16
  v_xor_b32 v18, 3, v17
  v_lshl_add_u32 v7, v18, 5, v16
  s_lshl_b32 s60, s47, 13
  s_add_u32 s60, s60, 65536
  v_lshlrev_b32 v1, 4, v2
  v_add_u32 v1, s60, v1
  v_mov_b32 v9, 0
  v_mov_b32 v11, 0
  v_mov_b32 v13, 0
  v_mov_b32 v15, 0
  v_pk_fma_f32 v[64:65], v[64:65], v[8:9], v[8:9] op_sel:[0,0,1] op_sel_hi:[1,0,1]
  v_pk_fma_f32 v[66:67], v[66:67], v[8:9], v[8:9] op_sel:[0,0,1] op_sel_hi:[1,0,1]
  v_pk_fma_f32 v[68:69], v[68:69], v[10:11], v[10:11] op_sel:[0,0,1] op_sel_hi:[1,0,1]
  v_pk_fma_f32 v[70:71], v[70:71], v[10:11], v[10:11] op_sel:[0,0,1] op_sel_hi:[1,0,1]
  v_pk_fma_f32 v[72:73], v[72:73], v[12:13], v[12:13] op_sel:[0,0,1] op_sel_hi:[1,0,1]
  v_pk_fma_f32 v[74:75], v[74:75], v[12:13], v[12:13] op_sel:[0,0,1] op_sel_hi:[1,0,1]
  v_pk_fma_f32 v[76:77], v[76:77], v[14:15], v[14:15] op_sel:[0,0,1] op_sel_hi:[1,0,1]
  v_pk_fma_f32 v[78:79], v[78:79], v[14:15], v[14:15] op_sel:[0,0,1] op_sel_hi:[1,0,1]
  v_pk_fma_f32 v[80:81], v[80:81], v[8:9], v[8:9] op_sel:[0,0,1] op_sel_hi:[1,0,1]
  v_pk_fma_f32 v[82:83], v[82:83], v[8:9], v[8:9] op_sel:[0,0,1] op_sel_hi:[1,0,1]
  v_pk_fma_f32 v[84:85], v[84:85], v[10:11], v[10:11] op_sel:[0,0,1] op_sel_hi:[1,0,1]
  v_pk_fma_f32 v[86:87], v[86:87], v[10:11], v[10:11] op_sel:[0,0,1] op_sel_hi:[1,0,1]
  v_pk_fma_f32 v[88:89], v[88:89], v[12:13], v[12:13] op_sel:[0,0,1] op_sel_hi:[1,0,1]
  v_pk_fma_f32 v[90:91], v[90:91], v[12:13], v[12:13] op_sel:[0,0,1] op_sel_hi:[1,0,1]
  v_pk_fma_f32 v[92:93], v[92:93], v[14:15], v[14:15] op_sel:[0,0,1] op_sel_hi:[1,0,1]
  v_pk_fma_f32 v[94:95], v[94:95], v[14:15], v[14:15] op_sel:[0,0,1] op_sel_hi:[1,0,1]
  v_pk_fma_f32 v[96:97], v[96:97], v[8:9], v[8:9] op_sel:[0,0,1] op_sel_hi:[1,0,1]
  v_pk_fma_f32 v[98:99], v[98:99], v[8:9], v[8:9] op_sel:[0,0,1] op_sel_hi:[1,0,1]
  v_pk_fma_f32 v[100:101], v[100:101], v[10:11], v[10:11] op_sel:[0,0,1] op_sel_hi:[1,0,1]
  v_pk_fma_f32 v[102:103], v[102:103], v[10:11], v[10:11] op_sel:[0,0,1] op_sel_hi:[1,0,1]
  v_pk_fma_f32 v[104:105], v[104:105], v[12:13], v[12:13] op_sel:[0,0,1] op_sel_hi:[1,0,1]
  v_pk_fma_f32 v[106:107], v[106:107], v[12:13], v[12:13] op_sel:[0,0,1] op_sel_hi:[1,0,1]
  v_pk_fma_f32 v[108:109], v[108:109], v[14:15], v[14:15] op_sel:[0,0,1] op_sel_hi:[1,0,1]
  v_pk_fma_f32 v[110:111], v[110:111], v[14:15], v[14:15] op_sel:[0,0,1] op_sel_hi:[1,0,1]
  v_pk_fma_f32 v[112:113], v[112:113], v[8:9], v[8:9] op_sel:[0,0,1] op_sel_hi:[1,0,1]
  v_pk_fma_f32 v[114:115], v[114:115], v[8:9], v[8:9] op_sel:[0,0,1] op_sel_hi:[1,0,1]
  v_pk_fma_f32 v[116:117], v[116:117], v[10:11], v[10:11] op_sel:[0,0,1] op_sel_hi:[1,0,1]
  v_pk_fma_f32 v[118:119], v[118:119], v[10:11], v[10:11] op_sel:[0,0,1] op_sel_hi:[1,0,1]
  v_pk_fma_f32 v[120:121], v[120:121], v[12:13], v[12:13] op_sel:[0,0,1] op_sel_hi:[1,0,1]
  v_pk_fma_f32 v[122:123], v[122:123], v[12:13], v[12:13] op_sel:[0,0,1] op_sel_hi:[1,0,1]
  v_pk_fma_f32 v[124:125], v[124:125], v[14:15], v[14:15] op_sel:[0,0,1] op_sel_hi:[1,0,1]
  v_pk_fma_f32 v[126:127], v[126:127], v[14:15], v[14:15] op_sel:[0,0,1] op_sel_hi:[1,0,1]
  v_mov_b32 v8, 1.0
  v_mov_b32 v10, 1.0
  v_mov_b32 v12, 1.0
  v_mov_b32 v14, 1.0
  ds_read_b64_tr_b16 v[16:17], v4 offset:0
  ds_read_b64_tr_b16 v[18:19], v4 offset:2048
  ds_read_b64_tr_b16 v[20:21], v4 offset:8192
  ds_read_b64_tr_b16 v[22:23], v4 offset:10240
  ds_read_b128 v[32:35], v1 offset:0
  ds_read_b128 v[36:39], v1 offset:1024
  ds_read_b128 v[40:43], v1 offset:2048
  ds_read_b128 v[44:47], v1 offset:3072
  ds_read_b128 v[48:51], v1 offset:4096
  ds_read_b128 v[52:55], v1 offset:5120
  ds_read_b128 v[56:59], v1 offset:6144
  ds_read_b128 v[60:63], v1 offset:7168
  s_mov_b32 s50, 3
  s_waitcnt lgkmcnt(0)
.p2align 6
LB_L1:
  s_waitcnt lgkmcnt(9)
  v_mfma_f32_16x16x32_bf16 v[64:67], v[16:19], v[32:35], v[64:67]
  ds_read_b64_tr_b16 v[24:25], v5 offset:0
  s_waitcnt lgkmcnt(7)
  v_mfma_f32_16x16x32_bf16 v[64:67], v[20:23], v[36:39], v[64:67]
  ds_read_b64_tr_b16 v[26:27], v5 offset:2048
  s_waitcnt lgkmcnt(7)
  v_mfma_f32_16x16x32_bf16 v[68:71], v[16:19], v[40:43], v[68:71]
  ds_read_b64_tr_b16 v[28:29], v5 offset:8192
  s_waitcnt lgkmcnt(7)
  v_mfma_f32_16x16x32_bf16 v[68:71], v[20:23], v[44:47], v[68:71]
  ds_read_b64_tr_b16 v[30:31], v5 offset:10240
  s_waitcnt lgkmcnt(7)
  v_mfma_f32_16x16x32_bf16 v[72:75], v[16:19], v[48:51], v[72:75]
  s_waitcnt lgkmcnt(6)
  v_mfma_f32_16x16x32_bf16 v[72:75], v[20:23], v[52:55], v[72:75]
  s_waitcnt lgkmcnt(5)
  v_mfma_f32_16x16x32_bf16 v[76:79], v[16:19], v[56:59], v[76:79]
  s_waitcnt lgkmcnt(4)
  v_mfma_f32_16x16x32_bf16 v[76:79], v[20:23], v[60:63], v[76:79]
  s_waitcnt lgkmcnt(2)
  v_mfma_f32_16x16x32_bf16 v[80:83], v[24:27], v[32:35], v[80:83]
  ds_read_b64_tr_b16 v[16:17], v6 offset:0
  s_waitcnt lgkmcnt(1)
  v_mfma_f32_16x16x32_bf16 v[80:83], v[28:31], v[36:39], v[80:83]
  ds_read_b64_tr_b16 v[18:19], v6 offset:2048
  v_mfma_f32_16x16x32_bf16 v[84:87], v[24:27], v[40:43], v[84:87]
  ds_read_b64_tr_b16 v[20:21], v6 offset:8192
  v_mfma_f32_16x16x32_bf16 v[84:87], v[28:31], v[44:47], v[84:87]
  ds_read_b64_tr_b16 v[22:23], v6 offset:10240
  v_mfma_f32_16x16x32_bf16 v[88:91], v[24:27], v[48:51], v[88:91]
  v_mfma_f32_16x16x32_bf16 v[88:91], v[28:31], v[52:55], v[88:91]
  v_mfma_f32_16x16x32_bf16 v[92:95], v[24:27], v[56:59], v[92:95]
  v_mfma_f32_16x16x32_bf16 v[92:95], v[28:31], v[60:63], v[92:95]
  s_waitcnt lgkmcnt(2)
  v_mfma_f32_16x16x32_bf16 v[96:99], v[16:19], v[32:35], v[96:99]
  ds_read_b64_tr_b16 v[24:25], v7 offset:0
  s_waitcnt lgkmcnt(1)
  v_mfma_f32_16x16x32_bf16 v[96:99], v[20:23], v[36:39], v[96:99]
  ds_read_b64_tr_b16 v[26:27], v7 offset:2048
  v_mfma_f32_16x16x32_bf16 v[100:103], v[16:19], v[40:43], v[100:103]
  ds_read_b64_tr_b16 v[28:29], v7 offset:8192
  v_mfma_f32_16x16x32_bf16 v[100:103], v[20:23], v[44:47], v[100:103]
  ds_read_b64_tr_b16 v[30:31], v7 offset:10240
  v_mfma_f32_16x16x32_bf16 v[104:107], v[16:19], v[48:51], v[104:107]
  v_mfma_f32_16x16x32_bf16 v[104:107], v[20:23], v[52:55], v[104:107]
  v_mfma_f32_16x16x32_bf16 v[108:111], v[16:19], v[56:59], v[108:111]
  v_mfma_f32_16x16x32_bf16 v[108:111], v[20:23], v[60:63], v[108:111]
  s_waitcnt lgkmcnt(0)
  s_barrier
  v_mfma_f32_16x16x32_bf16 v[112:115], v[24:27], v[32:35], v[112:115]
  ds_read_b64_tr_b16 v[16:17], v4 offset:16384
  v_mfma_f32_16x16x32_bf16 v[112:115], v[28:31], v[36:39], v[112:115]
  ds_read_b64_tr_b16 v[18:19], v4 offset:18432
  ds_read_b128 v[32:35], v1 offset:16384
  ds_read_b128 v[36:39], v1 offset:17408
  v_mfma_f32_16x16x32_bf16 v[116:119], v[24:27], v[40:43], v[116:119]
  ds_read_b64_tr_b16 v[20:21], v4 offset:24576
  v_mfma_f32_16x16x32_bf16 v[116:119], v[28:31], v[44:47], v[116:119]
  ds_read_b64_tr_b16 v[22:23], v4 offset:26624
  ds_read_b128 v[40:43], v1 offset:18432
  ds_read_b128 v[44:47], v1 offset:19456
  v_mfma_f32_16x16x32_bf16 v[120:123], v[24:27], v[48:51], v[120:123]
  v_mfma_f32_16x16x32_bf16 v[120:123], v[28:31], v[52:55], v[120:123]
  ds_read_b128 v[48:51], v1 offset:20480
  ds_read_b128 v[52:55], v1 offset:21504
  v_mfma_f32_16x16x32_bf16 v[124:127], v[24:27], v[56:59], v[124:127]
  v_mfma_f32_16x16x32_bf16 v[124:127], v[28:31], v[60:63], v[124:127]
  ds_read_b128 v[56:59], v1 offset:22528
  ds_read_b128 v[60:63], v1 offset:23552
  s_waitcnt lgkmcnt(9)
  v_mfma_f32_16x16x32_bf16 v[64:67], v[16:19], v[32:35], v[64:67]
  ds_read_b64_tr_b16 v[24:25], v5 offset:16384
  s_waitcnt lgkmcnt(7)
  v_mfma_f32_16x16x32_bf16 v[64:67], v[20:23], v[36:39], v[64:67]
  ds_read_b64_tr_b16 v[26:27], v5 offset:18432
  s_waitcnt lgkmcnt(7)
  v_mfma_f32_16x16x32_bf16 v[68:71], v[16:19], v[40:43], v[68:71]
  ds_read_b64_tr_b16 v[28:29], v5 offset:24576
  s_waitcnt lgkmcnt(7)
  v_mfma_f32_16x16x32_bf16 v[68:71], v[20:23], v[44:47], v[68:71]
  ds_read_b64_tr_b16 v[30:31], v5 offset:26624
  s_waitcnt lgkmcnt(7)
  v_mfma_f32_16x16x32_bf16 v[72:75], v[16:19], v[48:51], v[72:75]
  s_waitcnt lgkmcnt(6)
  v_mfma_f32_16x16x32_bf16 v[72:75], v[20:23], v[52:55], v[72:75]
  s_waitcnt lgkmcnt(5)
  v_mfma_f32_16x16x32_bf16 v[76:79], v[16:19], v[56:59], v[76:79]
  s_waitcnt lgkmcnt(4)
  v_mfma_f32_16x16x32_bf16 v[76:79], v[20:23], v[60:63], v[76:79]
  s_waitcnt lgkmcnt(2)
  v_mfma_f32_16x16x32_bf16 v[80:83], v[24:27], v[32:35], v[80:83]
  ds_read_b64_tr_b16 v[16:17], v6 offset:16384
  s_waitcnt lgkmcnt(1)
  v_mfma_f32_16x16x32_bf16 v[80:83], v[28:31], v[36:39], v[80:83]
  ds_read_b64_tr_b16 v[18:19], v6 offset:18432
  v_mfma_f32_16x16x32_bf16 v[84:87], v[24:27], v[40:43], v[84:87]
  ds_read_b64_tr_b16 v[20:21], v6 offset:24576
  v_mfma_f32_16x16x32_bf16 v[84:87], v[28:31], v[44:47], v[84:87]
  ds_read_b64_tr_b16 v[22:23], v6 offset:26624
  v_mfma_f32_16x16x32_bf16 v[88:91], v[24:27], v[48:51], v[88:91]
  v_mfma_f32_16x16x32_bf16 v[88:91], v[28:31], v[52:55], v[88:91]
  v_mfma_f32_16x16x32_bf16 v[92:95], v[24:27], v[56:59], v[92:95]
  v_mfma_f32_16x16x32_bf16 v[92:95], v[28:31], v[60:63], v[92:95]
  s_waitcnt lgkmcnt(2)
  v_mfma_f32_16x16x32_bf16 v[96:99], v[16:19], v[32:35], v[96:99]
  ds_read_b64_tr_b16 v[24:25], v7 offset:16384
  s_waitcnt lgkmcnt(1)
  v_mfma_f32_16x16x32_bf16 v[96:99], v[20:23], v[36:39], v[96:99]
  ds_read_b64_tr_b16 v[26:27], v7 offset:18432
  v_mfma_f32_16x16x32_bf16 v[100:103], v[16:19], v[40:43], v[100:103]
  ds_read_b64_tr_b16 v[28:29], v7 offset:24576
  v_mfma_f32_16x16x32_bf16 v[100:103], v[20:23], v[44:47], v[100:103]
  ds_read_b64_tr_b16 v[30:31], v7 offset:26624
  v_mfma_f32_16x16x32_bf16 v[104:107], v[16:19], v[48:51], v[104:107]
  v_mfma_f32_16x16x32_bf16 v[104:107], v[20:23], v[52:55], v[104:107]
  v_mfma_f32_16x16x32_bf16 v[108:111], v[16:19], v[56:59], v[108:111]
  v_mfma_f32_16x16x32_bf16 v[108:111], v[20:23], v[60:63], v[108:111]
  s_waitcnt lgkmcnt(0)
  s_barrier
  v_mfma_f32_16x16x32_bf16 v[112:115], v[24:27], v[32:35], v[112:115]
  ds_read_b64_tr_b16 v[16:17], v4 offset:32768
  v_mfma_f32_16x16x32_bf16 v[112:115], v[28:31], v[36:39], v[112:115]
  ds_read_b64_tr_b16 v[18:19], v4 offset:34816
  ds_read_b128 v[32:35], v1 offset:32768
  ds_read_b128 v[36:39], v1 offset:33792
  v_mfma_f32_16x16x32_bf16 v[116:119], v[24:27], v[40:43], v[116:119]
  ds_read_b64_tr_b16 v[20:21], v4 offset:40960
  v_mfma_f32_16x16x32_bf16 v[116:119], v[28:31], v[44:47], v[116:119]
  ds_read_b64_tr_b16 v[22:23], v4 offset:43008
  ds_read_b128 v[40:43], v1 offset:34816
  ds_read_b128 v[44:47], v1 offset:35840
  v_mfma_f32_16x16x32_bf16 v[120:123], v[24:27], v[48:51], v[120:123]
  v_mfma_f32_16x16x32_bf16 v[120:123], v[28:31], v[52:55], v[120:123]
  ds_read_b128 v[48:51], v1 offset:36864
  ds_read_b128 v[52:55], v1 offset:37888
  v_mfma_f32_16x16x32_bf16 v[124:127], v[24:27], v[56:59], v[124:127]
  v_mfma_f32_16x16x32_bf16 v[124:127], v[28:31], v[60:63], v[124:127]
  ds_read_b128 v[56:59], v1 offset:38912
  ds_read_b128 v[60:63], v1 offset:39936
  s_waitcnt lgkmcnt(9)
  v_mfma_f32_16x16x32_bf16 v[64:67], v[16:19], v[32:35], v[64:67]
  ds_read_b64_tr_b16 v[24:25], v5 offset:32768
  s_waitcnt lgkmcnt(7)
  v_mfma_f32_16x16x32_bf16 v[64:67], v[20:23], v[36:39], v[64:67]
  ds_read_b64_tr_b16 v[26:27], v5 offset:34816
  s_waitcnt lgkmcnt(7)
  v_mfma_f32_16x16x32_bf16 v[68:71], v[16:19], v[40:43], v[68:71]
  ds_read_b64_tr_b16 v[28:29], v5 offset:40960
  s_waitcnt lgkmcnt(7)
  v_mfma_f32_16x16x32_bf16 v[68:71], v[20:23], v[44:47], v[68:71]
  ds_read_b64_tr_b16 v[30:31], v5 offset:43008
  s_waitcnt lgkmcnt(7)
  v_mfma_f32_16x16x32_bf16 v[72:75], v[16:19], v[48:51], v[72:75]
  s_waitcnt lgkmcnt(6)
  v_mfma_f32_16x16x32_bf16 v[72:75], v[20:23], v[52:55], v[72:75]
  s_waitcnt lgkmcnt(5)
  v_mfma_f32_16x16x32_bf16 v[76:79], v[16:19], v[56:59], v[76:79]
  s_waitcnt lgkmcnt(4)
  v_mfma_f32_16x16x32_bf16 v[76:79], v[20:23], v[60:63], v[76:79]
  s_waitcnt lgkmcnt(2)
  v_mfma_f32_16x16x32_bf16 v[80:83], v[24:27], v[32:35], v[80:83]
  ds_read_b64_tr_b16 v[16:17], v6 offset:32768
  s_waitcnt lgkmcnt(1)
  v_mfma_f32_16x16x32_bf16 v[80:83], v[28:31], v[36:39], v[80:83]
  ds_read_b64_tr_b16 v[18:19], v6 offset:34816
  v_mfma_f32_16x16x32_bf16 v[84:87], v[24:27], v[40:43], v[84:87]
  ds_read_b64_tr_b16 v[20:21], v6 offset:40960
  v_mfma_f32_16x16x32_bf16 v[84:87], v[28:31], v[44:47], v[84:87]
  ds_read_b64_tr_b16 v[22:23], v6 offset:43008
  v_mfma_f32_16x16x32_bf16 v[88:91], v[24:27], v[48:51], v[88:91]
  v_mfma_f32_16x16x32_bf16 v[88:91], v[28:31], v[52:55], v[88:91]
  v_mfma_f32_16x16x32_bf16 v[92:95], v[24:27], v[56:59], v[92:95]
  v_mfma_f32_16x16x32_bf16 v[92:95], v[28:31], v[60:63], v[92:95]
  s_waitcnt lgkmcnt(2)
  v_mfma_f32_16x16x32_bf16 v[96:99], v[16:19], v[32:35], v[96:99]
  ds_read_b64_tr_b16 v[24:25], v7 offset:32768
  s_waitcnt lgkmcnt(1)
  v_mfma_f32_16x16x32_bf16 v[96:99], v[20:23], v[36:39], v[96:99]
  ds_read_b64_tr_b16 v[26:27], v7 offset:34816
  v_mfma_f32_16x16x32_bf16 v[100:103], v[16:19], v[40:43], v[100:103]
  ds_read_b64_tr_b16 v[28:29], v7 offset:40960
  v_mfma_f32_16x16x32_bf16 v[100:103], v[20:23], v[44:47], v[100:103]
  ds_read_b64_tr_b16 v[30:31], v7 offset:43008
  v_mfma_f32_16x16x32_bf16 v[104:107], v[16:19], v[48:51], v[104:107]
  v_mfma_f32_16x16x32_bf16 v[104:107], v[20:23], v[52:55], v[104:107]
  v_mfma_f32_16x16x32_bf16 v[108:111], v[16:19], v[56:59], v[108:111]
  v_mfma_f32_16x16x32_bf16 v[108:111], v[20:23], v[60:63], v[108:111]
  s_waitcnt lgkmcnt(0)
  s_barrier
  v_mfma_f32_16x16x32_bf16 v[112:115], v[24:27], v[32:35], v[112:115]
  ds_read_b64_tr_b16 v[16:17], v4 offset:49152
  v_mfma_f32_16x16x32_bf16 v[112:115], v[28:31], v[36:39], v[112:115]
  ds_read_b64_tr_b16 v[18:19], v4 offset:51200
  ds_read_b128 v[32:35], v1 offset:49152
  ds_read_b128 v[36:39], v1 offset:50176
  v_mfma_f32_16x16x32_bf16 v[116:119], v[24:27], v[40:43], v[116:119]
  ds_read_b64_tr_b16 v[20:21], v4 offset:57344
  v_mfma_f32_16x16x32_bf16 v[116:119], v[28:31], v[44:47], v[116:119]
  ds_read_b64_tr_b16 v[22:23], v4 offset:59392
  ds_read_b128 v[40:43], v1 offset:51200
  ds_read_b128 v[44:47], v1 offset:52224
  v_mfma_f32_16x16x32_bf16 v[120:123], v[24:27], v[48:51], v[120:123]
  v_mfma_f32_16x16x32_bf16 v[120:123], v[28:31], v[52:55], v[120:123]
  ds_read_b128 v[48:51], v1 offset:53248
  ds_read_b128 v[52:55], v1 offset:54272
  v_mfma_f32_16x16x32_bf16 v[124:127], v[24:27], v[56:59], v[124:127]
  v_mfma_f32_16x16x32_bf16 v[124:127], v[28:31], v[60:63], v[124:127]
  ds_read_b128 v[56:59], v1 offset:55296
  ds_read_b128 v[60:63], v1 offset:56320
  s_waitcnt lgkmcnt(9)
  v_mfma_f32_16x16x32_bf16 v[64:67], v[16:19], v[32:35], v[64:67]
  ds_read_b64_tr_b16 v[24:25], v5 offset:49152
  s_waitcnt lgkmcnt(7)
  v_mfma_f32_16x16x32_bf16 v[64:67], v[20:23], v[36:39], v[64:67]
  ds_read_b64_tr_b16 v[26:27], v5 offset:51200
  s_waitcnt lgkmcnt(7)
  v_mfma_f32_16x16x32_bf16 v[68:71], v[16:19], v[40:43], v[68:71]
  ds_read_b64_tr_b16 v[28:29], v5 offset:57344
  s_waitcnt lgkmcnt(7)
  v_mfma_f32_16x16x32_bf16 v[68:71], v[20:23], v[44:47], v[68:71]
  ds_read_b64_tr_b16 v[30:31], v5 offset:59392
  s_waitcnt lgkmcnt(7)
  v_mfma_f32_16x16x32_bf16 v[72:75], v[16:19], v[48:51], v[72:75]
  s_waitcnt lgkmcnt(6)
  v_mfma_f32_16x16x32_bf16 v[72:75], v[20:23], v[52:55], v[72:75]
  s_waitcnt lgkmcnt(5)
  v_mfma_f32_16x16x32_bf16 v[76:79], v[16:19], v[56:59], v[76:79]
  s_waitcnt lgkmcnt(4)
  v_mfma_f32_16x16x32_bf16 v[76:79], v[20:23], v[60:63], v[76:79]
  s_waitcnt lgkmcnt(2)
  v_mfma_f32_16x16x32_bf16 v[80:83], v[24:27], v[32:35], v[80:83]
  ds_read_b64_tr_b16 v[16:17], v6 offset:49152
  s_waitcnt lgkmcnt(1)
  v_mfma_f32_16x16x32_bf16 v[80:83], v[28:31], v[36:39], v[80:83]
  ds_read_b64_tr_b16 v[18:19], v6 offset:51200
  v_mfma_f32_16x16x32_bf16 v[84:87], v[24:27], v[40:43], v[84:87]
  ds_read_b64_tr_b16 v[20:21], v6 offset:57344
  v_mfma_f32_16x16x32_bf16 v[84:87], v[28:31], v[44:47], v[84:87]
  ds_read_b64_tr_b16 v[22:23], v6 offset:59392
  v_mfma_f32_16x16x32_bf16 v[88:91], v[24:27], v[48:51], v[88:91]
  v_mfma_f32_16x16x32_bf16 v[88:91], v[28:31], v[52:55], v[88:91]
  v_mfma_f32_16x16x32_bf16 v[92:95], v[24:27], v[56:59], v[92:95]
  v_mfma_f32_16x16x32_bf16 v[92:95], v[28:31], v[60:63], v[92:95]
  s_waitcnt lgkmcnt(2)
  v_mfma_f32_16x16x32_bf16 v[96:99], v[16:19], v[32:35], v[96:99]
  ds_read_b64_tr_b16 v[24:25], v7 offset:49152
  s_waitcnt lgkmcnt(1)
  v_mfma_f32_16x16x32_bf16 v[96:99], v[20:23], v[36:39], v[96:99]
  ds_read_b64_tr_b16 v[26:27], v7 offset:51200
  v_mfma_f32_16x16x32_bf16 v[100:103], v[16:19], v[40:43], v[100:103]
  ds_read_b64_tr_b16 v[28:29], v7 offset:57344
  v_mfma_f32_16x16x32_bf16 v[100:103], v[20:23], v[44:47], v[100:103]
  ds_read_b64_tr_b16 v[30:31], v7 offset:59392
  v_mfma_f32_16x16x32_bf16 v[104:107], v[16:19], v[48:51], v[104:107]
  v_mfma_f32_16x16x32_bf16 v[104:107], v[20:23], v[52:55], v[104:107]
  v_mfma_f32_16x16x32_bf16 v[108:111], v[16:19], v[56:59], v[108:111]
  v_mfma_f32_16x16x32_bf16 v[108:111], v[20:23], v[60:63], v[108:111]
  s_sub_u32 s50, s50, 1
  s_cmp_lg_u32 s50, 0
  s_waitcnt lgkmcnt(0)
  s_barrier
  v_mfma_f32_16x16x32_bf16 v[112:115], v[24:27], v[32:35], v[112:115]
  ds_read_b64_tr_b16 v[16:17], v4 offset:0
  v_mfma_f32_16x16x32_bf16 v[112:115], v[28:31], v[36:39], v[112:115]
  ds_read_b64_tr_b16 v[18:19], v4 offset:2048
  ds_read_b128 v[32:35], v1 offset:0
  ds_read_b128 v[36:39], v1 offset:1024
  v_mfma_f32_16x16x32_bf16 v[116:119], v[24:27], v[40:43], v[116:119]
  ds_read_b64_tr_b16 v[20:21], v4 offset:8192
  v_mfma_f32_16x16x32_bf16 v[116:119], v[28:31], v[44:47], v[116:119]
  ds_read_b64_tr_b16 v[22:23], v4 offset:10240
  ds_read_b128 v[40:43], v1 offset:2048
  ds_read_b128 v[44:47], v1 offset:3072
  v_mfma_f32_16x16x32_bf16 v[120:123], v[24:27], v[48:51], v[120:123]
  v_mfma_f32_16x16x32_bf16 v[120:123], v[28:31], v[52:55], v[120:123]
  ds_read_b128 v[48:51], v1 offset:4096
  ds_read_b128 v[52:55], v1 offset:5120
  v_mfma_f32_16x16x32_bf16 v[124:127], v[24:27], v[56:59], v[124:127]
  v_mfma_f32_16x16x32_bf16 v[124:127], v[28:31], v[60:63], v[124:127]
  ds_read_b128 v[56:59], v1 offset:6144
  ds_read_b128 v[60:63], v1 offset:7168
  s_cbranch_scc1 LB_L1
  s_waitcnt lgkmcnt(9)
  v_mfma_f32_16x16x32_bf16 v[64:67], v[16:19], v[32:35], v[64:67]
  ds_read_b64_tr_b16 v[24:25], v5 offset:0
  s_waitcnt lgkmcnt(7)
  v_mfma_f32_16x16x32_bf16 v[64:67], v[20:23], v[36:39], v[64:67]
  ds_read_b64_tr_b16 v[26:27], v5 offset:2048
  s_waitcnt lgkmcnt(7)
  v_mfma_f32_16x16x32_bf16 v[68:71], v[16:19], v[40:43], v[68:71]
  ds_read_b64_tr_b16 v[28:29], v5 offset:8192
  s_waitcnt lgkmcnt(7)
  v_mfma_f32_16x16x32_bf16 v[68:71], v[20:23], v[44:47], v[68:71]
  ds_read_b64_tr_b16 v[30:31], v5 offset:10240
  s_waitcnt lgkmcnt(7)
  v_mfma_f32_16x16x32_bf16 v[72:75], v[16:19], v[48:51], v[72:75]
  s_waitcnt lgkmcnt(6)
  v_mfma_f32_16x16x32_bf16 v[72:75], v[20:23], v[52:55], v[72:75]
  s_waitcnt lgkmcnt(5)
  v_mfma_f32_16x16x32_bf16 v[76:79], v[16:19], v[56:59], v[76:79]
  s_waitcnt lgkmcnt(4)
  v_mfma_f32_16x16x32_bf16 v[76:79], v[20:23], v[60:63], v[76:79]
  s_waitcnt lgkmcnt(2)
  v_mfma_f32_16x16x32_bf16 v[80:83], v[24:27], v[32:35], v[80:83]
  ds_read_b64_tr_b16 v[16:17], v6 offset:0
  s_waitcnt lgkmcnt(1)
  v_mfma_f32_16x16x32_bf16 v[80:83], v[28:31], v[36:39], v[80:83]
  ds_read_b64_tr_b16 v[18:19], v6 offset:2048
  v_mfma_f32_16x16x32_bf16 v[84:87], v[24:27], v[40:43], v[84:87]
  ds_read_b64_tr_b16 v[20:21], v6 offset:8192
  v_mfma_f32_16x16x32_bf16 v[84:87], v[28:31], v[44:47], v[84:87]
  ds_read_b64_tr_b16 v[22:23], v6 offset:10240
  v_mfma_f32_16x16x32_bf16 v[88:91], v[24:27], v[48:51], v[88:91]
  v_mfma_f32_16x16x32_bf16 v[88:91], v[28:31], v[52:55], v[88:91]
  v_mfma_f32_16x16x32_bf16 v[92:95], v[24:27], v[56:59], v[92:95]
  v_mfma_f32_16x16x32_bf16 v[92:95], v[28:31], v[60:63], v[92:95]
  s_waitcnt lgkmcnt(2)
  v_mfma_f32_16x16x32_bf16 v[96:99], v[16:19], v[32:35], v[96:99]
  ds_read_b64_tr_b16 v[24:25], v7 offset:0
  s_waitcnt lgkmcnt(1)
  v_mfma_f32_16x16x32_bf16 v[96:99], v[20:23], v[36:39], v[96:99]
  ds_read_b64_tr_b16 v[26:27], v7 offset:2048
  v_mfma_f32_16x16x32_bf16 v[100:103], v[16:19], v[40:43], v[100:103]
  ds_read_b64_tr_b16 v[28:29], v7 offset:8192
  v_mfma_f32_16x16x32_bf16 v[100:103], v[20:23], v[44:47], v[100:103]
  ds_read_b64_tr_b16 v[30:31], v7 offset:10240
  v_mfma_f32_16x16x32_bf16 v[104:107], v[16:19], v[48:51], v[104:107]
  v_mfma_f32_16x16x32_bf16 v[104:107], v[20:23], v[52:55], v[104:107]
  v_mfma_f32_16x16x32_bf16 v[108:111], v[16:19], v[56:59], v[108:111]
  v_mfma_f32_16x16x32_bf16 v[108:111], v[20:23], v[60:63], v[108:111]
  s_waitcnt lgkmcnt(0)
  s_barrier
  v_mfma_f32_16x16x32_bf16 v[112:115], v[24:27], v[32:35], v[112:115]
  ds_read_b64_tr_b16 v[16:17], v4 offset:16384
  v_mfma_f32_16x16x32_bf16 v[112:115], v[28:31], v[36:39], v[112:115]
  ds_read_b64_tr_b16 v[18:19], v4 offset:18432
  ds_read_b128 v[32:35], v1 offset:16384
  ds_read_b128 v[36:39], v1 offset:17408
  v_mfma_f32_16x16x32_bf16 v[116:119], v[24:27], v[40:43], v[116:119]
  ds_read_b64_tr_b16 v[20:21], v4 offset:24576
  v_mfma_f32_16x16x32_bf16 v[116:119], v[28:31], v[44:47], v[116:119]
  ds_read_b64_tr_b16 v[22:23], v4 offset:26624
  ds_read_b128 v[40:43], v1 offset:18432
  ds_read_b128 v[44:47], v1 offset:19456
  v_mfma_f32_16x16x32_bf16 v[120:123], v[24:27], v[48:51], v[120:123]
  v_mfma_f32_16x16x32_bf16 v[120:123], v[28:31], v[52:55], v[120:123]
  ds_read_b128 v[48:51], v1 offset:20480
  ds_read_b128 v[52:55], v1 offset:21504
  v_mfma_f32_16x16x32_bf16 v[124:127], v[24:27], v[56:59], v[124:127]
  v_mfma_f32_16x16x32_bf16 v[124:127], v[28:31], v[60:63], v[124:127]
  ds_read_b128 v[56:59], v1 offset:22528
  ds_read_b128 v[60:63], v1 offset:23552
  s_waitcnt lgkmcnt(9)
  v_mfma_f32_16x16x32_bf16 v[64:67], v[16:19], v[32:35], v[64:67]
  ds_read_b64_tr_b16 v[24:25], v5 offset:16384
  s_waitcnt lgkmcnt(7)
  v_mfma_f32_16x16x32_bf16 v[64:67], v[20:23], v[36:39], v[64:67]
  ds_read_b64_tr_b16 v[26:27], v5 offset:18432
  s_waitcnt lgkmcnt(7)
  v_mfma_f32_16x16x32_bf16 v[68:71], v[16:19], v[40:43], v[68:71]
  ds_read_b64_tr_b16 v[28:29], v5 offset:24576
  s_waitcnt lgkmcnt(7)
  v_mfma_f32_16x16x32_bf16 v[68:71], v[20:23], v[44:47], v[68:71]
  ds_read_b64_tr_b16 v[30:31], v5 offset:26624
  s_waitcnt lgkmcnt(7)
  v_mfma_f32_16x16x32_bf16 v[72:75], v[16:19], v[48:51], v[72:75]
  s_waitcnt lgkmcnt(6)
  v_mfma_f32_16x16x32_bf16 v[72:75], v[20:23], v[52:55], v[72:75]
  s_waitcnt lgkmcnt(5)
  v_mfma_f32_16x16x32_bf16 v[76:79], v[16:19], v[56:59], v[76:79]
  s_waitcnt lgkmcnt(4)
  v_mfma_f32_16x16x32_bf16 v[76:79], v[20:23], v[60:63], v[76:79]
  s_waitcnt lgkmcnt(2)
  v_mfma_f32_16x16x32_bf16 v[80:83], v[24:27], v[32:35], v[80:83]
  ds_read_b64_tr_b16 v[16:17], v6 offset:16384
  s_waitcnt lgkmcnt(1)
  v_mfma_f32_16x16x32_bf16 v[80:83], v[28:31], v[36:39], v[80:83]
  ds_read_b64_tr_b16 v[18:19], v6 offset:18432
  v_mfma_f32_16x16x32_bf16 v[84:87], v[24:27], v[40:43], v[84:87]
  ds_read_b64_tr_b16 v[20:21], v6 offset:24576
  v_mfma_f32_16x16x32_bf16 v[84:87], v[28:31], v[44:47], v[84:87]
  ds_read_b64_tr_b16 v[22:23], v6 offset:26624
  v_mfma_f32_16x16x32_bf16 v[88:91], v[24:27], v[48:51], v[88:91]
  v_mfma_f32_16x16x32_bf16 v[88:91], v[28:31], v[52:55], v[88:91]
  v_mfma_f32_16x16x32_bf16 v[92:95], v[24:27], v[56:59], v[92:95]
  v_mfma_f32_16x16x32_bf16 v[92:95], v[28:31], v[60:63], v[92:95]
  s_waitcnt lgkmcnt(2)
  v_mfma_f32_16x16x32_bf16 v[96:99], v[16:19], v[32:35], v[96:99]
  ds_read_b64_tr_b16 v[24:25], v7 offset:16384
  s_waitcnt lgkmcnt(1)
  v_mfma_f32_16x16x32_bf16 v[96:99], v[20:23], v[36:39], v[96:99]
  ds_read_b64_tr_b16 v[26:27], v7 offset:18432
  v_mfma_f32_16x16x32_bf16 v[100:103], v[16:19], v[40:43], v[100:103]
  ds_read_b64_tr_b16 v[28:29], v7 offset:24576
  v_mfma_f32_16x16x32_bf16 v[100:103], v[20:23], v[44:47], v[100:103]
  ds_read_b64_tr_b16 v[30:31], v7 offset:26624
  v_mfma_f32_16x16x32_bf16 v[104:107], v[16:19], v[48:51], v[104:107]
  v_mfma_f32_16x16x32_bf16 v[104:107], v[20:23], v[52:55], v[104:107]
  v_mfma_f32_16x16x32_bf16 v[108:111], v[16:19], v[56:59], v[108:111]
  v_mfma_f32_16x16x32_bf16 v[108:111], v[20:23], v[60:63], v[108:111]
  s_waitcnt lgkmcnt(0)
  s_barrier
  v_mfma_f32_16x16x32_bf16 v[112:115], v[24:27], v[32:35], v[112:115]
  ds_read_b64_tr_b16 v[16:17], v4 offset:32768
  v_mfma_f32_16x16x32_bf16 v[112:115], v[28:31], v[36:39], v[112:115]
  ds_read_b64_tr_b16 v[18:19], v4 offset:34816
  ds_read_b128 v[32:35], v1 offset:32768
  ds_read_b128 v[36:39], v1 offset:33792
  v_mfma_f32_16x16x32_bf16 v[116:119], v[24:27], v[40:43], v[116:119]
  ds_read_b64_tr_b16 v[20:21], v4 offset:40960
  v_mfma_f32_16x16x32_bf16 v[116:119], v[28:31], v[44:47], v[116:119]
  ds_read_b64_tr_b16 v[22:23], v4 offset:43008
  ds_read_b128 v[40:43], v1 offset:34816
  ds_read_b128 v[44:47], v1 offset:35840
  v_mfma_f32_16x16x32_bf16 v[120:123], v[24:27], v[48:51], v[120:123]
  v_mfma_f32_16x16x32_bf16 v[120:123], v[28:31], v[52:55], v[120:123]
  ds_read_b128 v[48:51], v1 offset:36864
  ds_read_b128 v[52:55], v1 offset:37888
  v_mfma_f32_16x16x32_bf16 v[124:127], v[24:27], v[56:59], v[124:127]
  v_mfma_f32_16x16x32_bf16 v[124:127], v[28:31], v[60:63], v[124:127]
  ds_read_b128 v[56:59], v1 offset:38912
  ds_read_b128 v[60:63], v1 offset:39936
  s_waitcnt lgkmcnt(9)
  v_mfma_f32_16x16x32_bf16 v[64:67], v[16:19], v[32:35], v[64:67]
  ds_read_b64_tr_b16 v[24:25], v5 offset:32768
  s_waitcnt lgkmcnt(7)
  v_mfma_f32_16x16x32_bf16 v[64:67], v[20:23], v[36:39], v[64:67]
  ds_read_b64_tr_b16 v[26:27], v5 offset:34816
  s_waitcnt lgkmcnt(7)
  v_mfma_f32_16x16x32_bf16 v[68:71], v[16:19], v[40:43], v[68:71]
  ds_read_b64_tr_b16 v[28:29], v5 offset:40960
  s_waitcnt lgkmcnt(7)
  v_mfma_f32_16x16x32_bf16 v[68:71], v[20:23], v[44:47], v[68:71]
  ds_read_b64_tr_b16 v[30:31], v5 offset:43008
  s_waitcnt lgkmcnt(7)
  v_mfma_f32_16x16x32_bf16 v[72:75], v[16:19], v[48:51], v[72:75]
  s_waitcnt lgkmcnt(6)
  v_mfma_f32_16x16x32_bf16 v[72:75], v[20:23], v[52:55], v[72:75]
  s_waitcnt lgkmcnt(5)
  v_mfma_f32_16x16x32_bf16 v[76:79], v[16:19], v[56:59], v[76:79]
  s_waitcnt lgkmcnt(4)
  v_mfma_f32_16x16x32_bf16 v[76:79], v[20:23], v[60:63], v[76:79]
  s_waitcnt lgkmcnt(2)
  v_mfma_f32_16x16x32_bf16 v[80:83], v[24:27], v[32:35], v[80:83]
  ds_read_b64_tr_b16 v[16:17], v6 offset:32768
  s_waitcnt lgkmcnt(1)
  v_mfma_f32_16x16x32_bf16 v[80:83], v[28:31], v[36:39], v[80:83]
  ds_read_b64_tr_b16 v[18:19], v6 offset:34816
  v_mfma_f32_16x16x32_bf16 v[84:87], v[24:27], v[40:43], v[84:87]
  ds_read_b64_tr_b16 v[20:21], v6 offset:40960
  v_mfma_f32_16x16x32_bf16 v[84:87], v[28:31], v[44:47], v[84:87]
  ds_read_b64_tr_b16 v[22:23], v6 offset:43008
  v_mfma_f32_16x16x32_bf16 v[88:91], v[24:27], v[48:51], v[88:91]
  v_mfma_f32_16x16x32_bf16 v[88:91], v[28:31], v[52:55], v[88:91]
  v_mfma_f32_16x16x32_bf16 v[92:95], v[24:27], v[56:59], v[92:95]
  v_mfma_f32_16x16x32_bf16 v[92:95], v[28:31], v[60:63], v[92:95]
  s_waitcnt lgkmcnt(2)
  v_mfma_f32_16x16x32_bf16 v[96:99], v[16:19], v[32:35], v[96:99]
  ds_read_b64_tr_b16 v[24:25], v7 offset:32768
  s_waitcnt lgkmcnt(1)
  v_mfma_f32_16x16x32_bf16 v[96:99], v[20:23], v[36:39], v[96:99]
  ds_read_b64_tr_b16 v[26:27], v7 offset:34816
  v_mfma_f32_16x16x32_bf16 v[100:103], v[16:19], v[40:43], v[100:103]
  ds_read_b64_tr_b16 v[28:29], v7 offset:40960
  v_mfma_f32_16x16x32_bf16 v[100:103], v[20:23], v[44:47], v[100:103]
  ds_read_b64_tr_b16 v[30:31], v7 offset:43008
  v_mfma_f32_16x16x32_bf16 v[104:107], v[16:19], v[48:51], v[104:107]
  v_mfma_f32_16x16x32_bf16 v[104:107], v[20:23], v[52:55], v[104:107]
  v_mfma_f32_16x16x32_bf16 v[108:111], v[16:19], v[56:59], v[108:111]
  v_mfma_f32_16x16x32_bf16 v[108:111], v[20:23], v[60:63], v[108:111]
  s_waitcnt lgkmcnt(0)
  s_barrier
  v_mfma_f32_16x16x32_bf16 v[112:115], v[24:27], v[32:35], v[112:115]
  ds_read_b64_tr_b16 v[16:17], v4 offset:49152
  v_mfma_f32_16x16x32_bf16 v[112:115], v[28:31], v[36:39], v[112:115]
  ds_read_b64_tr_b16 v[18:19], v4 offset:51200
  ds_read_b128 v[32:35], v1 offset:49152
  ds_read_b128 v[36:39], v1 offset:50176
  v_mfma_f32_16x16x32_bf16 v[116:119], v[24:27], v[40:43], v[116:119]
  ds_read_b64_tr_b16 v[20:21], v4 offset:57344
  v_mfma_f32_16x16x32_bf16 v[116:119], v[28:31], v[44:47], v[116:119]
  ds_read_b64_tr_b16 v[22:23], v4 offset:59392
  ds_read_b128 v[40:43], v1 offset:51200
  ds_read_b128 v[44:47], v1 offset:52224
  v_mfma_f32_16x16x32_bf16 v[120:123], v[24:27], v[48:51], v[120:123]
  v_mfma_f32_16x16x32_bf16 v[120:123], v[28:31], v[52:55], v[120:123]
  ds_read_b128 v[48:51], v1 offset:53248
  ds_read_b128 v[52:55], v1 offset:54272
  v_mfma_f32_16x16x32_bf16 v[124:127], v[24:27], v[56:59], v[124:127]
  v_mfma_f32_16x16x32_bf16 v[124:127], v[28:31], v[60:63], v[124:127]
  ds_read_b128 v[56:59], v1 offset:55296
  ds_read_b128 v[60:63], v1 offset:56320
  s_waitcnt lgkmcnt(9)
  v_mfma_f32_16x16x32_bf16 v[64:67], v[16:19], v[32:35], v[64:67]
  ds_read_b64_tr_b16 v[24:25], v5 offset:49152
  s_waitcnt lgkmcnt(7)
  v_mfma_f32_16x16x32_bf16 v[64:67], v[20:23], v[36:39], v[64:67]
  ds_read_b64_tr_b16 v[26:27], v5 offset:51200
  s_waitcnt lgkmcnt(7)
  v_mfma_f32_16x16x32_bf16 v[68:71], v[16:19], v[40:43], v[68:71]
  ds_read_b64_tr_b16 v[28:29], v5 offset:57344
  s_waitcnt lgkmcnt(7)
  v_mfma_f32_16x16x32_bf16 v[68:71], v[20:23], v[44:47], v[68:71]
  ds_read_b64_tr_b16 v[30:31], v5 offset:59392
  s_waitcnt lgkmcnt(7)
  v_mfma_f32_16x16x32_bf16 v[72:75], v[16:19], v[48:51], v[72:75]
  s_waitcnt lgkmcnt(6)
  v_mfma_f32_16x16x32_bf16 v[72:75], v[20:23], v[52:55], v[72:75]
  s_waitcnt lgkmcnt(5)
  v_mfma_f32_16x16x32_bf16 v[76:79], v[16:19], v[56:59], v[76:79]
  s_waitcnt lgkmcnt(4)
  v_mfma_f32_16x16x32_bf16 v[76:79], v[20:23], v[60:63], v[76:79]
  s_waitcnt lgkmcnt(2)
  v_mfma_f32_16x16x32_bf16 v[80:83], v[24:27], v[32:35], v[80:83]
  ds_read_b64_tr_b16 v[16:17], v6 offset:49152
  s_waitcnt lgkmcnt(1)
  v_mfma_f32_16x16x32_bf16 v[80:83], v[28:31], v[36:39], v[80:83]
  ds_read_b64_tr_b16 v[18:19], v6 offset:51200
  v_mfma_f32_16x16x32_bf16 v[84:87], v[24:27], v[40:43], v[84:87]
  ds_read_b64_tr_b16 v[20:21], v6 offset:57344
  v_mfma_f32_16x16x32_bf16 v[84:87], v[28:31], v[44:47], v[84:87]
  ds_read_b64_tr_b16 v[22:23], v6 offset:59392
  v_mfma_f32_16x16x32_bf16 v[88:91], v[24:27], v[48:51], v[88:91]
  v_mfma_f32_16x16x32_bf16 v[88:91], v[28:31], v[52:55], v[88:91]
  v_mfma_f32_16x16x32_bf16 v[92:95], v[24:27], v[56:59], v[92:95]
  v_mfma_f32_16x16x32_bf16 v[92:95], v[28:31], v[60:63], v[92:95]
  s_waitcnt lgkmcnt(2)
  v_mfma_f32_16x16x32_bf16 v[96:99], v[16:19], v[32:35], v[96:99]
  ds_read_b64_tr_b16 v[24:25], v7 offset:49152
  s_waitcnt lgkmcnt(1)
  v_mfma_f32_16x16x32_bf16 v[96:99], v[20:23], v[36:39], v[96:99]
  ds_read_b64_tr_b16 v[26:27], v7 offset:51200
  v_mfma_f32_16x16x32_bf16 v[100:103], v[16:19], v[40:43], v[100:103]
  ds_read_b64_tr_b16 v[28:29], v7 offset:57344
  v_mfma_f32_16x16x32_bf16 v[100:103], v[20:23], v[44:47], v[100:103]
  ds_read_b64_tr_b16 v[30:31], v7 offset:59392
  v_mfma_f32_16x16x32_bf16 v[104:107], v[16:19], v[48:51], v[104:107]
  v_mfma_f32_16x16x32_bf16 v[104:107], v[20:23], v[52:55], v[104:107]
  v_mfma_f32_16x16x32_bf16 v[108:111], v[16:19], v[56:59], v[108:111]
  v_mfma_f32_16x16x32_bf16 v[108:111], v[20:23], v[60:63], v[108:111]
  s_waitcnt lgkmcnt(2)
  v_mfma_f32_16x16x32_bf16 v[112:115], v[24:27], v[32:35], v[112:115]
  s_waitcnt lgkmcnt(0)
  v_mfma_f32_16x16x32_bf16 v[112:115], v[28:31], v[36:39], v[112:115]
  v_mfma_f32_16x16x32_bf16 v[116:119], v[24:27], v[40:43], v[116:119]
  v_mfma_f32_16x16x32_bf16 v[116:119], v[28:31], v[44:47], v[116:119]
  v_mfma_f32_16x16x32_bf16 v[120:123], v[24:27], v[48:51], v[120:123]
  v_mfma_f32_16x16x32_bf16 v[120:123], v[28:31], v[52:55], v[120:123]
  v_mfma_f32_16x16x32_bf16 v[124:127], v[24:27], v[56:59], v[124:127]
  v_mfma_f32_16x16x32_bf16 v[124:127], v[28:31], v[60:63], v[124:127]
L_epi:
  s_cmp_eq_u32 s15, 0
  s_cbranch_scc1 L_fin2
  s_nop 5
  v_pk_fma_f32 v[64:65], v[64:65], v[8:9], v[8:9] op_sel:[0,0,1] op_sel_hi:[1,0,1]
  v_pk_fma_f32 v[66:67], v[66:67], v[8:9], v[8:9] op_sel:[0,0,1] op_sel_hi:[1,0,1]
  v_pk_fma_f32 v[68:69], v[68:69], v[10:11], v[10:11] op_sel:[0,0,1] op_sel_hi:[1,0,1]
  v_pk_fma_f32 v[70:71], v[70:71], v[10:11], v[10:11] op_sel:[0,0,1] op_sel_hi:[1,0,1]
  v_cvt_pk_bf16_f32 v16, v64, v65
  v_cvt_pk_bf16_f32 v17, v66, v67
  v_cvt_pk_bf16_f32 v18, v68, v69
  v_cvt_pk_bf16_f32 v19, v70, v71
  v_min_u32 v16, -2, v16
  v_min_u32 v17, -2, v17
  v_min_u32 v18, -2, v18
  v_min_u32 v19, -2, v19
  buffer_store_dwordx4 v[16:19], v3, s[32:35], s52 offen offset:0 sc1
  v_pk_fma_f32 v[72:73], v[72:73], v[12:13], v[12:13] op_sel:[0,0,1] op_sel_hi:[1,0,1]
  v_pk_fma_f32 v[74:75], v[74:75], v[12:13], v[12:13] op_sel:[0,0,1] op_sel_hi:[1,0,1]
  v_pk_fma_f32 v[76:77], v[76:77], v[14:15], v[14:15] op_sel:[0,0,1] op_sel_hi:[1,0,1]
  v_pk_fma_f32 v[78:79], v[78:79], v[14:15], v[14:15] op_sel:[0,0,1] op_sel_hi:[1,0,1]
  v_cvt_pk_bf16_f32 v20, v72, v73
  v_cvt_pk_bf16_f32 v21, v74, v75
  v_cvt_pk_bf16_f32 v22, v76, v77
  v_cvt_pk_bf16_f32 v23, v78, v79
  v_min_u32 v20, -2, v20
  v_min_u32 v21, -2, v21
  v_min_u32 v22, -2, v22
  v_min_u32 v23, -2, v23
  buffer_store_dwordx4 v[20:23], v3, s[32:35], s52 offen offset:1024 sc1
  v_pk_fma_f32 v[80:81], v[80:81], v[8:9], v[8:9] op_sel:[0,0,1] op_sel_hi:[1,0,1]
  v_pk_fma_f32 v[82:83], v[82:83], v[8:9], v[8:9] op_sel:[0,0,1] op_sel_hi:[1,0,1]
  v_pk_fma_f32 v[84:85], v[84:85], v[10:11], v[10:11] op_sel:[0,0,1] op_sel_hi:[1,0,1]
  v_pk_fma_f32 v[86:87], v[86:87], v[10:11], v[10:11] op_sel:[0,0,1] op_sel_hi:[1,0,1]
  v_cvt_pk_bf16_f32 v24, v80, v81
  v_cvt_pk_bf16_f32 v25, v82, v83
  v_cvt_pk_bf16_f32 v26, v84, v85
  v_cvt_pk_bf16_f32 v27, v86, v87
  v_min_u32 v24, -2, v24
  v_min_u32 v25, -2, v25
  v_min_u32 v26, -2, v26
  v_min_u32 v27, -2, v27
  buffer_store_dwordx4 v[24:27], v3, s[32:35], s52 offen offset:2048 sc1
  v_pk_fma_f32 v[88:89], v[88:89], v[12:13], v[12:13] op_sel:[0,0,1] op_sel_hi:[1,0,1]
  v_pk_fma_f32 v[90:91], v[90:91], v[12:13], v[12:13] op_sel:[0,0,1] op_sel_hi:[1,0,1]
  v_pk_fma_f32 v[92:93], v[92:93], v[14:15], v[14:15] op_sel:[0,0,1] op_sel_hi:[1,0,1]
  v_pk_fma_f32 v[94:95], v[94:95], v[14:15], v[14:15] op_sel:[0,0,1] op_sel_hi:[1,0,1]
  v_cvt_pk_bf16_f32 v28, v88, v89
  v_cvt_pk_bf16_f32 v29, v90, v91
  v_cvt_pk_bf16_f32 v30, v92, v93
  v_cvt_pk_bf16_f32 v31, v94, v95
  v_min_u32 v28, -2, v28
  v_min_u32 v29, -2, v29
  v_min_u32 v30, -2, v30
  v_min_u32 v31, -2, v31
  buffer_store_dwordx4 v[28:31], v3, s[32:35], s52 offen offset:3072 sc1
  v_pk_fma_f32 v[96:97], v[96:97], v[8:9], v[8:9] op_sel:[0,0,1] op_sel_hi:[1,0,1]
  v_pk_fma_f32 v[98:99], v[98:99], v[8:9], v[8:9] op_sel:[0,0,1] op_sel_hi:[1,0,1]
  v_pk_fma_f32 v[100:101], v[100:101], v[10:11], v[10:11] op_sel:[0,0,1] op_sel_hi:[1,0,1]
  v_pk_fma_f32 v[102:103], v[102:103], v[10:11], v[10:11] op_sel:[0,0,1] op_sel_hi:[1,0,1]
  v_cvt_pk_bf16_f32 v32, v96, v97
  v_cvt_pk_bf16_f32 v33, v98, v99
  v_cvt_pk_bf16_f32 v34, v100, v101
  v_cvt_pk_bf16_f32 v35, v102, v103
  v_min_u32 v32, -2, v32
  v_min_u32 v33, -2, v33
  v_min_u32 v34, -2, v34
  v_min_u32 v35, -2, v35
  buffer_store_dwordx4 v[32:35], v3, s[32:35], s53 offen offset:0 sc1
  v_pk_fma_f32 v[104:105], v[104:105], v[12:13], v[12:13] op_sel:[0,0,1] op_sel_hi:[1,0,1]
  v_pk_fma_f32 v[106:107], v[106:107], v[12:13], v[12:13] op_sel:[0,0,1] op_sel_hi:[1,0,1]
  v_pk_fma_f32 v[108:109], v[108:109], v[14:15], v[14:15] op_sel:[0,0,1] op_sel_hi:[1,0,1]
  v_pk_fma_f32 v[110:111], v[110:111], v[14:15], v[14:15] op_sel:[0,0,1] op_sel_hi:[1,0,1]
  v_cvt_pk_bf16_f32 v36, v104, v105
  v_cvt_pk_bf16_f32 v37, v106, v107
  v_cvt_pk_bf16_f32 v38, v108, v109
  v_cvt_pk_bf16_f32 v39, v110, v111
  v_min_u32 v36, -2, v36
  v_min_u32 v37, -2, v37
  v_min_u32 v38, -2, v38
  v_min_u32 v39, -2, v39
  buffer_store_dwordx4 v[36:39], v3, s[32:35], s53 offen offset:1024 sc1
  v_pk_fma_f32 v[112:113], v[112:113], v[8:9], v[8:9] op_sel:[0,0,1] op_sel_hi:[1,0,1]
  v_pk_fma_f32 v[114:115], v[114:115], v[8:9], v[8:9] op_sel:[0,0,1] op_sel_hi:[1,0,1]
  v_pk_fma_f32 v[116:117], v[116:117], v[10:11], v[10:11] op_sel:[0,0,1] op_sel_hi:[1,0,1]
  v_pk_fma_f32 v[118:119], v[118:119], v[10:11], v[10:11] op_sel:[0,0,1] op_sel_hi:[1,0,1]
  v_cvt_pk_bf16_f32 v40, v112, v113
  v_cvt_pk_bf16_f32 v41, v114, v115
  v_cvt_pk_bf16_f32 v42, v116, v117
  v_cvt_pk_bf16_f32 v43, v118, v119
  v_min_u32 v40, -2, v40
  v_min_u32 v41, -2, v41
  v_min_u32 v42, -2, v42
  v_min_u32 v43, -2, v43
  buffer_store_dwordx4 v[40:43], v3, s[32:35], s53 offen offset:2048 sc1
  v_pk_fma_f32 v[120:121], v[120:121], v[12:13], v[12:13] op_sel:[0,0,1] op_sel_hi:[1,0,1]
  v_pk_fma_f32 v[122:123], v[122:123], v[12:13], v[12:13] op_sel:[0,0,1] op_sel_hi:[1,0,1]
  v_pk_fma_f32 v[124:125], v[124:125], v[14:15], v[14:15] op_sel:[0,0,1] op_sel_hi:[1,0,1]
  v_pk_fma_f32 v[126:127], v[126:127], v[14:15], v[14:15] op_sel:[0,0,1] op_sel_hi:[1,0,1]
  v_cvt_pk_bf16_f32 v44, v120, v121
  v_cvt_pk_bf16_f32 v45, v122, v123
  v_cvt_pk_bf16_f32 v46, v124, v125
  v_cvt_pk_bf16_f32 v47, v126, v127
  v_min_u32 v44, -2, v44
  v_min_u32 v45, -2, v45
  v_min_u32 v46, -2, v46
  v_min_u32 v47, -2, v47
  buffer_store_dwordx4 v[44:47], v3, s[32:35], s53 offen offset:3072 sc1
  s_endpgm
L_fin2:
  buffer_load_dwordx4 v[16:19], v3, s[32:35], s52 offen offset:0 sc1
  buffer_load_dwordx4 v[20:23], v3, s[32:35], s52 offen offset:1024 sc1
  buffer_load_dwordx4 v[24:27], v3, s[32:35], s52 offen offset:2048 sc1
  buffer_load_dwordx4 v[28:31], v3, s[32:35], s52 offen offset:3072 sc1
  buffer_load_dwordx4 v[32:35], v3, s[32:35], s53 offen offset:0 sc1
  buffer_load_dwordx4 v[36:39], v3, s[32:35], s53 offen offset:1024 sc1
  buffer_load_dwordx4 v[40:43], v3, s[32:35], s53 offen offset:2048 sc1
  buffer_load_dwordx4 v[44:47], v3, s[32:35], s53 offen offset:3072 sc1
  v_pk_fma_f32 v[64:65], v[64:65], v[8:9], v[8:9] op_sel:[0,0,1] op_sel_hi:[1,0,1]
  v_pk_fma_f32 v[66:67], v[66:67], v[8:9], v[8:9] op_sel:[0,0,1] op_sel_hi:[1,0,1]
  v_pk_fma_f32 v[68:69], v[68:69], v[10:11], v[10:11] op_sel:[0,0,1] op_sel_hi:[1,0,1]
  v_pk_fma_f32 v[70:71], v[70:71], v[10:11], v[10:11] op_sel:[0,0,1] op_sel_hi:[1,0,1]
  v_pk_fma_f32 v[72:73], v[72:73], v[12:13], v[12:13] op_sel:[0,0,1] op_sel_hi:[1,0,1]
  v_pk_fma_f32 v[74:75], v[74:75], v[12:13], v[12:13] op_sel:[0,0,1] op_sel_hi:[1,0,1]
  v_pk_fma_f32 v[76:77], v[76:77], v[14:15], v[14:15] op_sel:[0,0,1] op_sel_hi:[1,0,1]
  v_pk_fma_f32 v[78:79], v[78:79], v[14:15], v[14:15] op_sel:[0,0,1] op_sel_hi:[1,0,1]
  v_pk_fma_f32 v[80:81], v[80:81], v[8:9], v[8:9] op_sel:[0,0,1] op_sel_hi:[1,0,1]
  v_pk_fma_f32 v[82:83], v[82:83], v[8:9], v[8:9] op_sel:[0,0,1] op_sel_hi:[1,0,1]
  v_pk_fma_f32 v[84:85], v[84:85], v[10:11], v[10:11] op_sel:[0,0,1] op_sel_hi:[1,0,1]
  v_pk_fma_f32 v[86:87], v[86:87], v[10:11], v[10:11] op_sel:[0,0,1] op_sel_hi:[1,0,1]
  v_pk_fma_f32 v[88:89], v[88:89], v[12:13], v[12:13] op_sel:[0,0,1] op_sel_hi:[1,0,1]
  v_pk_fma_f32 v[90:91], v[90:91], v[12:13], v[12:13] op_sel:[0,0,1] op_sel_hi:[1,0,1]
  v_pk_fma_f32 v[92:93], v[92:93], v[14:15], v[14:15] op_sel:[0,0,1] op_sel_hi:[1,0,1]
  v_pk_fma_f32 v[94:95], v[94:95], v[14:15], v[14:15] op_sel:[0,0,1] op_sel_hi:[1,0,1]
  v_pk_fma_f32 v[96:97], v[96:97], v[8:9], v[8:9] op_sel:[0,0,1] op_sel_hi:[1,0,1]
  v_pk_fma_f32 v[98:99], v[98:99], v[8:9], v[8:9] op_sel:[0,0,1] op_sel_hi:[1,0,1]
  v_pk_fma_f32 v[100:101], v[100:101], v[10:11], v[10:11] op_sel:[0,0,1] op_sel_hi:[1,0,1]
  v_pk_fma_f32 v[102:103], v[102:103], v[10:11], v[10:11] op_sel:[0,0,1] op_sel_hi:[1,0,1]
  v_pk_fma_f32 v[104:105], v[104:105], v[12:13], v[12:13] op_sel:[0,0,1] op_sel_hi:[1,0,1]
  v_pk_fma_f32 v[106:107], v[106:107], v[12:13], v[12:13] op_sel:[0,0,1] op_sel_hi:[1,0,1]
  v_pk_fma_f32 v[108:109], v[108:109], v[14:15], v[14:15] op_sel:[0,0,1] op_sel_hi:[1,0,1]
  v_pk_fma_f32 v[110:111], v[110:111], v[14:15], v[14:15] op_sel:[0,0,1] op_sel_hi:[1,0,1]
  v_pk_fma_f32 v[112:113], v[112:113], v[8:9], v[8:9] op_sel:[0,0,1] op_sel_hi:[1,0,1]
  v_pk_fma_f32 v[114:115], v[114:115], v[8:9], v[8:9] op_sel:[0,0,1] op_sel_hi:[1,0,1]
  v_pk_fma_f32 v[116:117], v[116:117], v[10:11], v[10:11] op_sel:[0,0,1] op_sel_hi:[1,0,1]
  v_pk_fma_f32 v[118:119], v[118:119], v[10:11], v[10:11] op_sel:[0,0,1] op_sel_hi:[1,0,1]
  v_pk_fma_f32 v[120:121], v[120:121], v[12:13], v[12:13] op_sel:[0,0,1] op_sel_hi:[1,0,1]
  v_pk_fma_f32 v[122:123], v[122:123], v[12:13], v[12:13] op_sel:[0,0,1] op_sel_hi:[1,0,1]
  v_pk_fma_f32 v[124:125], v[124:125], v[14:15], v[14:15] op_sel:[0,0,1] op_sel_hi:[1,0,1]
  v_pk_fma_f32 v[126:127], v[126:127], v[14:15], v[14:15] op_sel:[0,0,1] op_sel_hi:[1,0,1]
  s_mov_b32 s57, 0x40000
L_poll:
  s_waitcnt vmcnt(0) lgkmcnt(0)
  v_max3_u32 v4, v16, v17, v18
  v_max3_u32 v5, v19, v20, v21
  v_max3_u32 v4, v4, v22, v23
  v_max3_u32 v5, v5, v24, v25
  v_max3_u32 v4, v4, v26, v27
  v_max3_u32 v5, v5, v28, v29
  v_max3_u32 v4, v4, v30, v31
  v_max3_u32 v5, v5, v32, v33
  v_max3_u32 v4, v4, v34, v35
  v_max3_u32 v5, v5, v36, v37
  v_max3_u32 v4, v4, v38, v39
  v_max3_u32 v5, v5, v40, v41
  v_max3_u32 v4, v4, v42, v43
  v_max3_u32 v5, v5, v44, v45
  v_max3_u32 v4, v4, v46, v47
  v_max_u32 v4, v4, v5
  v_cmp_eq_u32 vcc, -1, v4
  s_nop 4
  s_cbranch_vccz L_got
  buffer_load_dwordx4 v[16:19], v3, s[32:35], s52 offen offset:0 sc1
  buffer_load_dwordx4 v[20:23], v3, s[32:35], s52 offen offset:1024 sc1
  buffer_load_dwordx4 v[24:27], v3, s[32:35], s52 offen offset:2048 sc1
  buffer_load_dwordx4 v[28:31], v3, s[32:35], s52 offen offset:3072 sc1
  buffer_load_dwordx4 v[32:35], v3, s[32:35], s53 offen offset:0 sc1
  buffer_load_dwordx4 v[36:39], v3, s[32:35], s53 offen offset:1024 sc1
  buffer_load_dwordx4 v[40:43], v3, s[32:35], s53 offen offset:2048 sc1
  buffer_load_dwordx4 v[44:47], v3, s[32:35], s53 offen offset:3072 sc1
  s_sub_u32 s57, s57, 1
  s_cmp_lg_u32 s57, 0
  s_cbranch_scc1 L_poll
L_got:
  v_lshlrev_b32 v8, 16, v16
  v_and_b32 v9, 0xffff0000, v16
  v_lshlrev_b32 v10, 16, v17
  v_and_b32 v11, 0xffff0000, v17
  v_pk_add_f32 v[64:65], v[64:65], v[8:9]
  v_pk_add_f32 v[66:67], v[66:67], v[10:11]
  v_lshlrev_b32 v12, 16, v24
  v_and_b32 v13, 0xffff0000, v24
  v_lshlrev_b32 v14, 16, v25
  v_and_b32 v15, 0xffff0000, v25
  v_pk_add_f32 v[80:81], v[80:81], v[12:13]
  v_pk_add_f32 v[82:83], v[82:83], v[14:15]
  v_lshlrev_b32 v8, 16, v32
  v_and_b32 v9, 0xffff0000, v32
  v_lshlrev_b32 v10, 16, v33
  v_and_b32 v11, 0xffff0000, v33
  v_pk_add_f32 v[96:97], v[96:97], v[8:9]
  v_pk_add_f32 v[98:99], v[98:99], v[10:11]
  v_lshlrev_b32 v12, 16, v40
  v_and_b32 v13, 0xffff0000, v40
  v_lshlrev_b32 v14, 16, v41
  v_and_b32 v15, 0xffff0000, v41
  v_pk_add_f32 v[112:113], v[112:113], v[12:13]
  v_pk_add_f32 v[114:115], v[114:115], v[14:15]
  v_cvt_pk_bf16_f32 v48, v64, v65
  v_cvt_pk_bf16_f32 v49, v66, v67
  v_cvt_pk_bf16_f32 v50, v80, v81
  v_cvt_pk_bf16_f32 v51, v82, v83
  v_cvt_pk_bf16_f32 v52, v96, v97
  v_cvt_pk_bf16_f32 v53, v98, v99
  v_cvt_pk_bf16_f32 v54, v112, v113
  v_cvt_pk_bf16_f32 v55, v114, v115
  s_add_u32 s55, s54, 0
  s_add_u32 s58, s54, 16384
  v_permlane16_swap_b32 v48, v50
  v_permlane16_swap_b32 v49, v51
  v_permlane16_swap_b32 v52, v54
  v_permlane16_swap_b32 v53, v55
  v_mov_b32 v4, v48
  v_mov_b32 v5, v49
  v_mov_b32 v6, v50
  v_mov_b32 v7, v51
  v_mov_b32_dpp v48, v52 row_ror:8 row_mask:0xf bank_mask:0xc
  v_mov_b32_dpp v49, v53 row_ror:8 row_mask:0xf bank_mask:0xc
  v_mov_b32_dpp v50, v54 row_ror:8 row_mask:0xf bank_mask:0xc
  v_mov_b32_dpp v51, v55 row_ror:8 row_mask:0xf bank_mask:0xc
  v_mov_b32_dpp v52, v4 row_ror:8 row_mask:0xf bank_mask:0x3
  v_mov_b32_dpp v53, v5 row_ror:8 row_mask:0xf bank_mask:0x3
  v_mov_b32_dpp v54, v6 row_ror:8 row_mask:0xf bank_mask:0x3
  v_mov_b32_dpp v55, v7 row_ror:8 row_mask:0xf bank_mask:0x3
  buffer_store_dwordx4 v[48:51], v0, s[24:27], s55 offen sc1
  buffer_store_dwordx4 v[52:55], v0, s[24:27], s58 offen sc1
  v_lshlrev_b32 v8, 16, v18
  v_and_b32 v9, 0xffff0000, v18
  v_lshlrev_b32 v10, 16, v19
  v_and_b32 v11, 0xffff0000, v19
  v_pk_add_f32 v[68:69], v[68:69], v[8:9]
  v_pk_add_f32 v[70:71], v[70:71], v[10:11]
  v_lshlrev_b32 v12, 16, v26
  v_and_b32 v13, 0xffff0000, v26
  v_lshlrev_b32 v14, 16, v27
  v_and_b32 v15, 0xffff0000, v27
  v_pk_add_f32 v[84:85], v[84:85], v[12:13]
  v_pk_add_f32 v[86:87], v[86:87], v[14:15]
  v_lshlrev_b32 v8, 16, v34
  v_and_b32 v9, 0xffff0000, v34
  v_lshlrev_b32 v10, 16, v35
  v_and_b32 v11, 0xffff0000, v35
  v_pk_add_f32 v[100:101], v[100:101], v[8:9]
  v_pk_add_f32 v[102:103], v[102:103], v[10:11]
  v_lshlrev_b32 v12, 16, v42
  v_and_b32 v13, 0xffff0000, v42
  v_lshlrev_b32 v14, 16, v43
  v_and_b32 v15, 0xffff0000, v43
  v_pk_add_f32 v[116:117], v[116:117], v[12:13]
  v_pk_add_f32 v[118:119], v[118:119], v[14:15]
  v_cvt_pk_bf16_f32 v56, v68, v69
  v_cvt_pk_bf16_f32 v57, v70, v71
  v_cvt_pk_bf16_f32 v58, v84, v85
  v_cvt_pk_bf16_f32 v59, v86, v87
  v_cvt_pk_bf16_f32 v60, v100, v101
  v_cvt_pk_bf16_f32 v61, v102, v103
  v_cvt_pk_bf16_f32 v62, v116, v117
  v_cvt_pk_bf16_f32 v63, v118, v119
  s_add_u32 s55, s54, 32768
  s_add_u32 s58, s54, 49152
  v_permlane16_swap_b32 v56, v58
  v_permlane16_swap_b32 v57, v59
  v_permlane16_swap_b32 v60, v62
  v_permlane16_swap_b32 v61, v63
  v_mov_b32 v4, v56
  v_mov_b32 v5, v57
  v_mov_b32 v6, v58
  v_mov_b32 v7, v59
  v_mov_b32_dpp v56, v60 row_ror:8 row_mask:0xf bank_mask:0xc
  v_mov_b32_dpp v57, v61 row_ror:8 row_mask:0xf bank_mask:0xc
  v_mov_b32_dpp v58, v62 row_ror:8 row_mask:0xf bank_mask:0xc
  v_mov_b32_dpp v59, v63 row_ror:8 row_mask:0xf bank_mask:0xc
  v_mov_b32_dpp v60, v4 row_ror:8 row_mask:0xf bank_mask:0x3
  v_mov_b32_dpp v61, v5 row_ror:8 row_mask:0xf bank_mask:0x3
  v_mov_b32_dpp v62, v6 row_ror:8 row_mask:0xf bank_mask:0x3
  v_mov_b32_dpp v63, v7 row_ror:8 row_mask:0xf bank_mask:0x3
  buffer_store_dwordx4 v[56:59], v0, s[24:27], s55 offen sc1
  buffer_store_dwordx4 v[60:63], v0, s[24:27], s58 offen sc1
  v_lshlrev_b32 v8, 16, v20
  v_and_b32 v9, 0xffff0000, v20
  v_lshlrev_b32 v10, 16, v21
  v_and_b32 v11, 0xffff0000, v21
  v_pk_add_f32 v[72:73], v[72:73], v[8:9]
  v_pk_add_f32 v[74:75], v[74:75], v[10:11]
  v_lshlrev_b32 v12, 16, v28
  v_and_b32 v13, 0xffff0000, v28
  v_lshlrev_b32 v14, 16, v29
  v_and_b32 v15, 0xffff0000, v29
  v_pk_add_f32 v[88:89], v[88:89], v[12:13]
  v_pk_add_f32 v[90:91], v[90:91], v[14:15]
  v_lshlrev_b32 v8, 16, v36
  v_and_b32 v9, 0xffff0000, v36
  v_lshlrev_b32 v10, 16, v37
  v_and_b32 v11, 0xffff0000, v37
  v_pk_add_f32 v[104:105], v[104:105], v[8:9]
  v_pk_add_f32 v[106:107], v[106:107], v[10:11]
  v_lshlrev_b32 v12, 16, v44
  v_and_b32 v13, 0xffff0000, v44
  v_lshlrev_b32 v14, 16, v45
  v_and_b32 v15, 0xffff0000, v45
  v_pk_add_f32 v[120:121], v[120:121], v[12:13]
  v_pk_add_f32 v[122:123], v[122:123], v[14:15]
  v_cvt_pk_bf16_f32 v48, v72, v73
  v_cvt_pk_bf16_f32 v49, v74, v75
  v_cvt_pk_bf16_f32 v50, v88, v89
  v_cvt_pk_bf16_f32 v51, v90, v91
  v_cvt_pk_bf16_f32 v52, v104, v105
  v_cvt_pk_bf16_f32 v53, v106, v107
  v_cvt_pk_bf16_f32 v54, v120, v121
  v_cvt_pk_bf16_f32 v55, v122, v123
  s_add_u32 s55, s54, 65536
  s_add_u32 s58, s54, 81920
  v_permlane16_swap_b32 v48, v50
  v_permlane16_swap_b32 v49, v51
  v_permlane16_swap_b32 v52, v54
  v_permlane16_swap_b32 v53, v55
  v_mov_b32 v4, v48
  v_mov_b32 v5, v49
  v_mov_b32 v6, v50
  v_mov_b32 v7, v51
  v_mov_b32_dpp v48, v52 row_ror:8 row_mask:0xf bank_mask:0xc
  v_mov_b32_dpp v49, v53 row_ror:8 row_mask:0xf bank_mask:0xc
  v_mov_b32_dpp v50, v54 row_ror:8 row_mask:0xf bank_mask:0xc
  v_mov_b32_dpp v51, v55 row_ror:8 row_mask:0xf bank_mask:0xc
  v_mov_b32_dpp v52, v4 row_ror:8 row_mask:0xf bank_mask:0x3
  v_mov_b32_dpp v53, v5 row_ror:8 row_mask:0xf bank_mask:0x3
  v_mov_b32_dpp v54, v6 row_ror:8 row_mask:0xf bank_mask:0x3
  v_mov_b32_dpp v55, v7 row_ror:8 row_mask:0xf bank_mask:0x3
  buffer_store_dwordx4 v[48:51], v0, s[24:27], s55 offen sc1
  buffer_store_dwordx4 v[52:55], v0, s[24:27], s58 offen sc1
  v_lshlrev_b32 v8, 16, v22
  v_and_b32 v9, 0xffff0000, v22
  v_lshlrev_b32 v10, 16, v23
  v_and_b32 v11, 0xffff0000, v23
  v_pk_add_f32 v[76:77], v[76:77], v[8:9]
  v_pk_add_f32 v[78:79], v[78:79], v[10:11]
  v_lshlrev_b32 v12, 16, v30
  v_and_b32 v13, 0xffff0000, v30
  v_lshlrev_b32 v14, 16, v31
  v_and_b32 v15, 0xffff0000, v31
  v_pk_add_f32 v[92:93], v[92:93], v[12:13]
  v_pk_add_f32 v[94:95], v[94:95], v[14:15]
  v_lshlrev_b32 v8, 16, v38
  v_and_b32 v9, 0xffff0000, v38
  v_lshlrev_b32 v10, 16, v39
  v_and_b32 v11, 0xffff0000, v39
  v_pk_add_f32 v[108:109], v[108:109], v[8:9]
  v_pk_add_f32 v[110:111], v[110:111], v[10:11]
  v_lshlrev_b32 v12, 16, v46
  v_and_b32 v13, 0xffff0000, v46
  v_lshlrev_b32 v14, 16, v47
  v_and_b32 v15, 0xffff0000, v47
  v_pk_add_f32 v[124:125], v[124:125], v[12:13]
  v_pk_add_f32 v[126:127], v[126:127], v[14:15]
  v_cvt_pk_bf16_f32 v56, v76, v77
  v_cvt_pk_bf16_f32 v57, v78, v79
  v_cvt_pk_bf16_f32 v58, v92, v93
  v_cvt_pk_bf16_f32 v59, v94, v95
  v_cvt_pk_bf16_f32 v60, v108, v109
  v_cvt_pk_bf16_f32 v61, v110, v111
  v_cvt_pk_bf16_f32 v62, v124, v125
  v_cvt_pk_bf16_f32 v63, v126, v127
  s_add_u32 s55, s54, 98304
  s_add_u32 s58, s54, 114688
  v_permlane16_swap_b32 v56, v58
  v_permlane16_swap_b32 v57, v59
  v_permlane16_swap_b32 v60, v62
  v_permlane16_swap_b32 v61, v63
  v_mov_b32 v4, v56
  v_mov_b32 v5, v57
  v_mov_b32 v6, v58
  v_mov_b32 v7, v59
  v_mov_b32_dpp v56, v60 row_ror:8 row_mask:0xf bank_mask:0xc
  v_mov_b32_dpp v57, v61 row_ror:8 row_mask:0xf bank_mask:0xc
  v_mov_b32_dpp v58, v62 row_ror:8 row_mask:0xf bank_mask:0xc
  v_mov_b32_dpp v59, v63 row_ror:8 row_mask:0xf bank_mask:0xc
  v_mov_b32_dpp v60, v4 row_ror:8 row_mask:0xf bank_mask:0x3
  v_mov_b32_dpp v61, v5 row_ror:8 row_mask:0xf bank_mask:0x3
  v_mov_b32_dpp v62, v6 row_ror:8 row_mask:0xf bank_mask:0x3
  v_mov_b32_dpp v63, v7 row_ror:8 row_mask:0xf bank_mask:0x3
  buffer_store_dwordx4 v[56:59], v0, s[24:27], s55 offen sc1
  buffer_store_dwordx4 v[60:63], v0, s[24:27], s58 offen sc1
  s_endpgm
L_kvw:
  v_bfe_u32 v16, v2, 2, 2
  v_lshrrev_b32 v17, 4, v2
  v_lshl_add_u32 v16, v17, 3, v16
  v_lshlrev_b32 v16, 6, v16
  v_and_b32 v17, 3, v2
  v_lshl_add_u32 v16, v17, 3, v16
  v_add_u32 v14, 8192, v16
  v_mov_b32 v64, 0
  v_mov_b32 v65, 0
  v_mov_b32 v66, 0
  v_mov_b32 v67, 0
  v_mov_b32 v68, 0
  v_mov_b32 v69, 0
  v_mov_b32 v70, 0
  v_mov_b32 v71, 0
  v_mov_b32 v72, 0
  v_mov_b32 v73, 0
  v_mov_b32 v74, 0
  v_mov_b32 v75, 0
  v_mov_b32 v76, 0
  v_mov_b32 v77, 0
  v_mov_b32 v78, 0
  v_mov_b32 v79, 0
  v_mov_b32 v80, 0
  v_mov_b32 v81, 0
  v_mov_b32 v82, 0
  v_mov_b32 v83, 0
  v_mov_b32 v84, 0
  v_mov_b32 v85, 0
  v_mov_b32 v86, 0
  v_mov_b32 v87, 0
  v_mov_b32 v88, 0
  v_mov_b32 v89, 0
  v_mov_b32 v90, 0
  v_mov_b32 v91, 0
  v_mov_b32 v92, 0
  v_mov_b32 v93, 0
  v_mov_b32 v94, 0
  v_mov_b32 v95, 0
  v_mov_b32 v112, 0
  v_mov_b32 v113, 0
  v_mov_b32 v114, 0
  v_mov_b32 v115, 0
  v_mov_b32 v116, 0
  v_mov_b32 v117, 0
  v_mov_b32 v118, 0
  v_mov_b32 v119, 0
  v_mov_b32 v120, 0
  v_mov_b32 v121, 0
  v_mov_b32 v122, 0
  v_mov_b32 v123, 0
  v_mov_b32 v124, 0
  v_mov_b32 v125, 0
  v_mov_b32 v126, 0
  v_mov_b32 v127, 0
  s_load_dwordx2 s[28:29], s[0:1], 64
  s_load_dwordx2 s[30:31], s[0:1], 32
  s_lshl_b32 s46, s43, 2
  s_add_u32 s46, s46, s51
  s_lshl_b32 s46, s46, 11
  s_add_u32 s46, s46, 4259840
  s_waitcnt lgkmcnt(0)
  s_mov_b32 s16, s38
  s_mov_b32 s17, s39
  s_mov_b32 s18, 8388608
  s_mov_b32 s19, 0x00020000
  s_add_u32 s20, s38, 25165824
  s_addc_u32 s21, s39, 0
  s_mov_b32 s22, 4194304
  s_mov_b32 s23, 0x00020000
  s_and_b32 s60, s40, 1
  s_cmp_eq_u32 s60, 0
  s_cbranch_scc0 L_vw
  v_bfe_u32 v16, v2, 3, 1
  v_lshl_add_u32 v15, v16, 8, v0
  v_and_b32 v16, 7, v2
  v_lshl_add_u32 v15, v16, 4, v15
  s_mov_b32 s47, 0x3e8293ee
  s_barrier
  ds_read_b128 v[48:51], v12 offset:0
  ds_read_b128 v[52:55], v13 offset:0
  ds_read_b128 v[56:59], v12 offset:2048
  ds_read_b128 v[60:63], v13 offset:2048
  ds_read_b64_tr_b16 v[16:17], v14 offset:0
  ds_read_b64_tr_b16 v[18:19], v14 offset:256
  ds_read_b64_tr_b16 v[20:21], v14 offset:2048
  ds_read_b64_tr_b16 v[22:23], v14 offset:2304
  ds_read_b64_tr_b16 v[24:25], v14 offset:32
  ds_read_b64_tr_b16 v[26:27], v14 offset:288
  ds_read_b64_tr_b16 v[28:29], v14 offset:2080
  ds_read_b64_tr_b16 v[30:31], v14 offset:2336
  s_waitcnt lgkmcnt(0)
  s_mov_b32 s50, 3
.p2align 6
Lk_LQ:
  s_waitcnt lgkmcnt(6)
  v_mfma_f32_16x16x32_bf16 v[112:115], v[16:19], v[48:51], v[112:115]
  s_waitcnt lgkmcnt(4)
  v_mfma_f32_16x16x32_bf16 v[112:115], v[20:23], v[52:55], v[112:115]
  v_mfma_f32_16x16x32_bf16 v[116:119], v[16:19], v[56:59], v[116:119]
  v_mfma_f32_16x16x32_bf16 v[116:119], v[20:23], v[60:63], v[116:119]
  s_waitcnt lgkmcnt(0)
  s_barrier
  v_mfma_f32_16x16x32_bf16 v[120:123], v[24:27], v[48:51], v[120:123]
  ds_read_b128 v[96:99], v12 offset:16384
  ds_read_b128 v[100:103], v13 offset:16384
  v_mfma_f32_16x16x32_bf16 v[120:123], v[28:31], v[52:55], v[120:123]
  ds_read_b128 v[104:107], v12 offset:18432
  ds_read_b128 v[108:111], v13 offset:18432
  v_mfma_f32_16x16x32_bf16 v[124:127], v[24:27], v[56:59], v[124:127]
  ds_read_b64_tr_b16 v[16:17], v14 offset:16384
  ds_read_b64_tr_b16 v[18:19], v14 offset:16640
  v_mfma_f32_16x16x32_bf16 v[124:127], v[28:31], v[60:63], v[124:127]
  ds_read_b64_tr_b16 v[20:21], v14 offset:18432
  ds_read_b64_tr_b16 v[22:23], v14 offset:18688
  ds_read_b64_tr_b16 v[24:25], v14 offset:16416
  ds_read_b64_tr_b16 v[26:27], v14 offset:16672
  ds_read_b64_tr_b16 v[28:29], v14 offset:18464
  ds_read_b64_tr_b16 v[30:31], v14 offset:18720
  s_waitcnt lgkmcnt(6)
  v_mfma_f32_16x16x32_bf16 v[112:115], v[16:19], v[96:99], v[112:115]
  s_waitcnt lgkmcnt(4)
  v_mfma_f32_16x16x32_bf16 v[112:115], v[20:23], v[100:103], v[112:115]
  v_mfma_f32_16x16x32_bf16 v[116:119], v[16:19], v[104:107], v[116:119]
  v_mfma_f32_16x16x32_bf16 v[116:119], v[20:23], v[108:111], v[116:119]
  s_waitcnt lgkmcnt(0)
  s_barrier
  v_mfma_f32_16x16x32_bf16 v[120:123], v[24:27], v[96:99], v[120:123]
  ds_read_b128 v[48:51], v12 offset:32768
  ds_read_b128 v[52:55], v13 offset:32768
  v_mfma_f32_16x16x32_bf16 v[120:123], v[28:31], v[100:103], v[120:123]
  ds_read_b128 v[56:59], v12 offset:34816
  ds_read_b128 v[60:63], v13 offset:34816
  v_mfma_f32_16x16x32_bf16 v[124:127], v[24:27], v[104:107], v[124:127]
  ds_read_b64_tr_b16 v[16:17], v14 offset:32768
  ds_read_b64_tr_b16 v[18:19], v14 offset:33024
  v_mfma_f32_16x16x32_bf16 v[124:127], v[28:31], v[108:111], v[124:127]
  ds_read_b64_tr_b16 v[20:21], v14 offset:34816
  ds_read_b64_tr_b16 v[22:23], v14 offset:35072
  ds_read_b64_tr_b16 v[24:25], v14 offset:32800
  ds_read_b64_tr_b16 v[26:27], v14 offset:33056
  ds_read_b64_tr_b16 v[28:29], v14 offset:34848
  ds_read_b64_tr_b16 v[30:31], v14 offset:35104
  s_waitcnt lgkmcnt(6)
  v_mfma_f32_16x16x32_bf16 v[112:115], v[16:19], v[48:51], v[112:115]
  s_waitcnt lgkmcnt(4)
  v_mfma_f32_16x16x32_bf16 v[112:115], v[20:23], v[52:55], v[112:115]
  v_mfma_f32_16x16x32_bf16 v[116:119], v[16:19], v[56:59], v[116:119]
  v_mfma_f32_16x16x32_bf16 v[116:119], v[20:23], v[60:63], v[116:119]
  s_waitcnt lgkmcnt(0)
  s_barrier
  v_mfma_f32_16x16x32_bf16 v[120:123], v[24:27], v[48:51], v[120:123]
  ds_read_b128 v[96:99], v12 offset:49152
  ds_read_b128 v[100:103], v13 offset:49152
  v_mfma_f32_16x16x32_bf16 v[120:123], v[28:31], v[52:55], v[120:123]
  ds_read_b128 v[104:107], v12 offset:51200
  ds_read_b128 v[108:111], v13 offset:51200
  v_mfma_f32_16x16x32_bf16 v[124:127], v[24:27], v[56:59], v[124:127]
  ds_read_b64_tr_b16 v[16:17], v14 offset:49152
  ds_read_b64_tr_b16 v[18:19], v14 offset:49408
  v_mfma_f32_16x16x32_bf16 v[124:127], v[28:31], v[60:63], v[124:127]
  ds_read_b64_tr_b16 v[20:21], v14 offset:51200
  ds_read_b64_tr_b16 v[22:23], v14 offset:51456
  ds_read_b64_tr_b16 v[24:25], v14 offset:49184
  ds_read_b64_tr_b16 v[26:27], v14 offset:49440
  ds_read_b64_tr_b16 v[28:29], v14 offset:51232
  ds_read_b64_tr_b16 v[30:31], v14 offset:51488
  s_waitcnt lgkmcnt(6)
  v_mfma_f32_16x16x32_bf16 v[112:115], v[16:19], v[96:99], v[112:115]
  s_waitcnt lgkmcnt(4)
  v_mfma_f32_16x16x32_bf16 v[112:115], v[20:23], v[100:103], v[112:115]
  v_mfma_f32_16x16x32_bf16 v[116:119], v[16:19], v[104:107], v[116:119]
  v_mfma_f32_16x16x32_bf16 v[116:119], v[20:23], v[108:111], v[116:119]
  s_waitcnt lgkmcnt(0)
  s_barrier
  v_mfma_f32_16x16x32_bf16 v[120:123], v[24:27], v[96:99], v[120:123]
  ds_read_b128 v[48:51], v12 offset:0
  ds_read_b128 v[52:55], v13 offset:0
  v_mfma_f32_16x16x32_bf16 v[120:123], v[28:31], v[100:103], v[120:123]
  ds_read_b128 v[56:59], v12 offset:2048
  ds_read_b128 v[60:63], v13 offset:2048
  v_mfma_f32_16x16x32_bf16 v[124:127], v[24:27], v[104:107], v[124:127]
  ds_read_b64_tr_b16 v[16:17], v14 offset:0
  ds_read_b64_tr_b16 v[18:19], v14 offset:256
  v_mfma_f32_16x16x32_bf16 v[124:127], v[28:31], v[108:111], v[124:127]
  ds_read_b64_tr_b16 v[20:21], v14 offset:2048
  ds_read_b64_tr_b16 v[22:23], v14 offset:2304
  s_sub_u32 s50, s50, 1
  s_cmp_lg_u32 s50, 0
  ds_read_b64_tr_b16 v[24:25], v14 offset:32
  ds_read_b64_tr_b16 v[26:27], v14 offset:288
  ds_read_b64_tr_b16 v[28:29], v14 offset:2080
  ds_read_b64_tr_b16 v[30:31], v14 offset:2336
  s_cbranch_scc1 Lk_LQ
  s_waitcnt lgkmcnt(6)
  v_mfma_f32_16x16x32_bf16 v[112:115], v[16:19], v[48:51], v[112:115]
  s_waitcnt lgkmcnt(4)
  v_mfma_f32_16x16x32_bf16 v[112:115], v[20:23], v[52:55], v[112:115]
  v_mfma_f32_16x16x32_bf16 v[116:119], v[16:19], v[56:59], v[116:119]
  v_mfma_f32_16x16x32_bf16 v[116:119], v[20:23], v[60:63], v[116:119]
  s_waitcnt lgkmcnt(0)
  s_barrier
  v_mfma_f32_16x16x32_bf16 v[120:123], v[24:27], v[48:51], v[120:123]
  ds_read_b128 v[96:99], v12 offset:16384
  ds_read_b128 v[100:103], v13 offset:16384
  v_mfma_f32_16x16x32_bf16 v[120:123], v[28:31], v[52:55], v[120:123]
  ds_read_b128 v[104:107], v12 offset:18432
  ds_read_b128 v[108:111], v13 offset:18432
  v_mfma_f32_16x16x32_bf16 v[124:127], v[24:27], v[56:59], v[124:127]
  ds_read_b64_tr_b16 v[16:17], v14 offset:16384
  ds_read_b64_tr_b16 v[18:19], v14 offset:16640
  v_mfma_f32_16x16x32_bf16 v[124:127], v[28:31], v[60:63], v[124:127]
  ds_read_b64_tr_b16 v[20:21], v14 offset:18432
  ds_read_b64_tr_b16 v[22:23], v14 offset:18688
  ds_read_b64_tr_b16 v[24:25], v14 offset:16416
  ds_read_b64_tr_b16 v[26:27], v14 offset:16672
  ds_read_b64_tr_b16 v[28:29], v14 offset:18464
  ds_read_b64_tr_b16 v[30:31], v14 offset:18720
  s_waitcnt lgkmcnt(6)
  v_mfma_f32_16x16x32_bf16 v[112:115], v[16:19], v[96:99], v[112:115]
  s_waitcnt lgkmcnt(4)
  v_mfma_f32_16x16x32_bf16 v[112:115], v[20:23], v[100:103], v[112:115]
  v_mfma_f32_16x16x32_bf16 v[116:119], v[16:19], v[104:107], v[116:119]
  v_mfma_f32_16x16x32_bf16 v[116:119], v[20:23], v[108:111], v[116:119]
  s_waitcnt lgkmcnt(0)
  s_barrier
  v_mfma_f32_16x16x32_bf16 v[120:123], v[24:27], v[96:99], v[120:123]
  ds_read_b128 v[48:51], v12 offset:32768
  ds_read_b128 v[52:55], v13 offset:32768
  v_mfma_f32_16x16x32_bf16 v[120:123], v[28:31], v[100:103], v[120:123]
  ds_read_b128 v[56:59], v12 offset:34816
  ds_read_b128 v[60:63], v13 offset:34816
  v_mfma_f32_16x16x32_bf16 v[124:127], v[24:27], v[104:107], v[124:127]
  ds_read_b64_tr_b16 v[16:17], v14 offset:32768
  ds_read_b64_tr_b16 v[18:19], v14 offset:33024
  v_mfma_f32_16x16x32_bf16 v[124:127], v[28:31], v[108:111], v[124:127]
  ds_read_b64_tr_b16 v[20:21], v14 offset:34816
  ds_read_b64_tr_b16 v[22:23], v14 offset:35072
  ds_read_b64_tr_b16 v[24:25], v14 offset:32800
  ds_read_b64_tr_b16 v[26:27], v14 offset:33056
  ds_read_b64_tr_b16 v[28:29], v14 offset:34848
  ds_read_b64_tr_b16 v[30:31], v14 offset:35104
  s_waitcnt lgkmcnt(6)
  v_mfma_f32_16x16x32_bf16 v[112:115], v[16:19], v[48:51], v[112:115]
  s_waitcnt lgkmcnt(4)
  v_mfma_f32_16x16x32_bf16 v[112:115], v[20:23], v[52:55], v[112:115]
  v_mfma_f32_16x16x32_bf16 v[116:119], v[16:19], v[56:59], v[116:119]
  v_mfma_f32_16x16x32_bf16 v[116:119], v[20:23], v[60:63], v[116:119]
  s_waitcnt lgkmcnt(0)
  s_barrier
  v_mfma_f32_16x16x32_bf16 v[120:123], v[24:27], v[48:51], v[120:123]
  ds_read_b128 v[96:99], v12 offset:49152
  ds_read_b128 v[100:103], v13 offset:49152
  v_mfma_f32_16x16x32_bf16 v[120:123], v[28:31], v[52:55], v[120:123]
  ds_read_b128 v[104:107], v12 offset:51200
  ds_read_b128 v[108:111], v13 offset:51200
  v_mfma_f32_16x16x32_bf16 v[124:127], v[24:27], v[56:59], v[124:127]
  ds_read_b64_tr_b16 v[16:17], v14 offset:49152
  ds_read_b64_tr_b16 v[18:19], v14 offset:49408
  v_mfma_f32_16x16x32_bf16 v[124:127], v[28:31], v[60:63], v[124:127]
  ds_read_b64_tr_b16 v[20:21], v14 offset:51200
  ds_read_b64_tr_b16 v[22:23], v14 offset:51456
  ds_read_b64_tr_b16 v[24:25], v14 offset:49184
  ds_read_b64_tr_b16 v[26:27], v14 offset:49440
  ds_read_b64_tr_b16 v[28:29], v14 offset:51232
  ds_read_b64_tr_b16 v[30:31], v14 offset:51488
  s_waitcnt lgkmcnt(6)
  v_mfma_f32_16x16x32_bf16 v[112:115], v[16:19], v[96:99], v[112:115]
  s_waitcnt lgkmcnt(4)
  v_mfma_f32_16x16x32_bf16 v[112:115], v[20:23], v[100:103], v[112:115]
  v_mfma_f32_16x16x32_bf16 v[116:119], v[16:19], v[104:107], v[116:119]
  v_mfma_f32_16x16x32_bf16 v[116:119], v[20:23], v[108:111], v[116:119]
  s_waitcnt lgkmcnt(0)
  s_barrier
  v_mfma_f32_16x16x32_bf16 v[120:123], v[24:27], v[96:99], v[120:123]
  v_mfma_f32_16x16x32_bf16 v[120:123], v[28:31], v[100:103], v[120:123]
  v_mfma_f32_16x16x32_bf16 v[124:127], v[24:27], v[104:107], v[124:127]
  v_mfma_f32_16x16x32_bf16 v[124:127], v[28:31], v[108:111], v[124:127]
  s_nop 7
  v_mul_f32 v112, s47, v112
  v_mul_f32 v113, s47, v113
  v_mul_f32 v114, s47, v114
  v_mul_f32 v115, s47, v115
  v_mul_f32 v116, s47, v116
  v_mul_f32 v117, s47, v117
  v_mul_f32 v118, s47, v118
  v_mul_f32 v119, s47, v119
  v_mul_f32 v120, s47, v120
  v_mul_f32 v121, s47, v121
  v_mul_f32 v122, s47, v122
  v_mul_f32 v123, s47, v123
  v_mul_f32 v124, s47, v124
  v_mul_f32 v125, s47, v125
  v_mul_f32 v126, s47, v126
  v_mul_f32 v127, s47, v127
  v_cvt_pk_bf16_f32 v40, v112, v113
  v_cvt_pk_bf16_f32 v41, v114, v115
  v_cvt_pk_bf16_f32 v42, v120, v121
  v_cvt_pk_bf16_f32 v43, v122, v123
  buffer_store_dwordx4 v[40:43], v15, s[16:19], s46 offen offset:0 sc1
  v_cvt_pk_bf16_f32 v44, v116, v117
  v_cvt_pk_bf16_f32 v45, v118, v119
  v_cvt_pk_bf16_f32 v46, v124, v125
  v_cvt_pk_bf16_f32 v47, v126, v127
  buffer_store_dwordx4 v[44:47], v15, s[16:19], s46 offen offset:128 sc1
  s_branch L_kvd
L_vw:
  s_add_u32 s46, s46, 131072
  s_barrier
  ds_read_b128 v[48:51], v12 offset:0
  ds_read_b128 v[52:55], v13 offset:0
  ds_read_b128 v[56:59], v12 offset:2048
  ds_read_b128 v[60:63], v13 offset:2048
  ds_read_b64_tr_b16 v[16:17], v14 offset:0
  ds_read_b64_tr_b16 v[18:19], v14 offset:256
  ds_read_b64_tr_b16 v[20:21], v14 offset:2048
  ds_read_b64_tr_b16 v[22:23], v14 offset:2304
  ds_read_b64_tr_b16 v[24:25], v14 offset:32
  ds_read_b64_tr_b16 v[26:27], v14 offset:288
  ds_read_b64_tr_b16 v[28:29], v14 offset:2080
  ds_read_b64_tr_b16 v[30:31], v14 offset:2336
  s_waitcnt lgkmcnt(0)
  s_mov_b32 s50, 3
.p2align 6
Lv_LQ:
  s_waitcnt lgkmcnt(6)
  v_mfma_f32_16x16x32_bf16 v[112:115], v[48:51], v[16:19], v[112:115]
  s_waitcnt lgkmcnt(4)
  v_mfma_f32_16x16x32_bf16 v[112:115], v[52:55], v[20:23], v[112:115]
  v_mfma_f32_16x16x32_bf16 v[116:119], v[56:59], v[16:19], v[116:119]
  v_mfma_f32_16x16x32_bf16 v[116:119], v[60:63], v[20:23], v[116:119]
  s_waitcnt lgkmcnt(0)
  s_barrier
  v_mfma_f32_16x16x32_bf16 v[120:123], v[48:51], v[24:27], v[120:123]
  ds_read_b128 v[96:99], v12 offset:16384
  ds_read_b128 v[100:103], v13 offset:16384
  v_mfma_f32_16x16x32_bf16 v[120:123], v[52:55], v[28:31], v[120:123]
  ds_read_b128 v[104:107], v12 offset:18432
  ds_read_b128 v[108:111], v13 offset:18432
  v_mfma_f32_16x16x32_bf16 v[124:127], v[56:59], v[24:27], v[124:127]
  ds_read_b64_tr_b16 v[16:17], v14 offset:16384
  ds_read_b64_tr_b16 v[18:19], v14 offset:16640
  v_mfma_f32_16x16x32_bf16 v[124:127], v[60:63], v[28:31], v[124:127]
  ds_read_b64_tr_b16 v[20:21], v14 offset:18432
  ds_read_b64_tr_b16 v[22:23], v14 offset:18688
  ds_read_b64_tr_b16 v[24:25], v14 offset:16416
  ds_read_b64_tr_b16 v[26:27], v14 offset:16672
  ds_read_b64_tr_b16 v[28:29], v14 offset:18464
  ds_read_b64_tr_b16 v[30:31], v14 offset:18720
  s_waitcnt lgkmcnt(6)
  v_mfma_f32_16x16x32_bf16 v[112:115], v[96:99], v[16:19], v[112:115]
  s_waitcnt lgkmcnt(4)
  v_mfma_f32_16x16x32_bf16 v[112:115], v[100:103], v[20:23], v[112:115]
  v_mfma_f32_16x16x32_bf16 v[116:119], v[104:107], v[16:19], v[116:119]
  v_mfma_f32_16x16x32_bf16 v[116:119], v[108:111], v[20:23], v[116:119]
  s_waitcnt lgkmcnt(0)
  s_barrier
  v_mfma_f32_16x16x32_bf16 v[120:123], v[96:99], v[24:27], v[120:123]
  ds_read_b128 v[48:51], v12 offset:32768
  ds_read_b128 v[52:55], v13 offset:32768
  v_mfma_f32_16x16x32_bf16 v[120:123], v[100:103], v[28:31], v[120:123]
  ds_read_b128 v[56:59], v12 offset:34816
  ds_read_b128 v[60:63], v13 offset:34816
  v_mfma_f32_16x16x32_bf16 v[124:127], v[104:107], v[24:27], v[124:127]
  ds_read_b64_tr_b16 v[16:17], v14 offset:32768
  ds_read_b64_tr_b16 v[18:19], v14 offset:33024
  v_mfma_f32_16x16x32_bf16 v[124:127], v[108:111], v[28:31], v[124:127]
  ds_read_b64_tr_b16 v[20:21], v14 offset:34816
  ds_read_b64_tr_b16 v[22:23], v14 offset:35072
  ds_read_b64_tr_b16 v[24:25], v14 offset:32800
  ds_read_b64_tr_b16 v[26:27], v14 offset:33056
  ds_read_b64_tr_b16 v[28:29], v14 offset:34848
  ds_read_b64_tr_b16 v[30:31], v14 offset:35104
  s_waitcnt lgkmcnt(6)
  v_mfma_f32_16x16x32_bf16 v[112:115], v[48:51], v[16:19], v[112:115]
  s_waitcnt lgkmcnt(4)
  v_mfma_f32_16x16x32_bf16 v[112:115], v[52:55], v[20:23], v[112:115]
  v_mfma_f32_16x16x32_bf16 v[116:119], v[56:59], v[16:19], v[116:119]
  v_mfma_f32_16x16x32_bf16 v[116:119], v[60:63], v[20:23], v[116:119]
  s_waitcnt lgkmcnt(0)
  s_barrier
  v_mfma_f32_16x16x32_bf16 v[120:123], v[48:51], v[24:27], v[120:123]
  ds_read_b128 v[96:99], v12 offset:49152
  ds_read_b128 v[100:103], v13 offset:49152
  v_mfma_f32_16x16x32_bf16 v[120:123], v[52:55], v[28:31], v[120:123]
  ds_read_b128 v[104:107], v12 offset:51200
  ds_read_b128 v[108:111], v13 offset:51200
  v_mfma_f32_16x16x32_bf16 v[124:127], v[56:59], v[24:27], v[124:127]
  ds_read_b64_tr_b16 v[16:17], v14 offset:49152
  ds_read_b64_tr_b16 v[18:19], v14 offset:49408
  v_mfma_f32_16x16x32_bf16 v[124:127], v[60:63], v[28:31], v[124:127]
  ds_read_b64_tr_b16 v[20:21], v14 offset:51200
  ds_read_b64_tr_b16 v[22:23], v14 offset:51456
  ds_read_b64_tr_b16 v[24:25], v14 offset:49184
  ds_read_b64_tr_b16 v[26:27], v14 offset:49440
  ds_read_b64_tr_b16 v[28:29], v14 offset:51232
  ds_read_b64_tr_b16 v[30:31], v14 offset:51488
  s_waitcnt lgkmcnt(6)
  v_mfma_f32_16x16x32_bf16 v[112:115], v[96:99], v[16:19], v[112:115]
  s_waitcnt lgkmcnt(4)
  v_mfma_f32_16x16x32_bf16 v[112:115], v[100:103], v[20:23], v[112:115]
  v_mfma_f32_16x16x32_bf16 v[116:119], v[104:107], v[16:19], v[116:119]
  v_mfma_f32_16x16x32_bf16 v[116:119], v[108:111], v[20:23], v[116:119]
  s_waitcnt lgkmcnt(0)
  s_barrier
  v_mfma_f32_16x16x32_bf16 v[120:123], v[96:99], v[24:27], v[120:123]
  ds_read_b128 v[48:51], v12 offset:0
  ds_read_b128 v[52:55], v13 offset:0
  v_mfma_f32_16x16x32_bf16 v[120:123], v[100:103], v[28:31], v[120:123]
  ds_read_b128 v[56:59], v12 offset:2048
  ds_read_b128 v[60:63], v13 offset:2048
  v_mfma_f32_16x16x32_bf16 v[124:127], v[104:107], v[24:27], v[124:127]
  ds_read_b64_tr_b16 v[16:17], v14 offset:0
  ds_read_b64_tr_b16 v[18:19], v14 offset:256
  v_mfma_f32_16x16x32_bf16 v[124:127], v[108:111], v[28:31], v[124:127]
  ds_read_b64_tr_b16 v[20:21], v14 offset:2048
  ds_read_b64_tr_b16 v[22:23], v14 offset:2304
  s_sub_u32 s50, s50, 1
  s_cmp_lg_u32 s50, 0
  ds_read_b64_tr_b16 v[24:25], v14 offset:32
  ds_read_b64_tr_b16 v[26:27], v14 offset:288
  ds_read_b64_tr_b16 v[28:29], v14 offset:2080
  ds_read_b64_tr_b16 v[30:31], v14 offset:2336
  s_cbranch_scc1 Lv_LQ
  s_waitcnt lgkmcnt(6)
  v_mfma_f32_16x16x32_bf16 v[112:115], v[48:51], v[16:19], v[112:115]
  s_waitcnt lgkmcnt(4)
  v_mfma_f32_16x16x32_bf16 v[112:115], v[52:55], v[20:23], v[112:115]
  v_mfma_f32_16x16x32_bf16 v[116:119], v[56:59], v[16:19], v[116:119]
  v_mfma_f32_16x16x32_bf16 v[116:119], v[60:63], v[20:23], v[116:119]
  s_waitcnt lgkmcnt(0)
  s_barrier
  v_mfma_f32_16x16x32_bf16 v[120:123], v[48:51], v[24:27], v[120:123]
  ds_read_b128 v[96:99], v12 offset:16384
  ds_read_b128 v[100:103], v13 offset:16384
  v_mfma_f32_16x16x32_bf16 v[120:123], v[52:55], v[28:31], v[120:123]
  ds_read_b128 v[104:107], v12 offset:18432
  ds_read_b128 v[108:111], v13 offset:18432
  v_mfma_f32_16x16x32_bf16 v[124:127], v[56:59], v[24:27], v[124:127]
  ds_read_b64_tr_b16 v[16:17], v14 offset:16384
  ds_read_b64_tr_b16 v[18:19], v14 offset:16640
  v_mfma_f32_16x16x32_bf16 v[124:127], v[60:63], v[28:31], v[124:127]
  ds_read_b64_tr_b16 v[20:21], v14 offset:18432
  ds_read_b64_tr_b16 v[22:23], v14 offset:18688
  ds_read_b64_tr_b16 v[24:25], v14 offset:16416
  ds_read_b64_tr_b16 v[26:27], v14 offset:16672
  ds_read_b64_tr_b16 v[28:29], v14 offset:18464
  ds_read_b64_tr_b16 v[30:31], v14 offset:18720
  s_waitcnt lgkmcnt(6)
  v_mfma_f32_16x16x32_bf16 v[112:115], v[96:99], v[16:19], v[112:115]
  s_waitcnt lgkmcnt(4)
  v_mfma_f32_16x16x32_bf16 v[112:115], v[100:103], v[20:23], v[112:115]
  v_mfma_f32_16x16x32_bf16 v[116:119], v[104:107], v[16:19], v[116:119]
  v_mfma_f32_16x16x32_bf16 v[116:119], v[108:111], v[20:23], v[116:119]
  s_waitcnt lgkmcnt(0)
  s_barrier
  v_mfma_f32_16x16x32_bf16 v[120:123], v[96:99], v[24:27], v[120:123]
  ds_read_b128 v[48:51], v12 offset:32768
  ds_read_b128 v[52:55], v13 offset:32768
  v_mfma_f32_16x16x32_bf16 v[120:123], v[100:103], v[28:31], v[120:123]
  ds_read_b128 v[56:59], v12 offset:34816
  ds_read_b128 v[60:63], v13 offset:34816
  v_mfma_f32_16x16x32_bf16 v[124:127], v[104:107], v[24:27], v[124:127]
  ds_read_b64_tr_b16 v[16:17], v14 offset:32768
  ds_read_b64_tr_b16 v[18:19], v14 offset:33024
  v_mfma_f32_16x16x32_bf16 v[124:127], v[108:111], v[28:31], v[124:127]
  ds_read_b64_tr_b16 v[20:21], v14 offset:34816
  ds_read_b64_tr_b16 v[22:23], v14 offset:35072
  ds_read_b64_tr_b16 v[24:25], v14 offset:32800
  ds_read_b64_tr_b16 v[26:27], v14 offset:33056
  ds_read_b64_tr_b16 v[28:29], v14 offset:34848
  ds_read_b64_tr_b16 v[30:31], v14 offset:35104
  s_waitcnt lgkmcnt(6)
  v_mfma_f32_16x16x32_bf16 v[112:115], v[48:51], v[16:19], v[112:115]
  s_waitcnt lgkmcnt(4)
  v_mfma_f32_16x16x32_bf16 v[112:115], v[52:55], v[20:23], v[112:115]
  v_mfma_f32_16x16x32_bf16 v[116:119], v[56:59], v[16:19], v[116:119]
  v_mfma_f32_16x16x32_bf16 v[116:119], v[60:63], v[20:23], v[116:119]
  s_waitcnt lgkmcnt(0)
  s_barrier
  v_mfma_f32_16x16x32_bf16 v[120:123], v[48:51], v[24:27], v[120:123]
  ds_read_b128 v[96:99], v12 offset:49152
  ds_read_b128 v[100:103], v13 offset:49152
  v_mfma_f32_16x16x32_bf16 v[120:123], v[52:55], v[28:31], v[120:123]
  ds_read_b128 v[104:107], v12 offset:51200
  ds_read_b128 v[108:111], v13 offset:51200
  v_mfma_f32_16x16x32_bf16 v[124:127], v[56:59], v[24:27], v[124:127]
  ds_read_b64_tr_b16 v[16:17], v14 offset:49152
  ds_read_b64_tr_b16 v[18:19], v14 offset:49408
  v_mfma_f32_16x16x32_bf16 v[124:127], v[60:63], v[28:31], v[124:127]
  ds_read_b64_tr_b16 v[20:21], v14 offset:51200
  ds_read_b64_tr_b16 v[22:23], v14 offset:51456
  ds_read_b64_tr_b16 v[24:25], v14 offset:49184
  ds_read_b64_tr_b16 v[26:27], v14 offset:49440
  ds_read_b64_tr_b16 v[28:29], v14 offset:51232
  ds_read_b64_tr_b16 v[30:31], v14 offset:51488
  s_waitcnt lgkmcnt(6)
  v_mfma_f32_16x16x32_bf16 v[112:115], v[96:99], v[16:19], v[112:115]
  s_waitcnt lgkmcnt(4)
  v_mfma_f32_16x16x32_bf16 v[112:115], v[100:103], v[20:23], v[112:115]
  v_mfma_f32_16x16x32_bf16 v[116:119], v[104:107], v[16:19], v[116:119]
  v_mfma_f32_16x16x32_bf16 v[116:119], v[108:111], v[20:23], v[116:119]
  s_waitcnt lgkmcnt(0)
  s_barrier
  v_mfma_f32_16x16x32_bf16 v[120:123], v[96:99], v[24:27], v[120:123]
  v_mfma_f32_16x16x32_bf16 v[120:123], v[100:103], v[28:31], v[120:123]
  v_mfma_f32_16x16x32_bf16 v[124:127], v[104:107], v[24:27], v[124:127]
  v_mfma_f32_16x16x32_bf16 v[124:127], v[108:111], v[28:31], v[124:127]
  s_nop 7
  v_cvt_pk_bf16_f32 v40, v112, v113
  v_cvt_pk_bf16_f32 v41, v114, v115
  v_cvt_pk_bf16_f32 v42, v116, v117
  v_cvt_pk_bf16_f32 v43, v118, v119
  buffer_store_dwordx4 v[40:43], v1, s[16:19], s46 offen offset:0 sc1
  v_cvt_pk_bf16_f32 v44, v120, v121
  v_cvt_pk_bf16_f32 v45, v122, v123
  v_cvt_pk_bf16_f32 v46, v124, v125
  v_cvt_pk_bf16_f32 v47, v126, v127
  buffer_store_dwordx4 v[44:47], v1, s[16:19], s46 offen offset:256 sc1
L_kvd:
  s_waitcnt vmcnt(0)
  s_barrier
  s_barrier
  s_barrier
  s_barrier
  ds_read_b128 v[48:51], v12 offset:0
  ds_read_b128 v[52:55], v13 offset:0
  ds_read_b128 v[56:59], v12 offset:2048
  ds_read_b128 v[60:63], v13 offset:2048
  ds_read_b64_tr_b16 v[16:17], v8 offset:0
  ds_read_b64_tr_b16 v[18:19], v8 offset:512
  ds_read_b64_tr_b16 v[20:21], v8 offset:4096
  ds_read_b64_tr_b16 v[22:23], v8 offset:4608
  ds_read_b64_tr_b16 v[24:25], v9 offset:0
  ds_read_b64_tr_b16 v[26:27], v9 offset:512
  ds_read_b64_tr_b16 v[28:29], v9 offset:4096
  ds_read_b64_tr_b16 v[30:31], v9 offset:4608
  ds_read_b64_tr_b16 v[32:33], v10 offset:0
  ds_read_b64_tr_b16 v[34:35], v10 offset:512
  ds_read_b64_tr_b16 v[36:37], v10 offset:4096
  ds_read_b64_tr_b16 v[38:39], v10 offset:4608
  ds_read_b64_tr_b16 v[40:41], v11 offset:0
  ds_read_b64_tr_b16 v[42:43], v11 offset:512
  ds_read_b64_tr_b16 v[44:45], v11 offset:4096
  ds_read_b64_tr_b16 v[46:47], v11 offset:4608
  s_waitcnt lgkmcnt(0)
  s_mov_b32 s50, 3
.p2align 6
Lq_LQ:
  s_waitcnt lgkmcnt(14)
  v_mfma_f32_16x16x32_bf16 v[64:67], v[16:19], v[48:51], v[64:67]
  s_waitcnt lgkmcnt(12)
  v_mfma_f32_16x16x32_bf16 v[64:67], v[20:23], v[52:55], v[64:67]
  v_mfma_f32_16x16x32_bf16 v[68:71], v[16:19], v[56:59], v[68:71]
  v_mfma_f32_16x16x32_bf16 v[68:71], v[20:23], v[60:63], v[68:71]
  s_waitcnt lgkmcnt(0)
  s_barrier
  v_mfma_f32_16x16x32_bf16 v[72:75], v[24:27], v[48:51], v[72:75]
  ds_read_b128 v[96:99], v12 offset:16384
  ds_read_b128 v[100:103], v13 offset:16384
  v_mfma_f32_16x16x32_bf16 v[72:75], v[28:31], v[52:55], v[72:75]
  ds_read_b128 v[104:107], v12 offset:18432
  ds_read_b128 v[108:111], v13 offset:18432
  v_mfma_f32_16x16x32_bf16 v[76:79], v[24:27], v[56:59], v[76:79]
  ds_read_b64_tr_b16 v[16:17], v8 offset:16384
  ds_read_b64_tr_b16 v[18:19], v8 offset:16896
  v_mfma_f32_16x16x32_bf16 v[76:79], v[28:31], v[60:63], v[76:79]
  ds_read_b64_tr_b16 v[20:21], v8 offset:20480
  ds_read_b64_tr_b16 v[22:23], v8 offset:20992
  v_mfma_f32_16x16x32_bf16 v[80:83], v[32:35], v[48:51], v[80:83]
  ds_read_b64_tr_b16 v[24:25], v9 offset:16384
  ds_read_b64_tr_b16 v[26:27], v9 offset:16896
  v_mfma_f32_16x16x32_bf16 v[80:83], v[36:39], v[52:55], v[80:83]
  ds_read_b64_tr_b16 v[28:29], v9 offset:20480
  ds_read_b64_tr_b16 v[30:31], v9 offset:20992
  v_mfma_f32_16x16x32_bf16 v[84:87], v[32:35], v[56:59], v[84:87]
  v_mfma_f32_16x16x32_bf16 v[84:87], v[36:39], v[60:63], v[84:87]
  v_mfma_f32_16x16x32_bf16 v[88:91], v[40:43], v[48:51], v[88:91]
  ds_read_b64_tr_b16 v[32:33], v10 offset:16384
  ds_read_b64_tr_b16 v[34:35], v10 offset:16896
  v_mfma_f32_16x16x32_bf16 v[88:91], v[44:47], v[52:55], v[88:91]
  ds_read_b64_tr_b16 v[36:37], v10 offset:20480
  ds_read_b64_tr_b16 v[38:39], v10 offset:20992
  v_mfma_f32_16x16x32_bf16 v[92:95], v[40:43], v[56:59], v[92:95]
  v_mfma_f32_16x16x32_bf16 v[92:95], v[44:47], v[60:63], v[92:95]
  ds_read_b64_tr_b16 v[40:41], v11 offset:16384
  ds_read_b64_tr_b16 v[42:43], v11 offset:16896
  ds_read_b64_tr_b16 v[44:45], v11 offset:20480
  ds_read_b64_tr_b16 v[46:47], v11 offset:20992
  s_waitcnt lgkmcnt(14)
  v_mfma_f32_16x16x32_bf16 v[64:67], v[16:19], v[96:99], v[64:67]
  s_waitcnt lgkmcnt(12)
  v_mfma_f32_16x16x32_bf16 v[64:67], v[20:23], v[100:103], v[64:67]
  v_mfma_f32_16x16x32_bf16 v[68:71], v[16:19], v[104:107], v[68:71]
  v_mfma_f32_16x16x32_bf16 v[68:71], v[20:23], v[108:111], v[68:71]
  s_waitcnt lgkmcnt(0)
  s_barrier
  v_mfma_f32_16x16x32_bf16 v[72:75], v[24:27], v[96:99], v[72:75]
  ds_read_b128 v[48:51], v12 offset:32768
  ds_read_b128 v[52:55], v13 offset:32768
  v_mfma_f32_16x16x32_bf16 v[72:75], v[28:31], v[100:103], v[72:75]
  ds_read_b128 v[56:59], v12 offset:34816
  ds_read_b128 v[60:63], v13 offset:34816
  v_mfma_f32_16x16x32_bf16 v[76:79], v[24:27], v[104:107], v[76:79]
  ds_read_b64_tr_b16 v[16:17], v8 offset:32768
  ds_read_b64_tr_b16 v[18:19], v8 offset:33280
  v_mfma_f32_16x16x32_bf16 v[76:79], v[28:31], v[108:111], v[76:79]
  ds_read_b64_tr_b16 v[20:21], v8 offset:36864
  ds_read_b64_tr_b16 v[22:23], v8 offset:37376
  v_mfma_f32_16x16x32_bf16 v[80:83], v[32:35], v[96:99], v[80:83]
  ds_read_b64_tr_b16 v[24:25], v9 offset:32768
  ds_read_b64_tr_b16 v[26:27], v9 offset:33280
  v_mfma_f32_16x16x32_bf16 v[80:83], v[36:39], v[100:103], v[80:83]
  ds_read_b64_tr_b16 v[28:29], v9 offset:36864
  ds_read_b64_tr_b16 v[30:31], v9 offset:37376
  v_mfma_f32_16x16x32_bf16 v[84:87], v[32:35], v[104:107], v[84:87]
  v_mfma_f32_16x16x32_bf16 v[84:87], v[36:39], v[108:111], v[84:87]
  v_mfma_f32_16x16x32_bf16 v[88:91], v[40:43], v[96:99], v[88:91]
  ds_read_b64_tr_b16 v[32:33], v10 offset:32768
  ds_read_b64_tr_b16 v[34:35], v10 offset:33280
  v_mfma_f32_16x16x32_bf16 v[88:91], v[44:47], v[100:103], v[88:91]
  ds_read_b64_tr_b16 v[36:37], v10 offset:36864
  ds_read_b64_tr_b16 v[38:39], v10 offset:37376
  v_mfma_f32_16x16x32_bf16 v[92:95], v[40:43], v[104:107], v[92:95]
  v_mfma_f32_16x16x32_bf16 v[92:95], v[44:47], v[108:111], v[92:95]
  ds_read_b64_tr_b16 v[40:41], v11 offset:32768
  ds_read_b64_tr_b16 v[42:43], v11 offset:33280
  ds_read_b64_tr_b16 v[44:45], v11 offset:36864
  ds_read_b64_tr_b16 v[46:47], v11 offset:37376
  s_waitcnt lgkmcnt(14)
  v_mfma_f32_16x16x32_bf16 v[64:67], v[16:19], v[48:51], v[64:67]
  s_waitcnt lgkmcnt(12)
  v_mfma_f32_16x16x32_bf16 v[64:67], v[20:23], v[52:55], v[64:67]
  v_mfma_f32_16x16x32_bf16 v[68:71], v[16:19], v[56:59], v[68:71]
  v_mfma_f32_16x16x32_bf16 v[68:71], v[20:23], v[60:63], v[68:71]
  s_waitcnt lgkmcnt(0)
  s_barrier
  v_mfma_f32_16x16x32_bf16 v[72:75], v[24:27], v[48:51], v[72:75]
  ds_read_b128 v[96:99], v12 offset:49152
  ds_read_b128 v[100:103], v13 offset:49152
  v_mfma_f32_16x16x32_bf16 v[72:75], v[28:31], v[52:55], v[72:75]
  ds_read_b128 v[104:107], v12 offset:51200
  ds_read_b128 v[108:111], v13 offset:51200
  v_mfma_f32_16x16x32_bf16 v[76:79], v[24:27], v[56:59], v[76:79]
  ds_read_b64_tr_b16 v[16:17], v8 offset:49152
  ds_read_b64_tr_b16 v[18:19], v8 offset:49664
  v_mfma_f32_16x16x32_bf16 v[76:79], v[28:31], v[60:63], v[76:79]
  ds_read_b64_tr_b16 v[20:21], v8 offset:53248
  ds_read_b64_tr_b16 v[22:23], v8 offset:53760
  v_mfma_f32_16x16x32_bf16 v[80:83], v[32:35], v[48:51], v[80:83]
  ds_read_b64_tr_b16 v[24:25], v9 offset:49152
  ds_read_b64_tr_b16 v[26:27], v9 offset:49664
  v_mfma_f32_16x16x32_bf16 v[80:83], v[36:39], v[52:55], v[80:83]
  ds_read_b64_tr_b16 v[28:29], v9 offset:53248
  ds_read_b64_tr_b16 v[30:31], v9 offset:53760
  v_mfma_f32_16x16x32_bf16 v[84:87], v[32:35], v[56:59], v[84:87]
  v_mfma_f32_16x16x32_bf16 v[84:87], v[36:39], v[60:63], v[84:87]
  v_mfma_f32_16x16x32_bf16 v[88:91], v[40:43], v[48:51], v[88:91]
  ds_read_b64_tr_b16 v[32:33], v10 offset:49152
  ds_read_b64_tr_b16 v[34:35], v10 offset:49664
  v_mfma_f32_16x16x32_bf16 v[88:91], v[44:47], v[52:55], v[88:91]
  ds_read_b64_tr_b16 v[36:37], v10 offset:53248
  ds_read_b64_tr_b16 v[38:39], v10 offset:53760
  v_mfma_f32_16x16x32_bf16 v[92:95], v[40:43], v[56:59], v[92:95]
  v_mfma_f32_16x16x32_bf16 v[92:95], v[44:47], v[60:63], v[92:95]
  ds_read_b64_tr_b16 v[40:41], v11 offset:49152
  ds_read_b64_tr_b16 v[42:43], v11 offset:49664
  ds_read_b64_tr_b16 v[44:45], v11 offset:53248
  ds_read_b64_tr_b16 v[46:47], v11 offset:53760
  s_waitcnt lgkmcnt(14)
  v_mfma_f32_16x16x32_bf16 v[64:67], v[16:19], v[96:99], v[64:67]
  s_waitcnt lgkmcnt(12)
  v_mfma_f32_16x16x32_bf16 v[64:67], v[20:23], v[100:103], v[64:67]
  v_mfma_f32_16x16x32_bf16 v[68:71], v[16:19], v[104:107], v[68:71]
  v_mfma_f32_16x16x32_bf16 v[68:71], v[20:23], v[108:111], v[68:71]
  s_waitcnt lgkmcnt(0)
  s_barrier
  v_mfma_f32_16x16x32_bf16 v[72:75], v[24:27], v[96:99], v[72:75]
  ds_read_b128 v[48:51], v12 offset:0
  ds_read_b128 v[52:55], v13 offset:0
  v_mfma_f32_16x16x32_bf16 v[72:75], v[28:31], v[100:103], v[72:75]
  ds_read_b128 v[56:59], v12 offset:2048
  ds_read_b128 v[60:63], v13 offset:2048
  v_mfma_f32_16x16x32_bf16 v[76:79], v[24:27], v[104:107], v[76:79]
  ds_read_b64_tr_b16 v[16:17], v8 offset:0
  ds_read_b64_tr_b16 v[18:19], v8 offset:512
  v_mfma_f32_16x16x32_bf16 v[76:79], v[28:31], v[108:111], v[76:79]
  ds_read_b64_tr_b16 v[20:21], v8 offset:4096
  ds_read_b64_tr_b16 v[22:23], v8 offset:4608
  s_sub_u32 s50, s50, 1
  s_cmp_lg_u32 s50, 0
  v_mfma_f32_16x16x32_bf16 v[80:83], v[32:35], v[96:99], v[80:83]
  ds_read_b64_tr_b16 v[24:25], v9 offset:0
  ds_read_b64_tr_b16 v[26:27], v9 offset:512
  v_mfma_f32_16x16x32_bf16 v[80:83], v[36:39], v[100:103], v[80:83]
  ds_read_b64_tr_b16 v[28:29], v9 offset:4096
  ds_read_b64_tr_b16 v[30:31], v9 offset:4608
  v_mfma_f32_16x16x32_bf16 v[84:87], v[32:35], v[104:107], v[84:87]
  v_mfma_f32_16x16x32_bf16 v[84:87], v[36:39], v[108:111], v[84:87]
  v_mfma_f32_16x16x32_bf16 v[88:91], v[40:43], v[96:99], v[88:91]
  ds_read_b64_tr_b16 v[32:33], v10 offset:0
  ds_read_b64_tr_b16 v[34:35], v10 offset:512
  v_mfma_f32_16x16x32_bf16 v[88:91], v[44:47], v[100:103], v[88:91]
  ds_read_b64_tr_b16 v[36:37], v10 offset:4096
  ds_read_b64_tr_b16 v[38:39], v10 offset:4608
  v_mfma_f32_16x16x32_bf16 v[92:95], v[40:43], v[104:107], v[92:95]
  v_mfma_f32_16x16x32_bf16 v[92:95], v[44:47], v[108:111], v[92:95]
  ds_read_b64_tr_b16 v[40:41], v11 offset:0
  ds_read_b64_tr_b16 v[42:43], v11 offset:512
  ds_read_b64_tr_b16 v[44:45], v11 offset:4096
  ds_read_b64_tr_b16 v[46:47], v11 offset:4608
  s_cbranch_scc1 Lq_LQ
  s_waitcnt lgkmcnt(14)
  v_mfma_f32_16x16x32_bf16 v[64:67], v[16:19], v[48:51], v[64:67]
  s_waitcnt lgkmcnt(12)
  v_mfma_f32_16x16x32_bf16 v[64:67], v[20:23], v[52:55], v[64:67]
  v_mfma_f32_16x16x32_bf16 v[68:71], v[16:19], v[56:59], v[68:71]
  v_mfma_f32_16x16x32_bf16 v[68:71], v[20:23], v[60:63], v[68:71]
  s_waitcnt lgkmcnt(0)
  s_barrier
  v_mfma_f32_16x16x32_bf16 v[72:75], v[24:27], v[48:51], v[72:75]
  ds_read_b128 v[96:99], v12 offset:16384
  ds_read_b128 v[100:103], v13 offset:16384
  v_mfma_f32_16x16x32_bf16 v[72:75], v[28:31], v[52:55], v[72:75]
  ds_read_b128 v[104:107], v12 offset:18432
  ds_read_b128 v[108:111], v13 offset:18432
  v_mfma_f32_16x16x32_bf16 v[76:79], v[24:27], v[56:59], v[76:79]
  ds_read_b64_tr_b16 v[16:17], v8 offset:16384
  ds_read_b64_tr_b16 v[18:19], v8 offset:16896
  v_mfma_f32_16x16x32_bf16 v[76:79], v[28:31], v[60:63], v[76:79]
  ds_read_b64_tr_b16 v[20:21], v8 offset:20480
  ds_read_b64_tr_b16 v[22:23], v8 offset:20992
  v_mfma_f32_16x16x32_bf16 v[80:83], v[32:35], v[48:51], v[80:83]
  ds_read_b64_tr_b16 v[24:25], v9 offset:16384
  ds_read_b64_tr_b16 v[26:27], v9 offset:16896
  v_mfma_f32_16x16x32_bf16 v[80:83], v[36:39], v[52:55], v[80:83]
  ds_read_b64_tr_b16 v[28:29], v9 offset:20480
  ds_read_b64_tr_b16 v[30:31], v9 offset:20992
  v_mfma_f32_16x16x32_bf16 v[84:87], v[32:35], v[56:59], v[84:87]
  v_mfma_f32_16x16x32_bf16 v[84:87], v[36:39], v[60:63], v[84:87]
  v_mfma_f32_16x16x32_bf16 v[88:91], v[40:43], v[48:51], v[88:91]
  ds_read_b64_tr_b16 v[32:33], v10 offset:16384
  ds_read_b64_tr_b16 v[34:35], v10 offset:16896
  v_mfma_f32_16x16x32_bf16 v[88:91], v[44:47], v[52:55], v[88:91]
  ds_read_b64_tr_b16 v[36:37], v10 offset:20480
  ds_read_b64_tr_b16 v[38:39], v10 offset:20992
  v_mfma_f32_16x16x32_bf16 v[92:95], v[40:43], v[56:59], v[92:95]
  v_mfma_f32_16x16x32_bf16 v[92:95], v[44:47], v[60:63], v[92:95]
  ds_read_b64_tr_b16 v[40:41], v11 offset:16384
  ds_read_b64_tr_b16 v[42:43], v11 offset:16896
  ds_read_b64_tr_b16 v[44:45], v11 offset:20480
  ds_read_b64_tr_b16 v[46:47], v11 offset:20992
  s_waitcnt lgkmcnt(14)
  v_mfma_f32_16x16x32_bf16 v[64:67], v[16:19], v[96:99], v[64:67]
  s_waitcnt lgkmcnt(12)
  v_mfma_f32_16x16x32_bf16 v[64:67], v[20:23], v[100:103], v[64:67]
  v_mfma_f32_16x16x32_bf16 v[68:71], v[16:19], v[104:107], v[68:71]
  v_mfma_f32_16x16x32_bf16 v[68:71], v[20:23], v[108:111], v[68:71]
  s_waitcnt lgkmcnt(0)
  s_barrier
  v_mfma_f32_16x16x32_bf16 v[72:75], v[24:27], v[96:99], v[72:75]
  ds_read_b128 v[48:51], v12 offset:32768
  ds_read_b128 v[52:55], v13 offset:32768
  v_mfma_f32_16x16x32_bf16 v[72:75], v[28:31], v[100:103], v[72:75]
  ds_read_b128 v[56:59], v12 offset:34816
  ds_read_b128 v[60:63], v13 offset:34816
  v_mfma_f32_16x16x32_bf16 v[76:79], v[24:27], v[104:107], v[76:79]
  ds_read_b64_tr_b16 v[16:17], v8 offset:32768
  ds_read_b64_tr_b16 v[18:19], v8 offset:33280
  v_mfma_f32_16x16x32_bf16 v[76:79], v[28:31], v[108:111], v[76:79]
  ds_read_b64_tr_b16 v[20:21], v8 offset:36864
  ds_read_b64_tr_b16 v[22:23], v8 offset:37376
  v_mfma_f32_16x16x32_bf16 v[80:83], v[32:35], v[96:99], v[80:83]
  ds_read_b64_tr_b16 v[24:25], v9 offset:32768
  ds_read_b64_tr_b16 v[26:27], v9 offset:33280
  v_mfma_f32_16x16x32_bf16 v[80:83], v[36:39], v[100:103], v[80:83]
  ds_read_b64_tr_b16 v[28:29], v9 offset:36864
  ds_read_b64_tr_b16 v[30:31], v9 offset:37376
  v_mfma_f32_16x16x32_bf16 v[84:87], v[32:35], v[104:107], v[84:87]
  v_mfma_f32_16x16x32_bf16 v[84:87], v[36:39], v[108:111], v[84:87]
  v_mfma_f32_16x16x32_bf16 v[88:91], v[40:43], v[96:99], v[88:91]
  ds_read_b64_tr_b16 v[32:33], v10 offset:32768
  ds_read_b64_tr_b16 v[34:35], v10 offset:33280
  v_mfma_f32_16x16x32_bf16 v[88:91], v[44:47], v[100:103], v[88:91]
  ds_read_b64_tr_b16 v[36:37], v10 offset:36864
  ds_read_b64_tr_b16 v[38:39], v10 offset:37376
  v_mfma_f32_16x16x32_bf16 v[92:95], v[40:43], v[104:107], v[92:95]
  v_mfma_f32_16x16x32_bf16 v[92:95], v[44:47], v[108:111], v[92:95]
  ds_read_b64_tr_b16 v[40:41], v11 offset:32768
  ds_read_b64_tr_b16 v[42:43], v11 offset:33280
  ds_read_b64_tr_b16 v[44:45], v11 offset:36864
  ds_read_b64_tr_b16 v[46:47], v11 offset:37376
  s_waitcnt lgkmcnt(14)
  v_mfma_f32_16x16x32_bf16 v[64:67], v[16:19], v[48:51], v[64:67]
  s_waitcnt lgkmcnt(12)
  v_mfma_f32_16x16x32_bf16 v[64:67], v[20:23], v[52:55], v[64:67]
  v_mfma_f32_16x16x32_bf16 v[68:71], v[16:19], v[56:59], v[68:71]
  v_mfma_f32_16x16x32_bf16 v[68:71], v[20:23], v[60:63], v[68:71]
  s_waitcnt lgkmcnt(0)
  s_barrier
  v_mfma_f32_16x16x32_bf16 v[72:75], v[24:27], v[48:51], v[72:75]
  ds_read_b128 v[96:99], v12 offset:49152
  ds_read_b128 v[100:103], v13 offset:49152
  v_mfma_f32_16x16x32_bf16 v[72:75], v[28:31], v[52:55], v[72:75]
  ds_read_b128 v[104:107], v12 offset:51200
  ds_read_b128 v[108:111], v13 offset:51200
  v_mfma_f32_16x16x32_bf16 v[76:79], v[24:27], v[56:59], v[76:79]
  ds_read_b64_tr_b16 v[16:17], v8 offset:49152
  ds_read_b64_tr_b16 v[18:19], v8 offset:49664
  v_mfma_f32_16x16x32_bf16 v[76:79], v[28:31], v[60:63], v[76:79]
  ds_read_b64_tr_b16 v[20:21], v8 offset:53248
  ds_read_b64_tr_b16 v[22:23], v8 offset:53760
  v_mfma_f32_16x16x32_bf16 v[80:83], v[32:35], v[48:51], v[80:83]
  ds_read_b64_tr_b16 v[24:25], v9 offset:49152
  ds_read_b64_tr_b16 v[26:27], v9 offset:49664
  v_mfma_f32_16x16x32_bf16 v[80:83], v[36:39], v[52:55], v[80:83]
  ds_read_b64_tr_b16 v[28:29], v9 offset:53248
  ds_read_b64_tr_b16 v[30:31], v9 offset:53760
  v_mfma_f32_16x16x32_bf16 v[84:87], v[32:35], v[56:59], v[84:87]
  v_mfma_f32_16x16x32_bf16 v[84:87], v[36:39], v[60:63], v[84:87]
  v_mfma_f32_16x16x32_bf16 v[88:91], v[40:43], v[48:51], v[88:91]
  ds_read_b64_tr_b16 v[32:33], v10 offset:49152
  ds_read_b64_tr_b16 v[34:35], v10 offset:49664
  v_mfma_f32_16x16x32_bf16 v[88:91], v[44:47], v[52:55], v[88:91]
  ds_read_b64_tr_b16 v[36:37], v10 offset:53248
  ds_read_b64_tr_b16 v[38:39], v10 offset:53760
  v_mfma_f32_16x16x32_bf16 v[92:95], v[40:43], v[56:59], v[92:95]
  v_mfma_f32_16x16x32_bf16 v[92:95], v[44:47], v[60:63], v[92:95]
  ds_read_b64_tr_b16 v[40:41], v11 offset:49152
  ds_read_b64_tr_b16 v[42:43], v11 offset:49664
  ds_read_b64_tr_b16 v[44:45], v11 offset:53248
  ds_read_b64_tr_b16 v[46:47], v11 offset:53760
  s_waitcnt lgkmcnt(14)
  v_mfma_f32_16x16x32_bf16 v[64:67], v[16:19], v[96:99], v[64:67]
  s_waitcnt lgkmcnt(12)
  v_mfma_f32_16x16x32_bf16 v[64:67], v[20:23], v[100:103], v[64:67]
  v_mfma_f32_16x16x32_bf16 v[68:71], v[16:19], v[104:107], v[68:71]
  v_mfma_f32_16x16x32_bf16 v[68:71], v[20:23], v[108:111], v[68:71]
  s_waitcnt lgkmcnt(0)
  s_barrier
  v_mfma_f32_16x16x32_bf16 v[72:75], v[24:27], v[96:99], v[72:75]
  v_mfma_f32_16x16x32_bf16 v[72:75], v[28:31], v[100:103], v[72:75]
  v_mfma_f32_16x16x32_bf16 v[76:79], v[24:27], v[104:107], v[76:79]
  v_mfma_f32_16x16x32_bf16 v[76:79], v[28:31], v[108:111], v[76:79]
  v_mfma_f32_16x16x32_bf16 v[80:83], v[32:35], v[96:99], v[80:83]
  v_mfma_f32_16x16x32_bf16 v[80:83], v[36:39], v[100:103], v[80:83]
  v_mfma_f32_16x16x32_bf16 v[84:87], v[32:35], v[104:107], v[84:87]
  v_mfma_f32_16x16x32_bf16 v[84:87], v[36:39], v[108:111], v[84:87]
  v_mfma_f32_16x16x32_bf16 v[88:91], v[40:43], v[96:99], v[88:91]
  v_mfma_f32_16x16x32_bf16 v[88:91], v[44:47], v[100:103], v[88:91]
  v_mfma_f32_16x16x32_bf16 v[92:95], v[40:43], v[104:107], v[92:95]
  v_mfma_f32_16x16x32_bf16 v[92:95], v[44:47], v[108:111], v[92:95]
  s_nop 1
  s_lshl_b32 s48, s51, 11
  s_add_u32 s48, s48, 0
  v_add_u32 v16, s48, v1
  v_cvt_pk_bf16_f32 v20, v64, v65
  v_cvt_pk_bf16_f32 v21, v66, v67
  v_cvt_pk_bf16_f32 v22, v72, v73
  v_cvt_pk_bf16_f32 v23, v74, v75
  ds_write_b128 v16, v[20:23] offset:0
  v_cvt_pk_bf16_f32 v24, v68, v69
  v_cvt_pk_bf16_f32 v25, v70, v71
  v_cvt_pk_bf16_f32 v26, v76, v77
  v_cvt_pk_bf16_f32 v27, v78, v79
  ds_write_b128 v16, v[24:27] offset:256
  v_cvt_pk_bf16_f32 v28, v80, v81
  v_cvt_pk_bf16_f32 v29, v82, v83
  v_cvt_pk_bf16_f32 v30, v88, v89
  v_cvt_pk_bf16_f32 v31, v90, v91
  ds_write_b128 v16, v[28:31] offset:8192
  v_cvt_pk_bf16_f32 v32, v84, v85
  v_cvt_pk_bf16_f32 v33, v86, v87
  v_cvt_pk_bf16_f32 v34, v92, v93
  v_cvt_pk_bf16_f32 v35, v94, v95
  ds_write_b128 v16, v[32:35] offset:8448
  s_waitcnt lgkmcnt(0)
  s_barrier
  s_sub_u32 s46, s2, 224
  s_lshl_b32 s46, s46, 2
  s_add_u32 s46, s46, s51
  s_lshl_b32 s46, s46, 13
  s_lshl_b32 s48, s46, 2
  v_lshlrev_b32 v5, 7, v2
  v_mov_b32 v8, -1
  v_mov_b32 v9, -1
  v_mov_b32 v10, -1
  v_mov_b32 v11, -1
  s_barrier
  s_barrier
  s_mov_b32 s16, s28
  s_mov_b32 s17, s29
  s_mov_b32 s18, 14680064
  s_mov_b32 s19, 0x00020000
  s_add_u32 s47, s46, 0
  buffer_load_dword v6, v5, s[16:19], s47 offen
  buffer_store_dwordx4 v[8:11], v3, s[20:23], s48 offen offset:0 sc1
  buffer_store_dwordx4 v[8:11], v3, s[20:23], s48 offen offset:1024 sc1
  buffer_store_dwordx4 v[8:11], v3, s[20:23], s48 offen offset:2048 sc1
  buffer_store_dwordx4 v[8:11], v3, s[20:23], s48 offen offset:3072 sc1
  s_add_u32 s48, s48, 4096
  s_barrier
  s_add_u32 s47, s46, 1048576
  buffer_load_dword v6, v5, s[16:19], s47 offen
  buffer_store_dwordx4 v[8:11], v3, s[20:23], s48 offen offset:0 sc1
  buffer_store_dwordx4 v[8:11], v3, s[20:23], s48 offen offset:1024 sc1
  buffer_store_dwordx4 v[8:11], v3, s[20:23], s48 offen offset:2048 sc1
  buffer_store_dwordx4 v[8:11], v3, s[20:23], s48 offen offset:3072 sc1
  s_add_u32 s48, s48, 4096
  s_barrier
  s_barrier
  s_add_u32 s47, s46, 2097152
  buffer_load_dword v6, v5, s[16:19], s47 offen
  buffer_store_dwordx4 v[8:11], v3, s[20:23], s48 offen offset:0 sc1
  buffer_store_dwordx4 v[8:11], v3, s[20:23], s48 offen offset:1024 sc1
  buffer_store_dwordx4 v[8:11], v3, s[20:23], s48 offen offset:2048 sc1
  buffer_store_dwordx4 v[8:11], v3, s[20:23], s48 offen offset:3072 sc1
  s_add_u32 s48, s48, 4096
  s_barrier
  s_add_u32 s47, s46, 3145728
  buffer_load_dword v6, v5, s[16:19], s47 offen
  buffer_store_dwordx4 v[8:11], v3, s[20:23], s48 offen offset:0 sc1
  buffer_store_dwordx4 v[8:11], v3, s[20:23], s48 offen offset:1024 sc1
  buffer_store_dwordx4 v[8:11], v3, s[20:23], s48 offen offset:2048 sc1
  buffer_store_dwordx4 v[8:11], v3, s[20:23], s48 offen offset:3072 sc1
  s_add_u32 s48, s48, 4096
  s_barrier
  s_barrier
  s_add_u32 s47, s46, 4194304
  buffer_load_dword v6, v5, s[16:19], s47 offen
  buffer_store_dwordx4 v[8:11], v3, s[20:23], s48 offen offset:0 sc1
  buffer_store_dwordx4 v[8:11], v3, s[20:23], s48 offen offset:1024 sc1
  buffer_store_dwordx4 v[8:11], v3, s[20:23], s48 offen offset:2048 sc1
  buffer_store_dwordx4 v[8:11], v3, s[20:23], s48 offen offset:3072 sc1
  s_add_u32 s48, s48, 4096
  s_barrier
  s_add_u32 s47, s46, 5242880
  buffer_load_dword v6, v5, s[16:19], s47 offen
  buffer_store_dwordx4 v[8:11], v3, s[20:23], s48 offen offset:0 sc1
  buffer_store_dwordx4 v[8:11], v3, s[20:23], s48 offen offset:1024 sc1
  buffer_store_dwordx4 v[8:11], v3, s[20:23], s48 offen offset:2048 sc1
  buffer_store_dwordx4 v[8:11], v3, s[20:23], s48 offen offset:3072 sc1
  s_add_u32 s48, s48, 4096
  s_barrier
  s_barrier
  s_add_u32 s47, s46, 6291456
  buffer_load_dword v6, v5, s[16:19], s47 offen
  buffer_store_dwordx4 v[8:11], v3, s[20:23], s48 offen offset:0 sc1
  buffer_store_dwordx4 v[8:11], v3, s[20:23], s48 offen offset:1024 sc1
  buffer_store_dwordx4 v[8:11], v3, s[20:23], s48 offen offset:2048 sc1
  buffer_store_dwordx4 v[8:11], v3, s[20:23], s48 offen offset:3072 sc1
  s_add_u32 s48, s48, 4096
  s_barrier
  s_add_u32 s47, s46, 7340032
  buffer_load_dword v6, v5, s[16:19], s47 offen
  buffer_store_dwordx4 v[8:11], v3, s[20:23], s48 offen offset:0 sc1
  buffer_store_dwordx4 v[8:11], v3, s[20:23], s48 offen offset:1024 sc1
  buffer_store_dwordx4 v[8:11], v3, s[20:23], s48 offen offset:2048 sc1
  buffer_store_dwordx4 v[8:11], v3, s[20:23], s48 offen offset:3072 sc1
  s_add_u32 s48, s48, 4096
  s_barrier
  s_barrier
  s_add_u32 s47, s46, 8388608
  buffer_load_dword v6, v5, s[16:19], s47 offen
  s_barrier
  s_add_u32 s47, s46, 9437184
  buffer_load_dword v6, v5, s[16:19], s47 offen
  s_barrier
  s_barrier
  s_add_u32 s47, s46, 10485760
  buffer_load_dword v6, v5, s[16:19], s47 offen
  s_barrier
  s_add_u32 s47, s46, 11534336
  buffer_load_dword v6, v5, s[16:19], s47 offen
  s_waitcnt vmcnt(0)
  s_barrier
  s_barrier
  s_add_u32 s47, s46, 12582912
  buffer_load_dword v6, v5, s[16:19], s47 offen
  s_barrier
  s_add_u32 s47, s46, 13631488
  buffer_load_dword v6, v5, s[16:19], s47 offen
  s_barrier
  s_barrier
  s_mov_b32 s16, s30
  s_mov_b32 s17, s31
  s_mov_b32 s18, 2097152
  s_mov_b32 s19, 0x00020000
  s_add_u32 s47, s46, 0
  buffer_load_dword v6, v5, s[16:19], s47 offen
  s_barrier
  s_add_u32 s47, s46, 1048576
  buffer_load_dword v6, v5, s[16:19], s47 offen
  s_barrier
  s_barrier
  s_barrier
  s_barrier
  s_waitcnt vmcnt(0)
  s_load_dwordx2 s[6:7], s[0:1], 72
  s_load_dwordx2 s[12:13], s[0:1], 88
  s_bfe_u32 s14, s2, 0x10002
  s_bfe_u32 s42, s2, 0x30003
  s_and_b32 s43, s2, 3
  s_lshl_b32 s43, s43, 2
  s_lshr_b32 s44, s2, 6
  s_add_u32 s43, s43, s44
  s_add_u32 s15, s42, s43
  s_add_u32 s15, s15, s14
  s_and_b32 s15, s15, 1
  s_mul_i32 s49, s15, 2
  s_lshl_b32 s44, s42, 7
  s_lshl_b32 s45, s43, 7
  s_and_b32 s46, s3, 1
  s_bfe_u32 s47, s3, 0x10001
  s_lshl_b32 s60, s46, 13
  s_add_u32 s60, s60, 0
  v_lshlrev_b32 v1, 4, v2
  v_add_u32 v1, s60, v1
  v_bfe_u32 v16, v2, 2, 2
  v_lshrrev_b32 v17, 4, v2
  v_lshl_add_u32 v16, v17, 2, v16
  v_lshlrev_b32 v16, 8, v16
  v_and_b32 v17, 3, v2
  v_lshl_add_u32 v16, v17, 3, v16
  v_add_u32 v16, 65536, v16
  v_bfe_u32 v17, v2, 2, 3
  s_lshl_b32 s60, s47, 2
  v_xor_b32 v17, s60, v17
  v_lshl_add_u32 v4, v17, 5, v16
  v_xor_b32 v18, 1, v17
  v_lshl_add_u32 v5, v18, 5, v16
  v_xor_b32 v18, 2, v17
  v_lshl_add_u32 v6, v18, 5, v16
  v_xor_b32 v18, 3, v17
  v_lshl_add_u32 v7, v18, 5, v16
  v_mov_b32 v64, 0
  v_mov_b32 v65, 0
  v_mov_b32 v66, 0
  v_mov_b32 v67, 0
  v_mov_b32 v68, 0
  v_mov_b32 v69, 0
  v_mov_b32 v70, 0
  v_mov_b32 v71, 0
  v_mov_b32 v72, 0
  v_mov_b32 v73, 0
  v_mov_b32 v74, 0
  v_mov_b32 v75, 0
  v_mov_b32 v76, 0
  v_mov_b32 v77, 0
  v_mov_b32 v78, 0
  v_mov_b32 v79, 0
  v_mov_b32 v80, 0
  v_mov_b32 v81, 0
  v_mov_b32 v82, 0
  v_mov_b32 v83, 0
  v_mov_b32 v84, 0
  v_mov_b32 v85, 0
  v_mov_b32 v86, 0
  v_mov_b32 v87, 0
  v_mov_b32 v88, 0
  v_mov_b32 v89, 0
  v_mov_b32 v90, 0
  v_mov_b32 v91, 0
  v_mov_b32 v92, 0
  v_mov_b32 v93, 0
  v_mov_b32 v94, 0
  v_mov_b32 v95, 0
  v_mov_b32 v96, 0
  v_mov_b32 v97, 0
  v_mov_b32 v98, 0
  v_mov_b32 v99, 0
  v_mov_b32 v100, 0
  v_mov_b32 v101, 0
  v_mov_b32 v102, 0
  v_mov_b32 v103, 0
  v_mov_b32 v104, 0
  v_mov_b32 v105, 0
  v_mov_b32 v106, 0
  v_mov_b32 v107, 0
  v_mov_b32 v108, 0
  v_mov_b32 v109, 0
  v_mov_b32 v110, 0
  v_mov_b32 v111, 0
  v_mov_b32 v112, 0
  v_mov_b32 v113, 0
  v_mov_b32 v114, 0
  v_mov_b32 v115, 0
  v_mov_b32 v116, 0
  v_mov_b32 v117, 0
  v_mov_b32 v118, 0
  v_mov_b32 v119, 0
  v_mov_b32 v120, 0
  v_mov_b32 v121, 0
  v_mov_b32 v122, 0
  v_mov_b32 v123, 0
  v_mov_b32 v124, 0
  v_mov_b32 v125, 0
  v_mov_b32 v126, 0
  v_mov_b32 v127, 0
  s_lshl_b32 s48, s47, 6
  s_add_u32 s48, s48, s45
  s_lshl_b32 s52, s43, 3
  s_add_u32 s52, s52, s42
  s_lshl_b32 s52, s52, 2
  s_and_b32 s53, s3, 3
  s_add_u32 s52, s52, s53
  s_lshl_b32 s52, s52, 13
  s_add_u32 s53, s52, 4096
  v_and_b32 v16, 7, v2
  v_lshlrev_b32 v16, 11, v16
  v_bfe_u32 v17, v2, 3, 1
  v_lshl_add_u32 v16, v17, 6, v16
  v_bfe_u32 v17, v2, 4, 1
  v_lshl_add_u32 v16, v17, 5, v16
  v_lshrrev_b32 v17, 5, v2
  v_lshl_add_u32 v0, v17, 4, v16
  s_lshl_b32 s54, s48, 11
  s_lshl_b32 s55, s46, 6
  s_add_u32 s55, s55, s44
  s_lshl_b32 s55, s55, 1
  s_add_u32 s54, s54, s55
  v_and_b32 v16, 15, v2
  v_add_u32 v16, s48, v16
  v_lshlrev_b32 v17, 1, v16
  v_lshlrev_b32 v18, 2, v16
  s_waitcnt lgkmcnt(0)
  s_mov_b32 s16, s6
  s_mov_b32 s17, s7
  s_mov_b32 s18, 4096
  s_mov_b32 s19, 0x00020000
  s_add_u32 s20, s38, 4194304
  s_addc_u32 s21, s39, 0
  s_mov_b32 s22, 8192
  s_mov_b32 s23, 0x00020000
  s_add_u32 s32, s38, 25165824
  s_addc_u32 s33, s39, 0
  s_mov_b32 s34, 4194304
  s_mov_b32 s35, 0x00020000
  s_mov_b32 s24, s12
  s_mov_b32 s25, s13
  s_mov_b32 s26, 4194304
  s_mov_b32 s27, 0x00020000
  buffer_load_dword v8, v18, s[20:23], 0 offen offset:0 sc1
  buffer_load_dword v10, v18, s[20:23], 0 offen offset:64 sc1
  buffer_load_dword v12, v18, s[20:23], 0 offen offset:128 sc1
  buffer_load_dword v14, v18, s[20:23], 0 offen offset:192 sc1
  buffer_load_ushort v9, v17, s[16:19], 0 offen offset:0
  buffer_load_ushort v11, v17, s[16:19], 0 offen offset:32
  buffer_load_ushort v13, v17, s[16:19], 0 offen offset:64
  buffer_load_ushort v15, v17, s[16:19], 0 offen offset:96
  s_barrier
  s_barrier
  s_barrier
  s_barrier
  s_barrier
  s_barrier
  s_barrier
  s_branch L_g2
L_attn:
  s_sub_u32 s46, s3, 4
  s_lshl_b32 s47, s43, 4
  s_add_u32 s47, s47, s42
  s_lshl_b32 s47, s47, 3
  s_add_u32 s47, s47, s46
  s_memrealtime s[60:61]
  s_waitcnt lgkmcnt(0)
  s_mov_b32 s28, s38
  s_mov_b32 s29, s39
  s_mov_b32 s30, 8388608
  s_mov_b32 s31, 0x00020000
  s_mov_b32 s56, s36
  s_mov_b32 s57, s37
  s_mov_b32 s58, 256
  s_mov_b32 s59, 0x00020000
  v_mov_b32 v124, 0
  s_or_b32 s60, s60, 1
  s_or_b32 s61, s2, s46
  v_mov_b32 v125, s60
  s_cmp_lg_u32 s61, 0
  s_cbranch_scc1 L_nm
  s_mov_b64 exec, 1
  buffer_store_dword v125, v124, s[56:59], 0 offen sc1
  s_mov_b64 exec, -1
L_nm:
  s_lshl_b32 s49, s46, 11
  s_add_u32 s49, s49, 131072
  v_add_u32 v24, s49, v3
  v_bfe_u32 v25, v2, 2, 2
  v_lshlrev_b32 v25, 11, v25
  v_lshrrev_b32 v26, 4, v2
  v_lshl_add_u32 v25, v26, 5, v25
  v_and_b32 v27, 3, v2
  v_lshl_add_u32 v25, v27, 3, v25
  s_lshl_b32 s49, s46, 8
  s_add_u32 s49, s49, 131072
  v_add_u32 v25, s49, v25
  v_bfe_u32 v27, v2, 2, 2
  v_lshlrev_b32 v27, 6, v27
  v_xor_b32 v25, v25, v27
  v_xor_b32 v28, 0x80, v25
  v_lshrrev_b32 v27, 5, v2
  v_lshlrev_b32 v27, 17, v27
  v_and_b32 v26, 1, v26
  v_lshl_add_u32 v27, v26, 11, v27
  v_and_b32 v26, 15, v2
  v_lshl_add_u32 v27, v26, 4, v27
  s_lshl_b32 s49, s46, 19
  s_lshl_b32 s50, s43, 13
  s_add_u32 s49, s49, s50
  s_lshr_b32 s50, s42, 3
  s_lshl_b32 s50, s50, 12
  s_add_u32 s49, s49, s50
  s_and_b32 s50, s42, 7
  s_lshl_b32 s50, s50, 8
  s_add_u32 s49, s49, s50
  s_add_u32 s50, s49, 262144
  s_lshl_b32 s51, s47, 2
  s_add_u32 s51, s51, 4194304
  s_mov_b32 s52, 0x3a800000
  s_mov_b32 s53, 0xbfb8aa3b
  s_and_b32 s47, s46, 3
  s_lshl_b32 s48, s43, 2
  s_add_u32 s47, s47, s48
  s_lshl_b32 s45, s47, 4
  s_add_u32 s45, s45, s42
  s_lshl_b32 s45, s45, 12
  s_lshr_b32 s48, s46, 2
  s_lshl_b32 s48, s48, 10
  s_add_u32 s45, s45, s48
  s_lshl_b32 s54, s47, 7
  s_add_u32 s54, s54, 4194304
  s_lshl_b32 s55, s46, 11
  s_add_u32 s55, s55, 0
  v_bfe_u32 v107, v2, 4, 1
  v_lshlrev_b32 v107, 11, v107
  v_and_b32 v7, 15, v2
  v_lshl_add_u32 v107, v7, 4, v107
  v_lshrrev_b32 v7, 5, v2
  v_lshl_add_u32 v107, v7, 8, v107
  v_and_b32 v5, 31, v2
  v_lshlrev_b32 v5, 2, v5
  v_add_u32 v1, s55, v3
  s_add_u32 s16, s38, 4259840
  s_addc_u32 s17, s39, 0
  s_mov_b32 s18, 262144
  s_mov_b32 s19, 0x00020000
  s_add_u32 s24, s38, 12582912
  s_addc_u32 s25, s39, 0
  s_mov_b32 s26, 4194304
  s_mov_b32 s27, 0x00020000
  s_cmp_lt_u32 s2, 224
  s_cselect_b32 s44, 96, 0
  v_bfe_u32 v7, v2, 2, 1
  v_and_b32 v105, 3, v2
  v_mov_b32 v106, 0x3f803f80
  v_cmp_gt_u32 vcc, 2, v105
  s_nop 1
  v_cndmask_b32 v106, 0, v106, vcc
  v_cmp_eq_u32 vcc, 0, v7
  s_nop 1
  v_cndmask_b32 v100, 0, v106, vcc
  v_cndmask_b32 v101, 0, v106, vcc
  v_sub_u32 v102, v106, v100
  v_sub_u32 v103, v106, v100
  v_mov_b32 v104, 0x44444444
  v_mov_b32 v106, 0xeeeeeeee
  v_cmp_eq_u32 vcc, 0, v105
  s_nop 1
  v_cndmask_b32 v104, v106, v104, vcc
  v_mov_b32 v80, 0
  v_mov_b32 v81, 0
  v_mov_b32 v82, 0
  v_mov_b32 v83, 0
  v_mov_b32 v84, 0
  v_mov_b32 v85, 0
  v_mov_b32 v86, 0
  v_mov_b32 v87, 0
  v_mov_b32 v88, 0
  v_mov_b32 v89, 0
  v_mov_b32 v90, 0
  v_mov_b32 v91, 0
  v_mov_b32 v92, 0
  v_mov_b32 v93, 0
  v_mov_b32 v94, 0
  v_mov_b32 v95, 0
  v_mov_b32 v96, 0
  v_mov_b32 v97, 0
  v_mov_b32 v98, 0
  v_mov_b32 v99, 0
  v_mov_b32 v72, 0
  v_mov_b32 v73, 0
  v_mov_b32 v74, 0
  v_mov_b32 v75, 0
  v_mov_b32 v76, 0
  v_mov_b32 v77, 0
  v_mov_b32 v78, 0
  v_mov_b32 v79, 0
  v_mov_b32 v120, 0
  v_mov_b32 v121, 0
  v_mov_b32 v122, 0
  v_mov_b32 v123, 0
  v_add_u32 v4, 131072, v3
  s_barrier
  ds_read_b128 v[8:11], v24
  ds_read_b128 v[12:15], v24 offset:1024
  ds_read_b128 v[16:19], v4 offset:16384
  ds_read_b128 v[20:23], v4 offset:17408
  s_waitcnt lgkmcnt(2)
  v_lshlrev_b32 v32, 16, v8
  v_and_b32 v33, 0xffff0000, v8
  v_lshlrev_b32 v34, 16, v9
  v_and_b32 v35, 0xffff0000, v9
  v_lshlrev_b32 v36, 16, v10
  v_and_b32 v37, 0xffff0000, v10
  v_lshlrev_b32 v38, 16, v11
  v_and_b32 v39, 0xffff0000, v11
  v_lshlrev_b32 v40, 16, v12
  v_and_b32 v41, 0xffff0000, v12
  v_lshlrev_b32 v42, 16, v13
  v_and_b32 v43, 0xffff0000, v13
  v_lshlrev_b32 v44, 16, v14
  v_and_b32 v45, 0xffff0000, v14
  v_lshlrev_b32 v46, 16, v15
  v_and_b32 v47, 0xffff0000, v15
  v_add_f32 v64, v32, v34
  v_add_f32 v65, v33, v35
  v_add_f32 v64, v64, v36
  v_add_f32 v65, v65, v37
  v_add_f32 v64, v64, v38
  v_add_f32 v65, v65, v39
  v_add_f32 v64, v64, v40
  v_add_f32 v65, v65, v41
  v_add_f32 v64, v64, v42
  v_add_f32 v65, v65, v43
  v_add_f32 v64, v64, v44
  v_add_f32 v65, v65, v45
  v_add_f32 v64, v64, v46
  v_add_f32 v65, v65, v47
  s_waitcnt lgkmcnt(0)
  v_lshlrev_b32 v48, 16, v16
  v_and_b32 v49, 0xffff0000, v16
  v_lshlrev_b32 v50, 16, v17
  v_and_b32 v51, 0xffff0000, v17
  v_lshlrev_b32 v52, 16, v18
  v_and_b32 v53, 0xffff0000, v18
  v_lshlrev_b32 v54, 16, v19
  v_and_b32 v55, 0xffff0000, v19
  v_lshlrev_b32 v56, 16, v20
  v_and_b32 v57, 0xffff0000, v20
  v_lshlrev_b32 v58, 16, v21
  v_and_b32 v59, 0xffff0000, v21
  v_lshlrev_b32 v60, 16, v22
  v_and_b32 v61, 0xffff0000, v22
  v_lshlrev_b32 v62, 16, v23
  v_and_b32 v63, 0xffff0000, v23
  v_mul_f32 v66, v32, v48
  v_mul_f32 v67, v33, v49
  v_fmac_f32 v66, v34, v50
  v_fmac_f32 v67, v35, v51
  v_fmac_f32 v66, v36, v52
  v_fmac_f32 v67, v37, v53
  v_fmac_f32 v66, v38, v54
  v_fmac_f32 v67, v39, v55
  v_fmac_f32 v66, v40, v56
  s_barrier
  v_fmac_f32 v67, v41, v57
  v_fmac_f32 v66, v42, v58
  v_fmac_f32 v67, v43, v59
  v_fmac_f32 v66, v44, v60
  v_fmac_f32 v67, v45, v61
  v_fmac_f32 v66, v46, v62
  v_fmac_f32 v67, v47, v63
  v_add_f32 v64, v64, v65
  v_add_f32 v66, v66, v67
  s_nop 0
  v_add_f32_dpp v64, v64, v64 quad_perm:[1,0,3,2] row_mask:0xf bank_mask:0xf
  v_add_f32_dpp v66, v66, v66 quad_perm:[1,0,3,2] row_mask:0xf bank_mask:0xf
  s_nop 0
  v_add_f32_dpp v64, v64, v64 quad_perm:[2,3,0,1] row_mask:0xf bank_mask:0xf
  v_add_f32_dpp v66, v66, v66 quad_perm:[2,3,0,1] row_mask:0xf bank_mask:0xf
  s_nop 0
  v_add_f32_dpp v64, v64, v64 row_half_mirror row_mask:0xf bank_mask:0xf
  v_add_f32_dpp v66, v66, v66 row_half_mirror row_mask:0xf bank_mask:0xf
  s_nop 0
  v_add_f32_dpp v64, v64, v64 row_mirror row_mask:0xf bank_mask:0xf
  v_add_f32_dpp v66, v66, v66 row_mirror row_mask:0xf bank_mask:0xf
  v_mov_b32 v68, v64
  v_mov_b32 v69, v66
  s_nop 1
  v_permlane16_swap_b32 v64, v68
  v_permlane16_swap_b32 v66, v69
  v_add_f32 v64, v64, v68
  v_add_f32 v66, v66, v69
  v_mov_b32 v68, v64
  v_mov_b32 v69, v66
  s_nop 1
  v_permlane32_swap_b32 v64, v68
  v_permlane32_swap_b32 v66, v69
  v_add_f32 v64, v64, v68
  v_add_f32 v66, v66, v69
  v_mul_f32 v64, s52, v64
  v_mul_f32 v66, s53, v66
  v_sub_f32 v32, v32, v64
  v_sub_f32 v33, v33, v64
  v_sub_f32 v34, v34, v64
  v_sub_f32 v35, v35, v64
  v_sub_f32 v36, v36, v64
  v_sub_f32 v37, v37, v64
  v_sub_f32 v38, v38, v64
  v_sub_f32 v39, v39, v64
  v_sub_f32 v40, v40, v64
  v_sub_f32 v41, v41, v64
  v_sub_f32 v42, v42, v64
  v_sub_f32 v43, v43, v64
  v_sub_f32 v44, v44, v64
  v_sub_f32 v45, v45, v64
  v_sub_f32 v46, v46, v64
  v_sub_f32 v47, v47, v64
  v_exp_f32 v66, v66
  v_mul_f32 v64, v32, v32
  v_mul_f32 v65, v33, v33
  v_fmac_f32 v64, v34, v34
  v_fmac_f32 v65, v35, v35
  v_fmac_f32 v64, v36, v36
  v_fmac_f32 v65, v37, v37
  v_fmac_f32 v64, v38, v38
  s_barrier
  v_fmac_f32 v65, v39, v39
  v_fmac_f32 v64, v40, v40
  v_fmac_f32 v65, v41, v41
  v_fmac_f32 v64, v42, v42
  v_fmac_f32 v65, v43, v43
  v_fmac_f32 v64, v44, v44
  v_fmac_f32 v65, v45, v45
  v_fmac_f32 v64, v46, v46
  v_fmac_f32 v65, v47, v47
  v_add_f32 v66, 1.0, v66
  v_add_f32 v64, v64, v65
  v_rcp_f32 v66, v66
  s_nop 1
  v_add_f32_dpp v64, v64, v64 quad_perm:[1,0,3,2] row_mask:0xf bank_mask:0xf
  s_nop 1
  v_add_f32_dpp v64, v64, v64 quad_perm:[2,3,0,1] row_mask:0xf bank_mask:0xf
  s_nop 1
  v_add_f32_dpp v64, v64, v64 row_half_mirror row_mask:0xf bank_mask:0xf
  s_nop 1
  v_add_f32_dpp v64, v64, v64 row_mirror row_mask:0xf bank_mask:0xf
  v_mov_b32 v68, v64
  s_nop 1
  v_permlane16_swap_b32 v64, v68
  v_add_f32 v64, v64, v68
  v_mov_b32 v68, v64
  s_nop 1
  v_permlane32_swap_b32 v64, v68
  v_add_f32 v64, v64, v68
  v_mov_b32 v68, 0x3727c5ac
  v_fma_f32 v64, v64, s52, v68
  v_rsq_f32 v64, v64
  v_mov_b32 v69, 0
  v_mul_f32 v32, v32, v64
  v_mul_f32 v33, v33, v64
  v_mul_f32 v34, v34, v64
  v_mul_f32 v35, v35, v64
  v_mul_f32 v36, v36, v64
  v_mul_f32 v37, v37, v64
  v_mul_f32 v38, v38, v64
  v_mul_f32 v39, v39, v64
  v_mul_f32 v40, v40, v64
  v_mul_f32 v41, v41, v64
  v_mul_f32 v42, v42, v64
  v_mul_f32 v43, v43, v64
  v_mul_f32 v44, v44, v64
  v_mul_f32 v45, v45, v64
  v_mul_f32 v46, v46, v64
  v_mul_f32 v47, v47, v64
  v_cvt_pk_bf16_f32 v8, v32, v33
  v_cvt_pk_bf16_f32 v9, v34, v35
  v_cvt_pk_bf16_f32 v10, v36, v37
  v_cvt_pk_bf16_f32 v11, v38, v39
  v_cvt_pk_bf16_f32 v12, v40, v41
  v_cvt_pk_bf16_f32 v13, v42, v43
  v_cvt_pk_bf16_f32 v14, v44, v45
  v_cvt_pk_bf16_f32 v15, v46, v47
  s_lshl_b32 s48, s46, 6
  s_and_b32 s48, s48, 0xc0
  v_xor_b32 v24, s48, v24
  ds_write_b128 v24, v[8:11]
  ds_write_b128 v24, v[12:15] offset:1024
  s_waitcnt lgkmcnt(0)
  s_barrier
  ds_read_b64_tr_b16 v[16:17], v25 offset:0
  ds_read_b64_tr_b16 v[18:19], v25 offset:8192
  ds_read_b64_tr_b16 v[20:21], v28 offset:0
  ds_read_b64_tr_b16 v[22:23], v28 offset:8192
  s_waitcnt lgkmcnt(0)
  s_barrier
  buffer_store_dwordx4 v[16:19], v27, s[28:31], s49 offen sc1
  buffer_store_dwordx4 v[20:23], v27, s[28:31], s50 offen sc1
  s_mov_b64 exec, 1
  buffer_store_dword v66, v69, s[28:31], s51 offen sc1
  s_mov_b64 exec, -1
  s_and_b32 s48, s2, 63
  s_lshl_b32 s48, s48, 7
  s_lshr_b32 s49, s2, 6
  s_lshl_b32 s49, s49, 2
  s_add_u32 s48, s48, s49
  s_add_u32 s48, s48, 4227072
  s_cmp_lg_u32 s3, 4
  s_cbranch_scc1 L_n0
  buffer_load_dword v125, v124, s[56:59], 0 offen sc1
L_n0:
  s_barrier
  s_barrier
  s_waitcnt vmcnt(0)
  s_barrier
  s_cmp_lg_u32 s3, 4
  s_cbranch_scc1 L_nh
  s_mov_b32 s49, 0x40000
L_n1:
  v_cmp_eq_u32 vcc, 0, v125
  s_nop 4
  s_cbranch_vccz L_n2
  buffer_load_dword v125, v124, s[56:59], 0 offen sc1
  s_sub_u32 s49, s49, 1
  s_cmp_lg_u32 s49, 0
  s_waitcnt vmcnt(0)
  s_cbranch_scc1 L_n1
L_n2:
  s_mov_b64 exec, 1
  buffer_store_dword v125, v124, s[28:31], s48 offen sc1
  v_mov_b32 v126, 163836
  ds_write_b32 v126, v125
  s_waitcnt lgkmcnt(0)
  s_mov_b64 exec, -1
L_nh:
  s_cmp_lt_u32 s2, 224
  s_cbranch_scc1 L_nx
  s_barrier
  s_barrier
  s_barrier
  s_barrier
  s_barrier
  s_barrier
  s_barrier
  s_barrier
  s_barrier
  s_barrier
  s_barrier
  s_barrier
  s_barrier
  s_barrier
  s_barrier
  s_barrier
  s_barrier
  s_barrier
  s_barrier
  s_barrier
L_nx:
  s_barrier
  s_barrier
  s_barrier
  s_barrier
  s_barrier
  s_barrier
  s_barrier
  s_barrier
  s_barrier
  buffer_load_dword v6, v5, s[28:31], s54 offen sc1
  s_barrier
  ds_read_b128 v[8:11], v1
  ds_read_b128 v[12:15], v1 offset:1024
  s_waitcnt lgkmcnt(0)
  s_barrier
  ds_read_b128 v[108:111], v4 offset:16384
  ds_read_b128 v[112:115], v4 offset:17408
  ds_read_b128 v[116:119], v4 offset:23552
  s_waitcnt vmcnt(0) lgkmcnt(0)
  v_mfma_f32_32x32x16_bf16 v[32:47], v[108:111], v[8:11], 0
  v_mfma_f32_32x32x16_bf16 v[32:47], v[112:115], v[12:15], v[32:47]
  s_nop 11
  v_max3_f32 v105, v32, v33, v34
  v_max3_f32 v105, v105, v35, v36
  v_max3_f32 v105, v105, v37, v38
  v_max3_f32 v105, v105, v39, v40
  v_max3_f32 v105, v105, v41, v42
  v_max3_f32 v105, v105, v43, v44
  v_max3_f32 v105, v105, v45, v46
  v_max_f32 v105, v105, v47
  v_mov_b32 v7, v105
  s_nop 1
  v_permlane32_swap_b32 v105, v7
  v_max_f32 v105, v105, v7
  v_sub_f32 v16, 0, v105
  v_sub_f32 v17, 0, v105
  v_sub_f32 v18, 0, v105
  v_sub_f32 v19, 0, v105
  v_sub_f32 v20, 0, v105
  v_sub_f32 v21, 0, v105
  v_sub_f32 v22, 0, v105
  v_sub_f32 v23, 0, v105
  v_sub_f32 v24, 0, v105
  v_sub_f32 v25, 0, v105
  v_sub_f32 v26, 0, v105
  v_sub_f32 v27, 0, v105
  v_sub_f32 v28, 0, v105
  v_sub_f32 v29, 0, v105
  v_sub_f32 v30, 0, v105
  v_sub_f32 v31, 0, v105
  s_nop 1
  v_mfma_f32_32x32x16_bf16 v[32:47], v[108:111], v[8:11], v[16:31]
  v_mfma_f32_32x32x16_bf16 v[32:47], v[112:115], v[12:15], v[32:47]
  ds_read_b128 v[108:111], v4 offset:18432
  ds_read_b128 v[112:115], v4 offset:19456
  s_mov_b32 s46, 8
  s_nop 7
.p2align 6
L_loop:
  s_waitcnt lgkmcnt(0)
  s_barrier
  v_mfma_f32_32x32x16_bf16 v[48:63], v[108:111], v[8:11], v[16:31]
  ds_read_b128 v[108:111], v4 offset:24576
  v_exp_f32 v32, v32
  v_exp_f32 v33, v33
  v_exp_f32 v34, v34
  v_exp_f32 v35, v35
  v_mfma_f32_32x32x16_bf16 v[48:63], v[112:115], v[12:15], v[48:63]
  ds_read_b128 v[112:115], v4 offset:25600
  v_exp_f32 v36, v36
  v_exp_f32 v37, v37
  v_exp_f32 v38, v38
  v_cvt_pk_bf16_f32 v64, v32, v33
  v_cvt_pk_bf16_f32 v65, v34, v35
  v_mfma_f32_32x32x16_bf16 v[80:95], v[120:123], v[76:79], v[80:95]
  ds_read_b128 v[120:123], v4 offset:28672
  v_exp_f32 v39, v39
  v_cvt_pk_bf16_f32 v66, v36, v37
  v_cvt_pk_bf16_f32 v67, v38, v39
  v_exp_f32 v40, v40
  v_exp_f32 v41, v41
  v_mfma_f32_32x32x16_bf16 v[80:95], v[116:119], v[64:67], v[80:95]
  ds_read_b128 v[116:119], v4 offset:29696
  v_exp_f32 v42, v42
  v_exp_f32 v43, v43
  v_exp_f32 v44, v44
  v_cvt_pk_bf16_f32 v68, v40, v41
  v_cvt_pk_bf16_f32 v69, v42, v43
  v_smfmac_f32_16x16x64_bf16 v[96:99], v[100:103], v[72:79], v104
  v_exp_f32 v45, v45
  v_exp_f32 v46, v46
  v_exp_f32 v47, v47
  v_cvt_pk_bf16_f32 v70, v44, v45
  v_cvt_pk_bf16_f32 v71, v46, v47
  s_bitcmp1_b32 s44, s46
  s_cbranch_scc0 L_x1
  s_barrier
L_x1:
  s_waitcnt lgkmcnt(1)
  v_mfma_f32_32x32x16_bf16 v[32:47], v[108:111], v[8:11], v[16:31]
  ds_read_b128 v[108:111], v4 offset:26624
  v_exp_f32 v48, v48
  v_exp_f32 v49, v49
  v_exp_f32 v50, v50
  v_exp_f32 v51, v51
  v_mfma_f32_32x32x16_bf16 v[32:47], v[112:115], v[12:15], v[32:47]
  ds_read_b128 v[112:115], v4 offset:27648
  v_exp_f32 v52, v52
  v_exp_f32 v53, v53
  v_exp_f32 v54, v54
  v_cvt_pk_bf16_f32 v72, v48, v49
  v_cvt_pk_bf16_f32 v73, v50, v51
  v_mfma_f32_32x32x16_bf16 v[80:95], v[120:123], v[68:71], v[80:95]
  ds_read_b128 v[120:123], v4 offset:30720
  v_exp_f32 v55, v55
  v_cvt_pk_bf16_f32 v74, v52, v53
  v_cvt_pk_bf16_f32 v75, v54, v55
  v_exp_f32 v56, v56
  v_exp_f32 v57, v57
  s_waitcnt lgkmcnt(3)
  v_mfma_f32_32x32x16_bf16 v[80:95], v[116:119], v[72:75], v[80:95]
  ds_read_b128 v[116:119], v4 offset:31744
  v_exp_f32 v58, v58
  v_exp_f32 v59, v59
  v_exp_f32 v60, v60
  v_cvt_pk_bf16_f32 v76, v56, v57
  v_cvt_pk_bf16_f32 v77, v58, v59
  v_smfmac_f32_16x16x64_bf16 v[96:99], v[100:103], v[64:71], v104
  v_exp_f32 v61, v61
  v_exp_f32 v62, v62
  v_exp_f32 v63, v63
  v_cvt_pk_bf16_f32 v78, v60, v61
  v_cvt_pk_bf16_f32 v79, v62, v63
  s_waitcnt lgkmcnt(0)
  s_barrier
  v_mfma_f32_32x32x16_bf16 v[48:63], v[108:111], v[8:11], v[16:31]
  ds_read_b128 v[108:111], v4 offset:0
  v_exp_f32 v32, v32
  v_exp_f32 v33, v33
  v_exp_f32 v34, v34
  v_exp_f32 v35, v35
  v_mfma_f32_32x32x16_bf16 v[48:63], v[112:115], v[12:15], v[48:63]
  ds_read_b128 v[112:115], v4 offset:1024
  v_exp_f32 v36, v36
  v_exp_f32 v37, v37
  v_exp_f32 v38, v38
  v_cvt_pk_bf16_f32 v64, v32, v33
  v_cvt_pk_bf16_f32 v65, v34, v35
  v_mfma_f32_32x32x16_bf16 v[80:95], v[120:123], v[76:79], v[80:95]
  ds_read_b128 v[120:123], v4 offset:4096
  v_exp_f32 v39, v39
  v_cvt_pk_bf16_f32 v66, v36, v37
  v_cvt_pk_bf16_f32 v67, v38, v39
  v_exp_f32 v40, v40
  v_exp_f32 v41, v41
  v_mfma_f32_32x32x16_bf16 v[80:95], v[116:119], v[64:67], v[80:95]
  ds_read_b128 v[116:119], v4 offset:5120
  v_exp_f32 v42, v42
  v_exp_f32 v43, v43
  v_exp_f32 v44, v44
  v_cvt_pk_bf16_f32 v68, v40, v41
  v_cvt_pk_bf16_f32 v69, v42, v43
  v_smfmac_f32_16x16x64_bf16 v[96:99], v[100:103], v[72:79], v104
  v_exp_f32 v45, v45
  v_exp_f32 v46, v46
  v_exp_f32 v47, v47
  v_cvt_pk_bf16_f32 v70, v44, v45
  v_cvt_pk_bf16_f32 v71, v46, v47
  s_bitcmp1_b32 s44, s46
  s_cbranch_scc0 L_x3
  s_barrier
L_x3:
  s_waitcnt lgkmcnt(1)
  v_mfma_f32_32x32x16_bf16 v[32:47], v[108:111], v[8:11], v[16:31]
  ds_read_b128 v[108:111], v4 offset:2048
  v_exp_f32 v48, v48
  v_exp_f32 v49, v49
  v_exp_f32 v50, v50
  v_exp_f32 v51, v51
  v_mfma_f32_32x32x16_bf16 v[32:47], v[112:115], v[12:15], v[32:47]
  ds_read_b128 v[112:115], v4 offset:3072
  v_exp_f32 v52, v52
  v_exp_f32 v53, v53
  v_exp_f32 v54, v54
  v_cvt_pk_bf16_f32 v72, v48, v49
  v_cvt_pk_bf16_f32 v73, v50, v51
  v_mfma_f32_32x32x16_bf16 v[80:95], v[120:123], v[68:71], v[80:95]
  ds_read_b128 v[120:123], v4 offset:6144
  v_exp_f32 v55, v55
  v_cvt_pk_bf16_f32 v74, v52, v53
  v_cvt_pk_bf16_f32 v75, v54, v55
  v_exp_f32 v56, v56
  v_exp_f32 v57, v57
  s_waitcnt lgkmcnt(3)
  v_mfma_f32_32x32x16_bf16 v[80:95], v[116:119], v[72:75], v[80:95]
  ds_read_b128 v[116:119], v4 offset:7168
  v_exp_f32 v58, v58
  v_exp_f32 v59, v59
  v_exp_f32 v60, v60
  v_cvt_pk_bf16_f32 v76, v56, v57
  v_cvt_pk_bf16_f32 v77, v58, v59
  v_smfmac_f32_16x16x64_bf16 v[96:99], v[100:103], v[64:71], v104
  v_exp_f32 v61, v61
  v_exp_f32 v62, v62
  v_exp_f32 v63, v63
  v_cvt_pk_bf16_f32 v78, v60, v61
  v_cvt_pk_bf16_f32 v79, v62, v63
  s_waitcnt lgkmcnt(0)
  s_barrier
  v_mfma_f32_32x32x16_bf16 v[48:63], v[108:111], v[8:11], v[16:31]
  ds_read_b128 v[108:111], v4 offset:8192
  v_exp_f32 v32, v32
  v_exp_f32 v33, v33
  v_exp_f32 v34, v34
  v_exp_f32 v35, v35
  v_mfma_f32_32x32x16_bf16 v[48:63], v[112:115], v[12:15], v[48:63]
  ds_read_b128 v[112:115], v4 offset:9216
  v_exp_f32 v36, v36
  v_exp_f32 v37, v37
  v_exp_f32 v38, v38
  v_cvt_pk_bf16_f32 v64, v32, v33
  v_cvt_pk_bf16_f32 v65, v34, v35
  v_mfma_f32_32x32x16_bf16 v[80:95], v[120:123], v[76:79], v[80:95]
  ds_read_b128 v[120:123], v4 offset:12288
  v_exp_f32 v39, v39
  v_cvt_pk_bf16_f32 v66, v36, v37
  v_cvt_pk_bf16_f32 v67, v38, v39
  v_exp_f32 v40, v40
  v_exp_f32 v41, v41
  v_mfma_f32_32x32x16_bf16 v[80:95], v[116:119], v[64:67], v[80:95]
  ds_read_b128 v[116:119], v4 offset:13312
  v_exp_f32 v42, v42
  v_exp_f32 v43, v43
  v_exp_f32 v44, v44
  v_cvt_pk_bf16_f32 v68, v40, v41
  v_cvt_pk_bf16_f32 v69, v42, v43
  v_smfmac_f32_16x16x64_bf16 v[96:99], v[100:103], v[72:79], v104
  v_exp_f32 v45, v45
  v_exp_f32 v46, v46
  v_exp_f32 v47, v47
  v_cvt_pk_bf16_f32 v70, v44, v45
  v_cvt_pk_bf16_f32 v71, v46, v47
  s_bitcmp1_b32 s44, s46
  s_cbranch_scc0 L_x5
  s_barrier
L_x5:
  s_waitcnt lgkmcnt(1)
  v_mfma_f32_32x32x16_bf16 v[32:47], v[108:111], v[8:11], v[16:31]
  ds_read_b128 v[108:111], v4 offset:10240
  v_exp_f32 v48, v48
  v_exp_f32 v49, v49
  v_exp_f32 v50, v50
  v_exp_f32 v51, v51
  v_mfma_f32_32x32x16_bf16 v[32:47], v[112:115], v[12:15], v[32:47]
  ds_read_b128 v[112:115], v4 offset:11264
  v_exp_f32 v52, v52
  v_exp_f32 v53, v53
  v_exp_f32 v54, v54
  v_cvt_pk_bf16_f32 v72, v48, v49
  v_cvt_pk_bf16_f32 v73, v50, v51
  v_mfma_f32_32x32x16_bf16 v[80:95], v[120:123], v[68:71], v[80:95]
  ds_read_b128 v[120:123], v4 offset:14336
  v_exp_f32 v55, v55
  v_cvt_pk_bf16_f32 v74, v52, v53
  v_cvt_pk_bf16_f32 v75, v54, v55
  v_exp_f32 v56, v56
  v_exp_f32 v57, v57
  s_waitcnt lgkmcnt(3)
  v_mfma_f32_32x32x16_bf16 v[80:95], v[116:119], v[72:75], v[80:95]
  ds_read_b128 v[116:119], v4 offset:15360
  v_exp_f32 v58, v58
  v_exp_f32 v59, v59
  v_exp_f32 v60, v60
  v_cvt_pk_bf16_f32 v76, v56, v57
  v_cvt_pk_bf16_f32 v77, v58, v59
  v_smfmac_f32_16x16x64_bf16 v[96:99], v[100:103], v[64:71], v104
  v_exp_f32 v61, v61
  v_exp_f32 v62, v62
  v_exp_f32 v63, v63
  v_cvt_pk_bf16_f32 v78, v60, v61
  v_cvt_pk_bf16_f32 v79, v62, v63
  s_waitcnt lgkmcnt(0)
  s_barrier
  v_mfma_f32_32x32x16_bf16 v[48:63], v[108:111], v[8:11], v[16:31]
  ds_read_b128 v[108:111], v4 offset:16384
  v_exp_f32 v32, v32
  v_exp_f32 v33, v33
  v_exp_f32 v34, v34
  v_exp_f32 v35, v35
  v_mfma_f32_32x32x16_bf16 v[48:63], v[112:115], v[12:15], v[48:63]
  ds_read_b128 v[112:115], v4 offset:17408
  v_exp_f32 v36, v36
  v_exp_f32 v37, v37
  v_exp_f32 v38, v38
  v_cvt_pk_bf16_f32 v64, v32, v33
  v_cvt_pk_bf16_f32 v65, v34, v35
  v_mfma_f32_32x32x16_bf16 v[80:95], v[120:123], v[76:79], v[80:95]
  ds_read_b128 v[120:123], v4 offset:20480
  v_exp_f32 v39, v39
  v_cvt_pk_bf16_f32 v66, v36, v37
  v_cvt_pk_bf16_f32 v67, v38, v39
  v_exp_f32 v40, v40
  v_exp_f32 v41, v41
  v_mfma_f32_32x32x16_bf16 v[80:95], v[116:119], v[64:67], v[80:95]
  ds_read_b128 v[116:119], v4 offset:21504
  v_exp_f32 v42, v42
  v_exp_f32 v43, v43
  v_exp_f32 v44, v44
  v_cvt_pk_bf16_f32 v68, v40, v41
  v_cvt_pk_bf16_f32 v69, v42, v43
  v_smfmac_f32_16x16x64_bf16 v[96:99], v[100:103], v[72:79], v104
  v_exp_f32 v45, v45
  v_exp_f32 v46, v46
  v_exp_f32 v47, v47
  v_cvt_pk_bf16_f32 v70, v44, v45
  v_cvt_pk_bf16_f32 v71, v46, v47
  s_bitcmp1_b32 s44, s46
  s_cbranch_scc0 L_x7
  s_barrier
L_x7:
  s_waitcnt lgkmcnt(1)
  v_mfma_f32_32x32x16_bf16 v[32:47], v[108:111], v[8:11], v[16:31]
  ds_read_b128 v[108:111], v4 offset:18432
  v_exp_f32 v48, v48
  v_exp_f32 v49, v49
  v_exp_f32 v50, v50
  v_exp_f32 v51, v51
  v_mfma_f32_32x32x16_bf16 v[32:47], v[112:115], v[12:15], v[32:47]
  ds_read_b128 v[112:115], v4 offset:19456
  v_exp_f32 v52, v52
  v_exp_f32 v53, v53
  v_exp_f32 v54, v54
  v_cvt_pk_bf16_f32 v72, v48, v49
  v_cvt_pk_bf16_f32 v73, v50, v51
  v_mfma_f32_32x32x16_bf16 v[80:95], v[120:123], v[68:71], v[80:95]
  ds_read_b128 v[120:123], v4 offset:22528
  v_exp_f32 v55, v55
  v_cvt_pk_bf16_f32 v74, v52, v53
  v_cvt_pk_bf16_f32 v75, v54, v55
  v_exp_f32 v56, v56
  v_exp_f32 v57, v57
  s_waitcnt lgkmcnt(3)
  v_mfma_f32_32x32x16_bf16 v[80:95], v[116:119], v[72:75], v[80:95]
  ds_read_b128 v[116:119], v4 offset:23552
  v_exp_f32 v58, v58
  v_exp_f32 v59, v59
  v_exp_f32 v60, v60
  v_cvt_pk_bf16_f32 v76, v56, v57
  v_cvt_pk_bf16_f32 v77, v58, v59
  v_smfmac_f32_16x16x64_bf16 v[96:99], v[100:103], v[64:71], v104
  s_sub_u32 s46, s46, 1
  s_cmp_lg_u32 s46, 0
  v_exp_f32 v61, v61
  v_exp_f32 v62, v62
  v_exp_f32 v63, v63
  v_cvt_pk_bf16_f32 v78, v60, v61
  v_cvt_pk_bf16_f32 v79, v62, v63
  s_cbranch_scc1 L_loop
  s_waitcnt lgkmcnt(0)
  s_nop 0
  v_mfma_f32_32x32x16_bf16 v[80:95], v[120:123], v[76:79], v[80:95]
  v_smfmac_f32_16x16x64_bf16 v[96:99], v[100:103], v[72:79], v104
  s_nop 11
  v_add_f32 v7, v96, v97
  v_max3_f32 v105, |v80|, |v81|, |v82|
  v_max3_f32 v105, v105, |v83|, |v84|
  v_max3_f32 v105, v105, |v85|, |v86|
  v_max3_f32 v105, v105, |v87|, |v88|
  v_max3_f32 v105, v105, |v89|, |v90|
  v_max3_f32 v105, v105, |v91|, |v92|
  v_max3_f32 v105, v105, |v93|, |v94|
  v_max_f32 v105, v105, |v95|
  v_add_f32 v106, v80, v81
  v_add_f32 v106, v106, v82
  v_add_f32 v106, v106, v83
  v_add_f32 v106, v106, v84
  v_add_f32 v106, v106, v85
  v_add_f32 v106, v106, v86
  v_add_f32 v106, v106, v87
  v_add_f32 v106, v106, v88
  v_add_f32 v106, v106, v89
  v_add_f32 v106, v106, v90
  v_add_f32 v106, v106, v91
  v_add_f32 v106, v106, v92
  v_add_f32 v106, v106, v93
  v_add_f32 v106, v106, v94
  v_add_f32 v106, v106, v95
  s_mov_b32 s48, 0x5f800000
  s_mov_b32 s49, 0x7b800000
  v_cmp_gt_f32 s[50:51], s48, v7
  v_cmp_gt_f32 s[52:53], s49, v105
  v_cmp_o_f32 vcc, v106, v106
  s_nop 1
  s_and_b64 s[50:51], s[50:51], s[52:53]
  s_and_b64 s[50:51], s[50:51], vcc
  s_cmp_eq_u64 s[50:51], -1
  s_cbranch_scc0 L_slow
L_fin:
  v_rcp_f32 v7, v7
  s_nop 0
  v_mul_f32 v7, v7, v6
  v_mul_f32 v80, v80, v7
  v_mul_f32 v81, v81, v7
  v_mul_f32 v82, v82, v7
  v_mul_f32 v83, v83, v7
  v_mul_f32 v84, v84, v7
  v_mul_f32 v85, v85, v7
  v_mul_f32 v86, v86, v7
  v_mul_f32 v87, v87, v7
  v_mul_f32 v88, v88, v7
  v_mul_f32 v89, v89, v7
  v_mul_f32 v90, v90, v7
  v_mul_f32 v91, v91, v7
  v_mul_f32 v92, v92, v7
  v_mul_f32 v93, v93, v7
  v_mul_f32 v94, v94, v7
  v_mul_f32 v95, v95, v7
  v_cvt_pk_bf16_f32 v80, v80, v81
  v_cvt_pk_bf16_f32 v81, v82, v83
  v_cvt_pk_bf16_f32 v82, v84, v85
  v_cvt_pk_bf16_f32 v83, v86, v87
  buffer_store_dwordx4 v[80:83], v107, s[24:27], s45 offen offset:0 sc1
  v_cvt_pk_bf16_f32 v88, v88, v89
  v_cvt_pk_bf16_f32 v89, v90, v91
  v_cvt_pk_bf16_f32 v90, v92, v93
  v_cvt_pk_bf16_f32 v91, v94, v95
  buffer_store_dwordx4 v[88:91], v107, s[24:27], s45 offen offset:512 sc1
  s_barrier
  s_barrier
  s_waitcnt vmcnt(0)
  s_barrier
L_end:
  s_endpgm
L_slow:
  v_mov_b32 v105, 0xff800000
  s_mov_b32 s46, 0
L_s1:
  buffer_load_dwordx4 v[108:111], v3, s[16:19], s46 offen
  buffer_load_dwordx4 v[112:115], v3, s[16:19], s46 offen offset:1024
  s_waitcnt vmcnt(0)
  v_mfma_f32_32x32x16_bf16 v[32:47], v[108:111], v[8:11], 0
  v_mfma_f32_32x32x16_bf16 v[32:47], v[112:115], v[12:15], v[32:47]
  s_nop 11
  v_max3_f32 v105, v105, v32, v33
  v_max3_f32 v105, v105, v34, v35
  v_max3_f32 v105, v105, v36, v37
  v_max3_f32 v105, v105, v38, v39
  v_max3_f32 v105, v105, v40, v41
  v_max3_f32 v105, v105, v42, v43
  v_max3_f32 v105, v105, v44, v45
  v_max3_f32 v105, v105, v46, v47
  s_add_u32 s46, s46, 2048
  s_cmp_lt_u32 s46, 131072
  s_cbranch_scc1 L_s1
  v_mov_b32 v7, v105
  s_nop 1
  v_permlane32_swap_b32 v105, v7
  v_max_f32 v105, v105, v7
  v_sub_f32 v16, 0, v105
  v_sub_f32 v17, 0, v105
  v_sub_f32 v18, 0, v105
  v_sub_f32 v19, 0, v105
  v_sub_f32 v20, 0, v105
  v_sub_f32 v21, 0, v105
  v_sub_f32 v22, 0, v105
  v_sub_f32 v23, 0, v105
  v_sub_f32 v24, 0, v105
  v_sub_f32 v25, 0, v105
  v_sub_f32 v26, 0, v105
  v_sub_f32 v27, 0, v105
  v_sub_f32 v28, 0, v105
  v_sub_f32 v29, 0, v105
  v_sub_f32 v30, 0, v105
  v_sub_f32 v31, 0, v105
  s_nop 1
  v_mov_b32 v80, 0
  v_mov_b32 v81, 0
  v_mov_b32 v82, 0
  v_mov_b32 v83, 0
  v_mov_b32 v84, 0
  v_mov_b32 v85, 0
  v_mov_b32 v86, 0
  v_mov_b32 v87, 0
  v_mov_b32 v88, 0
  v_mov_b32 v89, 0
  v_mov_b32 v90, 0
  v_mov_b32 v91, 0
  v_mov_b32 v92, 0
  v_mov_b32 v93, 0
  v_mov_b32 v94, 0
  v_mov_b32 v95, 0
  v_mov_b32 v96, 0
  v_mov_b32 v97, 0
  v_mov_b32 v98, 0
  v_mov_b32 v99, 0
  s_mov_b32 s46, 0
L_s2:
  s_add_u32 s47, s46, 131072
  buffer_load_dwordx4 v[108:111], v3, s[16:19], s46 offen
  buffer_load_dwordx4 v[112:115], v3, s[16:19], s46 offen offset:1024
  buffer_load_dwordx4 v[116:119], v3, s[16:19], s47 offen
  buffer_load_dwordx4 v[120:123], v3, s[16:19], s47 offen offset:1024
  s_waitcnt vmcnt(0)
  v_mfma_f32_32x32x16_bf16 v[32:47], v[108:111], v[8:11], v[16:31]
  v_mfma_f32_32x32x16_bf16 v[32:47], v[112:115], v[12:15], v[32:47]
  s_nop 11
  v_exp_f32 v32, v32
  v_exp_f32 v33, v33
  v_exp_f32 v34, v34
  v_exp_f32 v35, v35
  v_exp_f32 v36, v36
  v_exp_f32 v37, v37
  v_exp_f32 v38, v38
  v_exp_f32 v39, v39
  v_exp_f32 v40, v40
  v_exp_f32 v41, v41
  v_exp_f32 v42, v42
  v_exp_f32 v43, v43
  v_exp_f32 v44, v44
  v_exp_f32 v45, v45
  v_exp_f32 v46, v46
  v_exp_f32 v47, v47
  s_nop 0
  v_cvt_pk_bf16_f32 v64, v32, v33
  v_cvt_pk_bf16_f32 v65, v34, v35
  v_cvt_pk_bf16_f32 v66, v36, v37
  v_cvt_pk_bf16_f32 v67, v38, v39
  v_cvt_pk_bf16_f32 v68, v40, v41
  v_cvt_pk_bf16_f32 v69, v42, v43
  v_cvt_pk_bf16_f32 v70, v44, v45
  v_cvt_pk_bf16_f32 v71, v46, v47
  s_nop 1
  v_mfma_f32_32x32x16_bf16 v[80:95], v[116:119], v[64:67], v[80:95]
  v_mfma_f32_32x32x16_bf16 v[80:95], v[120:123], v[68:71], v[80:95]
  v_smfmac_f32_16x16x64_bf16 v[96:99], v[100:103], v[64:71], v104
  s_add_u32 s46, s46, 2048
  s_cmp_lt_u32 s46, 131072
  s_nop 7
  s_cbranch_scc1 L_s2
  s_nop 11
  v_add_f32 v7, v96, v97
  s_branch L_fin
.section .rodata,"a"
.p2align 6
.amdhsa_kernel gated_mix__grouped_kv_mqa__mixer_token_mlp__prompt_kernel
  .amdhsa_next_free_vgpr 128
  .amdhsa_next_free_sgpr 96
  .amdhsa_accum_offset 128
  .amdhsa_group_segment_fixed_size 0
  .amdhsa_kernarg_size 112
  .amdhsa_user_sgpr_count 2
  .amdhsa_user_sgpr_kernarg_segment_ptr 1
  .amdhsa_system_sgpr_workgroup_id_x 1
.end_amdhsa_kernel
```
